```python
import torch

def _softmax(x, axis=-1):
    return torch.softmax(x, dim=axis)
def _gelu(x):
    return torch.nn.functional.gelu(x, approximate="tanh")
def _silu(x):
    return torch.nn.functional.silu(x)
def _sigmoid(x):
    return torch.sigmoid(x)
def _layernorm(x, axis=-1, eps=1e-5):
    m = x.mean(dim=axis, keepdim=True)
    v = x.var(dim=axis, keepdim=True, unbiased=False)
    return (x - m) / torch.sqrt(v + eps)
def _scatter_add(tgt, idx, src, axis=0):
    return tgt.clone().index_add_(axis, idx, src)
def _segment_sum(src, seg, n):
    out = torch.zeros((n,) + src.shape[1:], dtype=src.dtype)
    return out.index_add_(0, seg, src)
def _pad(x, pw):
    flat = tuple(v for pair in reversed(pw) for v in pair)
    return torch.nn.functional.pad(x, flat)

kernel_name = 'sequential_preLN__sliding_block__mixer_s_mlp__prompt'

def setup_inputs():

    _w = (lambda a: (lambda t: t.to(torch.bfloat16) if t.is_floating_point() else t)(torch.as_tensor(a)))
    def _A_setup():
        B, S, D = 1, 2048, 640
        return {
            "x": _w((lambda *s: torch.randn(*s, dtype=torch.bfloat16) * 0.05)(B, S, D)),
            "wqkv": _w((lambda *s: torch.randn(*s, dtype=torch.bfloat16) * 0.05)(D, 3 * D)),
            "wo": _w((lambda *s: torch.randn(*s, dtype=torch.bfloat16) * 0.05)(D, D)),
        }
    _A_in = _A_setup()

    def _B_setup():
        B, S, D, F = 1, 2048, 640, 1536
        return {
            "x":  _w((lambda *s: torch.randn(*s, dtype=torch.bfloat16) * 0.05)(B, S, D)),
            "w1": _w((lambda *s: torch.randn(*s, dtype=torch.bfloat16) * 3.2)(D, D) * (D ** -0.5)),
            "w2": _w((lambda *s: torch.randn(*s, dtype=torch.bfloat16) * 3.2)(D, D) * (D ** -0.5)),
            "w3": _w((lambda *s: torch.randn(*s, dtype=torch.bfloat16) * 3.2)(D, F) * (D ** -0.5)),
            "w4": _w((lambda *s: torch.randn(*s, dtype=torch.bfloat16) * 3.2)(F, D) * (F ** -0.5)),
        }
    _B_in = _B_setup()

    return {
        "A_x": _A_in["x"],
        "A_wqkv": _A_in["wqkv"],
        "A_wo": _A_in["wo"],
        "B_x": _B_in["x"],
        "B_w1": _B_in["w1"],
        "B_w2": _B_in["w2"],
        "B_w3": _B_in["w3"],
        "B_w4": _B_in["w4"],
    }

def reference(A_x, A_wqkv, A_wo, B_x, B_w1, B_w2, B_w3, B_w4):
    def _A_ref(x, wqkv, wo):
        B, S, D = x.shape
        H = 32; Dh = D // H; W = 256
        qkv = (lambda x, *d: x.permute(*d))((x @ wqkv).reshape(B, S, 3, H, Dh), 2, 0, 3, 1, 4)
        q, k, v = qkv[0], qkv[1], qkv[2]
        scores = torch.einsum("bhqd,bhkd->bhqk", q, k) * (Dh ** -0.5)
        idx = torch.arange(S)
        mask = (idx[:, None] - idx[None, :] >= 0) & (idx[:, None] - idx[None, :] < W)
        scores = torch.where(mask[None, None], scores, -1e9)
        p = _softmax(scores, axis=-1)
        o = torch.einsum("bhqk,bhkd->bhqd", p, v)
        return (lambda x, *d: x.permute(*d))(o, 0, 2, 1, 3).reshape(B, S, D) @ wo

    def _B_ref(x, w1, w2, w3, w4):
        B, S, D = x.shape
        h = _gelu(_layernorm(x, axis=-1) @ w1)
        c = D // 4
        g0 = _pad(h[:, :, 0*c:1*c], ((0, 0), (1, 0), (0, 0)))[:, :S, :]
        g1 = _pad(h[:, :, 1*c:2*c], ((0, 0), (0, 1), (0, 0)))[:, 1:, :]
        g2 = _pad(h[:, :, 2*c:3*c], ((0, 0), (2, 0), (0, 0)))[:, :S, :]
        g3 = _pad(h[:, :, 3*c:   ], ((0, 0), (0, 2), (0, 0)))[:, 2:, :]
        hs = torch.concatenate([g0, g1, g2, g3], axis=-1) @ w2
        x1 = x + hs
        h2 = _gelu(_layernorm(x1, axis=-1) @ w3) @ w4
        return x1 + h2

    x = A_x
    h = x + _A_ref(_layernorm(x, axis=-1), A_wqkv, A_wo)
    h2 = h + _B_ref(_layernorm(h, axis=-1), B_w1, B_w2, B_w3, B_w4)
    return h2
```

```asm
; @launch kernel=k1_qkv_kernel grid=(256,1,1) block=(512,1,1) lds=163840
; @launch kernel=k2_attn_kernel grid=(256,1,1) block=(512,1,1) lds=65920
; @launch kernel=k3_fused_kernel grid=(256,1,1) block=(320,1,1) lds=147968
.amdgcn_target "amdgcn-amd-amdhsa--gfx950"
.text
.globl k1_qkv_kernel
.p2align 8
.type k1_qkv_kernel,@function
k1_qkv_kernel:
    s_cmp_ge_u32 s2, 256
    s_cbranch_scc1 k1_qkv_kernel_end
    s_load_dwordx16 s[16:31], s[0:1], 0
    s_load_dwordx4 s[32:35], s[0:1], 64
    s_load_dwordx2 s[36:37], s[0:1], 80
    s_and_b32 s3, s2, 7
    s_lshr_b32 s4, s2, 3
    s_and_b32 s5, s3, 1
    s_lshr_b32 s9, s3, 1
    s_lshl_b32 s3, s5, 3
    s_and_b32 s5, s4, 7
    s_add_u32 s3, s3, s5
    s_lshr_b32 s4, s4, 3
    s_lshl_b32 s9, s9, 2
    s_add_u32 s4, s4, s9
    s_cmp_ge_u32 s4, 15
    s_cbranch_scc1 k1_qkv_kernel_end
    s_mul_i32 s5, s3, 128
    s_mul_i32 s6, s4, 128
    v_lshrrev_b32 v1, 6, v0
    v_and_b32 v2, 63, v0
    v_and_b32 v3, 15, v0
    v_bfe_u32 v4, v0, 4, 2
    s_nop 0
    v_readfirstlane_b32 s7, v1
    s_lshl_b32 s8, s7, 10
    s_lshr_b32 s9, s5, 4
    s_lshr_b32 s38, s7, 1
    s_and_b32 s39, s7, 1
    s_mul_i32 s64, s38, 2
    s_add_u32 s64, s64, s9
    v_lshl_add_u32 v5, s64, 4, v3
    s_add_u32 s65, s64, 1
    v_lshl_add_u32 v6, s65, 4, v3
    v_bfe_u32 v8, v0, 3, 3
    v_and_b32 v9, 7, v0
    v_xor_b32 v9, v9, v8
    s_mul_i32 s10, s7, 16
    s_add_u32 s10, s10, s5
    v_add_u32 v8, s10, v8
    v_mul_u32_u24 v8, 1280, v8
    v_lshl_add_u32 v12, v9, 4, v8
    v_and_b32 v8, 7, v3
    v_lshrrev_b32 v9, 3, v3
    v_lshlrev_b32 v9, 10, v9
    v_lshl_add_u32 v9, v8, 7, v9
    s_mul_i32 s10, s38, 4096
    v_add_u32 v9, s10, v9
    v_or_b32 v10, 0, v4
    v_xor_b32 v10, v10, v8
    v_lshl_add_u32 v13, v10, 4, v9
    v_add_u32 v14, 65536, v13
    v_add_u32 v15, 131072, v13
    v_or_b32 v10, 4, v4
    v_xor_b32 v10, v10, v8
    v_lshl_add_u32 v16, v10, 4, v9
    v_add_u32 v17, 65536, v16
    v_add_u32 v18, 131072, v16
    s_mul_i32 s15, s7, 2048
    v_add_u32 v8, 0, v0
    v_lshrrev_b32 v9, 4, v8
    v_mul_u32_u24 v10, 16, v9
    v_sub_u32 v10, v8, v10
    v_and_b32 v19, 0xfffffff3, v9
    v_bfe_u32 v8, v9, 2, 1
    v_lshl_add_u32 v19, v8, 3, v19
    v_bfe_u32 v8, v9, 3, 1
    v_lshl_add_u32 v19, v8, 2, v19
    v_mul_u32_u24 v19, 3840, v19
    v_and_b32 v8, 7, v9
    v_mov_b32 v8, v8
    v_lshlrev_b32 v8, 1, v8
    v_xor_b32 v10, v10, v8
    v_lshl_add_u32 v19, v10, 4, v19
    v_lshl_add_u32 v19, s6, 1, v19
    v_add_u32 v8, 512, v0
    v_lshrrev_b32 v9, 4, v8
    v_mul_u32_u24 v10, 16, v9
    v_sub_u32 v10, v8, v10
    v_and_b32 v20, 0xfffffff3, v9
    v_bfe_u32 v8, v9, 2, 1
    v_lshl_add_u32 v20, v8, 3, v20
    v_bfe_u32 v8, v9, 3, 1
    v_lshl_add_u32 v20, v8, 2, v20
    v_mul_u32_u24 v20, 3840, v20
    v_and_b32 v8, 7, v9
    v_mov_b32 v8, v8
    v_lshlrev_b32 v8, 1, v8
    v_xor_b32 v10, v10, v8
    v_lshl_add_u32 v20, v10, 4, v20
    v_lshl_add_u32 v20, s6, 1, v20
    s_mul_i32 s13, s39, 4
    v_bfe_u32 v8, v0, 2, 3
    v_bfe_u32 v9, v0, 5, 1
    v_lshl_add_u32 v9, v9, 4, v8
    v_mul_u32_u24 v9, 256, v9
    v_and_b32 v10, 3, v0
    v_lshl_add_u32 v9, v10, 3, v9
    v_mov_b32 v8, v8
    s_add_u32 s9, s13, 0
    v_xor_b32 v10, s9, v8
    v_lshl_add_u32 v21, v10, 5, v9
    v_add_u32 v22, 65536, v21
    s_add_u32 s9, s13, 1
    v_xor_b32 v10, s9, v8
    v_lshl_add_u32 v23, v10, 5, v9
    v_add_u32 v24, 65536, v23
    s_add_u32 s9, s13, 2
    v_xor_b32 v10, s9, v8
    v_lshl_add_u32 v25, v10, 5, v9
    v_add_u32 v26, 65536, v25
    s_add_u32 s9, s13, 3
    v_xor_b32 v10, s9, v8
    v_lshl_add_u32 v27, v10, 5, v9
    v_add_u32 v28, 65536, v27
    s_add_u32 s9, s7, 0
    s_min_u32 s9, s9, 7
    v_xor_b32 v10, s9, v8
    v_lshl_add_u32 v29, v10, 5, v9
    v_add_u32 v30, 65536, v29
    v_mov_b32 v32, 0x3f803f80
    v_mov_b32 v33, 0x3f803f80
    v_mov_b32 v34, 0x3f803f80
    v_mov_b32 v35, 0x3f803f80
    v_mov_b32 v36, 0
    v_mov_b32 v38, 0
    v_mov_b32 v37, 0
    v_mov_b32 v39, 0
    v_mov_b32 v44, 0
    v_mov_b32 v52, 0
    v_mov_b32 v45, 0
    v_mov_b32 v53, 0
    v_mov_b32 v46, 0
    v_mov_b32 v54, 0
    v_mov_b32 v47, 0
    v_mov_b32 v55, 0
    v_mov_b32 v48, 0
    v_mov_b32 v56, 0
    v_mov_b32 v49, 0
    v_mov_b32 v57, 0
    v_mov_b32 v50, 0
    v_mov_b32 v58, 0
    v_mov_b32 v51, 0
    v_mov_b32 v59, 0
    s_lshl_b32 s9, s13, 4
    s_add_u32 s6, s6, s9
    s_waitcnt lgkmcnt(0)
    s_mov_b32 s40, s16
    s_mov_b32 s41, s17
    s_and_b32 s41, s41, 0xffff
    s_mov_b32 s42, 2621440
    s_mov_b32 s43, 0x00020000
    s_mov_b32 s44, s18
    s_mov_b32 s45, s19
    s_and_b32 s45, s45, 0xffff
    s_mov_b32 s46, 2457600
    s_mov_b32 s47, 0x00020000
    v_lshlrev_b32 v125, 7, v0
    s_mov_b32 s10, 0
    s_add_u32 m0, s15, 81920
    s_nop 0
    buffer_load_dwordx4 v12, s[40:43], s10 offen lds
    s_mov_b32 s10, 10240
    s_add_u32 m0, s15, 82944
    s_nop 0
    buffer_load_dwordx4 v12, s[40:43], s10 offen lds
    s_mov_b32 s10, 0
    s_add_u32 m0, s8, 0
    s_nop 0
    buffer_load_dwordx4 v19, s[44:47], s10 offen lds
    s_mov_b32 s10, 0
    s_add_u32 m0, s8, 8192
    s_nop 0
    buffer_load_dwordx4 v20, s[44:47], s10 offen lds
    s_mov_b32 s48, s36
    s_mov_b32 s49, s37
    s_and_b32 s49, s49, 0xffff
    s_mov_b32 s50, 7864320
    s_mov_b32 s51, 0x00020000
    s_mul_i32 s9, s64, 61440
    s_lshl_b32 s14, s6, 5
    s_add_u32 s9, s9, s14
    v_lshrrev_b32 v8, 1, v4
    v_lshl_add_u32 v8, v8, 4, v3
    v_lshlrev_b32 v126, 4, v8
    v_and_b32 v8, 1, v4
    v_lshl_add_u32 v126, v8, 3, v126
    v_add_u32 v126, s9, v126
    s_mov_b32 s48, s36
    s_mov_b32 s49, s37
    s_and_b32 s49, s49, 0xffff
    s_mov_b32 s50, 7864320
    s_mov_b32 s51, 0x00020000
    s_mul_i32 s9, s65, 61440
    s_lshl_b32 s14, s6, 5
    s_add_u32 s9, s9, s14
    v_lshrrev_b32 v8, 1, v4
    v_lshl_add_u32 v8, v8, 4, v3
    v_lshlrev_b32 v127, 4, v8
    v_and_b32 v8, 1, v4
    v_lshl_add_u32 v127, v8, 3, v127
    v_add_u32 v127, s9, v127
    s_mov_b32 s10, 128
    s_add_u32 m0, s15, 98304
    s_nop 0
    buffer_load_dwordx4 v12, s[40:43], s10 offen lds
    s_mov_b32 s10, 10368
    s_add_u32 m0, s15, 99328
    s_nop 0
    buffer_load_dwordx4 v12, s[40:43], s10 offen lds
    s_mov_b32 s10, 245760
    s_add_u32 m0, s8, 16384
    s_nop 0
    buffer_load_dwordx4 v19, s[44:47], s10 offen lds
    s_mov_b32 s10, 245760
    s_add_u32 m0, s8, 24576
    s_nop 0
    buffer_load_dwordx4 v20, s[44:47], s10 offen lds
    s_mov_b32 s10, 256
    s_add_u32 m0, s15, 114688
    s_nop 0
    buffer_load_dwordx4 v12, s[40:43], s10 offen lds
    s_mov_b32 s10, 10496
    s_add_u32 m0, s15, 115712
    s_nop 0
    buffer_load_dwordx4 v12, s[40:43], s10 offen lds
    s_mov_b32 s10, 491520
    s_add_u32 m0, s8, 32768
    s_nop 0
    buffer_load_dwordx4 v19, s[44:47], s10 offen lds
    s_mov_b32 s10, 491520
    s_add_u32 m0, s8, 40960
    s_nop 0
    buffer_load_dwordx4 v20, s[44:47], s10 offen lds
    v_mov_b32 v60, 0
    v_mov_b32 v61, 0
    v_mov_b32 v62, 0
    v_mov_b32 v63, 0
    v_mov_b32 v64, 0
    v_mov_b32 v65, 0
    v_mov_b32 v66, 0
    v_mov_b32 v67, 0
    v_mov_b32 v68, 0
    v_mov_b32 v69, 0
    v_mov_b32 v70, 0
    v_mov_b32 v71, 0
    v_mov_b32 v72, 0
    v_mov_b32 v73, 0
    v_mov_b32 v74, 0
    v_mov_b32 v75, 0
    v_mov_b32 v76, 0
    v_mov_b32 v77, 0
    v_mov_b32 v78, 0
    v_mov_b32 v79, 0
    v_mov_b32 v80, 0
    v_mov_b32 v81, 0
    v_mov_b32 v82, 0
    v_mov_b32 v83, 0
    v_mov_b32 v84, 0
    v_mov_b32 v85, 0
    v_mov_b32 v86, 0
    v_mov_b32 v87, 0
    v_mov_b32 v88, 0
    v_mov_b32 v89, 0
    v_mov_b32 v90, 0
    v_mov_b32 v91, 0
    v_mov_b32 v40, 0
    v_mov_b32 v41, 0
    v_mov_b32 v42, 0
    v_mov_b32 v43, 0
    s_waitcnt vmcnt(8)
    s_barrier
    ds_read_b128 v[92:95], v14 offset:16384
    ds_read_b128 v[96:99], v14 offset:18432
    ds_read_b64_tr_b16 v[128:129], v21 offset:0
    ds_read_b64_tr_b16 v[130:131], v21 offset:2048
    ds_read_b64_tr_b16 v[132:133], v23 offset:0
    ds_read_b64_tr_b16 v[134:135], v23 offset:2048
    ds_read_b64_tr_b16 v[136:137], v25 offset:0
    ds_read_b64_tr_b16 v[138:139], v25 offset:2048
    ds_read_b64_tr_b16 v[140:141], v27 offset:0
    ds_read_b64_tr_b16 v[142:143], v27 offset:2048
    ds_read_b64_tr_b16 v[144:145], v29 offset:0
    ds_read_b64_tr_b16 v[146:147], v29 offset:2048
    ds_read_b128 v[100:103], v17 offset:16384
    ds_read_b128 v[104:107], v17 offset:18432
    ds_read_b64_tr_b16 v[148:149], v21 offset:8192
    ds_read_b64_tr_b16 v[150:151], v21 offset:10240
    s_waitcnt lgkmcnt(12)
    v_mfma_f32_16x16x32_bf16 v[60:63], v[128:131], v[92:95], v[60:63]
    v_mfma_f32_16x16x32_bf16 v[76:79], v[128:131], v[96:99], v[76:79]
    v_mfma_f32_16x16x32_bf16 v[44:47], v[32:35], v[92:95], v[44:47]
    s_mov_b32 s10, 384
    s_add_u32 m0, s15, 131072
    s_nop 0
    buffer_load_dwordx4 v12, s[40:43], s10 offen lds
    ds_read_b64_tr_b16 v[152:153], v23 offset:8192
    ds_read_b64_tr_b16 v[154:155], v23 offset:10240
    s_waitcnt lgkmcnt(12)
    v_mfma_f32_16x16x32_bf16 v[64:67], v[132:135], v[92:95], v[64:67]
    v_mfma_f32_16x16x32_bf16 v[80:83], v[132:135], v[96:99], v[80:83]
    v_mfma_f32_16x16x32_bf16 v[52:55], v[92:95], v[92:95], v[52:55]
    s_mov_b32 s10, 10624
    s_add_u32 m0, s15, 132096
    s_nop 0
    buffer_load_dwordx4 v12, s[40:43], s10 offen lds
    ds_read_b64_tr_b16 v[128:129], v25 offset:8192
    ds_read_b64_tr_b16 v[130:131], v25 offset:10240
    s_waitcnt lgkmcnt(12)
    v_mfma_f32_16x16x32_bf16 v[68:71], v[136:139], v[92:95], v[68:71]
    v_mfma_f32_16x16x32_bf16 v[84:87], v[136:139], v[96:99], v[84:87]
    v_mfma_f32_16x16x32_bf16 v[48:51], v[32:35], v[96:99], v[48:51]
    s_mov_b32 s10, 737280
    s_add_u32 m0, s8, 49152
    s_nop 0
    buffer_load_dwordx4 v19, s[44:47], s10 offen lds
    ds_read_b64_tr_b16 v[132:133], v27 offset:8192
    ds_read_b64_tr_b16 v[134:135], v27 offset:10240
    s_waitcnt lgkmcnt(12)
    v_mfma_f32_16x16x32_bf16 v[72:75], v[140:143], v[92:95], v[72:75]
    v_mfma_f32_16x16x32_bf16 v[88:91], v[140:143], v[96:99], v[88:91]
    v_mfma_f32_16x16x32_bf16 v[56:59], v[96:99], v[96:99], v[56:59]
    s_mov_b32 s10, 737280
    s_add_u32 m0, s8, 57344
    s_nop 0
    buffer_load_dwordx4 v20, s[44:47], s10 offen lds
    ds_read_b64_tr_b16 v[136:137], v29 offset:8192
    ds_read_b64_tr_b16 v[138:139], v29 offset:10240
    s_waitcnt lgkmcnt(12)
    v_mfma_f32_16x16x32_bf16 v[40:43], v[144:147], v[32:35], v[40:43]
    s_waitcnt vmcnt(8)
    s_barrier
    ds_read_b128 v[108:111], v14 offset:32768
    ds_read_b128 v[112:115], v14 offset:34816
    ds_read_b64_tr_b16 v[140:141], v21 offset:16384
    ds_read_b64_tr_b16 v[142:143], v21 offset:18432
    s_waitcnt lgkmcnt(12)
    v_mfma_f32_16x16x32_bf16 v[60:63], v[148:151], v[100:103], v[60:63]
    v_mfma_f32_16x16x32_bf16 v[76:79], v[148:151], v[104:107], v[76:79]
    v_mfma_f32_16x16x32_bf16 v[44:47], v[32:35], v[100:103], v[44:47]
    s_mov_b32 s10, 512
    s_add_u32 m0, s15, 147456
    s_nop 0
    buffer_load_dwordx4 v12, s[40:43], s10 offen lds
    ds_read_b64_tr_b16 v[144:145], v23 offset:16384
    ds_read_b64_tr_b16 v[146:147], v23 offset:18432
    s_waitcnt lgkmcnt(12)
    v_mfma_f32_16x16x32_bf16 v[64:67], v[152:155], v[100:103], v[64:67]
    v_mfma_f32_16x16x32_bf16 v[80:83], v[152:155], v[104:107], v[80:83]
    v_mfma_f32_16x16x32_bf16 v[52:55], v[100:103], v[100:103], v[52:55]
    s_mov_b32 s10, 10752
    s_add_u32 m0, s15, 148480
    s_nop 0
    buffer_load_dwordx4 v12, s[40:43], s10 offen lds
    ds_read_b64_tr_b16 v[148:149], v25 offset:16384
    ds_read_b64_tr_b16 v[150:151], v25 offset:18432
    s_waitcnt lgkmcnt(12)
    v_mfma_f32_16x16x32_bf16 v[68:71], v[128:131], v[100:103], v[68:71]
    v_mfma_f32_16x16x32_bf16 v[84:87], v[128:131], v[104:107], v[84:87]
    v_mfma_f32_16x16x32_bf16 v[48:51], v[32:35], v[104:107], v[48:51]
    s_mov_b32 s10, 983040
    s_add_u32 m0, s8, 65536
    s_nop 0
    buffer_load_dwordx4 v19, s[44:47], s10 offen lds
    ds_read_b64_tr_b16 v[152:153], v27 offset:16384
    ds_read_b64_tr_b16 v[154:155], v27 offset:18432
    s_waitcnt lgkmcnt(12)
    v_mfma_f32_16x16x32_bf16 v[72:75], v[132:135], v[100:103], v[72:75]
    v_mfma_f32_16x16x32_bf16 v[88:91], v[132:135], v[104:107], v[88:91]
    v_mfma_f32_16x16x32_bf16 v[56:59], v[104:107], v[104:107], v[56:59]
    s_mov_b32 s10, 983040
    s_add_u32 m0, s8, 73728
    s_nop 0
    buffer_load_dwordx4 v20, s[44:47], s10 offen lds
    ds_read_b64_tr_b16 v[128:129], v29 offset:16384
    ds_read_b64_tr_b16 v[130:131], v29 offset:18432
    s_waitcnt lgkmcnt(12)
    v_mfma_f32_16x16x32_bf16 v[40:43], v[136:139], v[32:35], v[40:43]
    ds_read_b128 v[116:119], v17 offset:32768
    ds_read_b128 v[120:123], v17 offset:34816
    ds_read_b64_tr_b16 v[132:133], v21 offset:24576
    ds_read_b64_tr_b16 v[134:135], v21 offset:26624
    s_waitcnt lgkmcnt(12)
    v_mfma_f32_16x16x32_bf16 v[60:63], v[140:143], v[108:111], v[60:63]
    v_mfma_f32_16x16x32_bf16 v[76:79], v[140:143], v[112:115], v[76:79]
    v_mfma_f32_16x16x32_bf16 v[44:47], v[32:35], v[108:111], v[44:47]
    ds_read_b64_tr_b16 v[136:137], v23 offset:24576
    ds_read_b64_tr_b16 v[138:139], v23 offset:26624
    s_waitcnt lgkmcnt(12)
    v_mfma_f32_16x16x32_bf16 v[64:67], v[144:147], v[108:111], v[64:67]
    v_mfma_f32_16x16x32_bf16 v[80:83], v[144:147], v[112:115], v[80:83]
    v_mfma_f32_16x16x32_bf16 v[52:55], v[108:111], v[108:111], v[52:55]
    ds_read_b64_tr_b16 v[140:141], v25 offset:24576
    ds_read_b64_tr_b16 v[142:143], v25 offset:26624
    s_waitcnt lgkmcnt(12)
    v_mfma_f32_16x16x32_bf16 v[68:71], v[148:151], v[108:111], v[68:71]
    v_mfma_f32_16x16x32_bf16 v[84:87], v[148:151], v[112:115], v[84:87]
    v_mfma_f32_16x16x32_bf16 v[48:51], v[32:35], v[112:115], v[48:51]
    ds_read_b64_tr_b16 v[144:145], v27 offset:24576
    ds_read_b64_tr_b16 v[146:147], v27 offset:26624
    s_waitcnt lgkmcnt(12)
    v_mfma_f32_16x16x32_bf16 v[72:75], v[152:155], v[108:111], v[72:75]
    v_mfma_f32_16x16x32_bf16 v[88:91], v[152:155], v[112:115], v[88:91]
    v_mfma_f32_16x16x32_bf16 v[56:59], v[112:115], v[112:115], v[56:59]
    ds_read_b64_tr_b16 v[148:149], v29 offset:24576
    ds_read_b64_tr_b16 v[150:151], v29 offset:26624
    s_waitcnt lgkmcnt(12)
    v_mfma_f32_16x16x32_bf16 v[40:43], v[128:131], v[32:35], v[40:43]
    s_waitcnt vmcnt(8)
    s_barrier
    ds_read_b128 v[92:95], v14 offset:49152
    ds_read_b128 v[96:99], v14 offset:51200
    ds_read_b64_tr_b16 v[152:153], v21 offset:32768
    ds_read_b64_tr_b16 v[154:155], v21 offset:34816
    s_waitcnt lgkmcnt(12)
    v_mfma_f32_16x16x32_bf16 v[60:63], v[132:135], v[116:119], v[60:63]
    v_mfma_f32_16x16x32_bf16 v[76:79], v[132:135], v[120:123], v[76:79]
    v_mfma_f32_16x16x32_bf16 v[44:47], v[32:35], v[116:119], v[44:47]
    s_mov_b32 s10, 640
    s_add_u32 m0, s15, 81920
    s_nop 0
    buffer_load_dwordx4 v12, s[40:43], s10 offen lds
    ds_read_b64_tr_b16 v[128:129], v23 offset:32768
    ds_read_b64_tr_b16 v[130:131], v23 offset:34816
    s_waitcnt lgkmcnt(12)
    v_mfma_f32_16x16x32_bf16 v[64:67], v[136:139], v[116:119], v[64:67]
    v_mfma_f32_16x16x32_bf16 v[80:83], v[136:139], v[120:123], v[80:83]
    v_mfma_f32_16x16x32_bf16 v[52:55], v[116:119], v[116:119], v[52:55]
    s_mov_b32 s10, 10880
    s_add_u32 m0, s15, 82944
    s_nop 0
    buffer_load_dwordx4 v12, s[40:43], s10 offen lds
    ds_read_b64_tr_b16 v[132:133], v25 offset:32768
    ds_read_b64_tr_b16 v[134:135], v25 offset:34816
    s_waitcnt lgkmcnt(12)
    v_mfma_f32_16x16x32_bf16 v[68:71], v[140:143], v[116:119], v[68:71]
    v_mfma_f32_16x16x32_bf16 v[84:87], v[140:143], v[120:123], v[84:87]
    v_mfma_f32_16x16x32_bf16 v[48:51], v[32:35], v[120:123], v[48:51]
    s_mov_b32 s10, 1228800
    s_add_u32 m0, s8, 0
    s_nop 0
    buffer_load_dwordx4 v19, s[44:47], s10 offen lds
    ds_read_b64_tr_b16 v[136:137], v27 offset:32768
    ds_read_b64_tr_b16 v[138:139], v27 offset:34816
    s_waitcnt lgkmcnt(12)
    v_mfma_f32_16x16x32_bf16 v[72:75], v[144:147], v[116:119], v[72:75]
    v_mfma_f32_16x16x32_bf16 v[88:91], v[144:147], v[120:123], v[88:91]
    v_mfma_f32_16x16x32_bf16 v[56:59], v[120:123], v[120:123], v[56:59]
    s_mov_b32 s10, 1228800
    s_add_u32 m0, s8, 8192
    s_nop 0
    buffer_load_dwordx4 v20, s[44:47], s10 offen lds
    ds_read_b64_tr_b16 v[140:141], v29 offset:32768
    ds_read_b64_tr_b16 v[142:143], v29 offset:34816
    s_waitcnt lgkmcnt(12)
    v_mfma_f32_16x16x32_bf16 v[40:43], v[148:151], v[32:35], v[40:43]
    ds_read_b128 v[100:103], v17 offset:49152
    ds_read_b128 v[104:107], v17 offset:51200
    ds_read_b64_tr_b16 v[144:145], v21 offset:40960
    ds_read_b64_tr_b16 v[146:147], v21 offset:43008
    s_waitcnt lgkmcnt(12)
    v_mfma_f32_16x16x32_bf16 v[60:63], v[152:155], v[92:95], v[60:63]
    v_mfma_f32_16x16x32_bf16 v[76:79], v[152:155], v[96:99], v[76:79]
    v_mfma_f32_16x16x32_bf16 v[44:47], v[32:35], v[92:95], v[44:47]
    ds_read_b64_tr_b16 v[148:149], v23 offset:40960
    ds_read_b64_tr_b16 v[150:151], v23 offset:43008
    s_waitcnt lgkmcnt(12)
    v_mfma_f32_16x16x32_bf16 v[64:67], v[128:131], v[92:95], v[64:67]
    v_mfma_f32_16x16x32_bf16 v[80:83], v[128:131], v[96:99], v[80:83]
    v_mfma_f32_16x16x32_bf16 v[52:55], v[92:95], v[92:95], v[52:55]
    ds_read_b64_tr_b16 v[152:153], v25 offset:40960
    ds_read_b64_tr_b16 v[154:155], v25 offset:43008
    s_waitcnt lgkmcnt(12)
    v_mfma_f32_16x16x32_bf16 v[68:71], v[132:135], v[92:95], v[68:71]
    v_mfma_f32_16x16x32_bf16 v[84:87], v[132:135], v[96:99], v[84:87]
    v_mfma_f32_16x16x32_bf16 v[48:51], v[32:35], v[96:99], v[48:51]
    ds_read_b64_tr_b16 v[128:129], v27 offset:40960
    ds_read_b64_tr_b16 v[130:131], v27 offset:43008
    s_waitcnt lgkmcnt(12)
    v_mfma_f32_16x16x32_bf16 v[72:75], v[136:139], v[92:95], v[72:75]
    v_mfma_f32_16x16x32_bf16 v[88:91], v[136:139], v[96:99], v[88:91]
    v_mfma_f32_16x16x32_bf16 v[56:59], v[96:99], v[96:99], v[56:59]
    ds_read_b64_tr_b16 v[132:133], v29 offset:40960
    ds_read_b64_tr_b16 v[134:135], v29 offset:43008
    s_waitcnt lgkmcnt(12)
    v_mfma_f32_16x16x32_bf16 v[40:43], v[140:143], v[32:35], v[40:43]
    s_waitcnt vmcnt(8)
    s_barrier
    ds_read_b128 v[108:111], v15 offset:0
    ds_read_b128 v[112:115], v15 offset:2048
    ds_read_b64_tr_b16 v[136:137], v21 offset:49152
    ds_read_b64_tr_b16 v[138:139], v21 offset:51200
    s_waitcnt lgkmcnt(12)
    v_mfma_f32_16x16x32_bf16 v[60:63], v[144:147], v[100:103], v[60:63]
    v_mfma_f32_16x16x32_bf16 v[76:79], v[144:147], v[104:107], v[76:79]
    v_mfma_f32_16x16x32_bf16 v[44:47], v[32:35], v[100:103], v[44:47]
    s_mov_b32 s10, 768
    s_add_u32 m0, s15, 98304
    s_nop 0
    buffer_load_dwordx4 v12, s[40:43], s10 offen lds
    ds_read_b64_tr_b16 v[140:141], v23 offset:49152
    ds_read_b64_tr_b16 v[142:143], v23 offset:51200
    s_waitcnt lgkmcnt(12)
    v_mfma_f32_16x16x32_bf16 v[64:67], v[148:151], v[100:103], v[64:67]
    v_mfma_f32_16x16x32_bf16 v[80:83], v[148:151], v[104:107], v[80:83]
    v_mfma_f32_16x16x32_bf16 v[52:55], v[100:103], v[100:103], v[52:55]
    s_mov_b32 s10, 11008
    s_add_u32 m0, s15, 99328
    s_nop 0
    buffer_load_dwordx4 v12, s[40:43], s10 offen lds
    ds_read_b64_tr_b16 v[144:145], v25 offset:49152
    ds_read_b64_tr_b16 v[146:147], v25 offset:51200
    s_waitcnt lgkmcnt(12)
    v_mfma_f32_16x16x32_bf16 v[68:71], v[152:155], v[100:103], v[68:71]
    v_mfma_f32_16x16x32_bf16 v[84:87], v[152:155], v[104:107], v[84:87]
    v_mfma_f32_16x16x32_bf16 v[48:51], v[32:35], v[104:107], v[48:51]
    s_mov_b32 s10, 1474560
    s_add_u32 m0, s8, 16384
    s_nop 0
    buffer_load_dwordx4 v19, s[44:47], s10 offen lds
    ds_read_b64_tr_b16 v[148:149], v27 offset:49152
    ds_read_b64_tr_b16 v[150:151], v27 offset:51200
    s_waitcnt lgkmcnt(12)
    v_mfma_f32_16x16x32_bf16 v[72:75], v[128:131], v[100:103], v[72:75]
    v_mfma_f32_16x16x32_bf16 v[88:91], v[128:131], v[104:107], v[88:91]
    v_mfma_f32_16x16x32_bf16 v[56:59], v[104:107], v[104:107], v[56:59]
    s_mov_b32 s10, 1474560
    s_add_u32 m0, s8, 24576
    s_nop 0
    buffer_load_dwordx4 v20, s[44:47], s10 offen lds
    ds_read_b64_tr_b16 v[152:153], v29 offset:49152
    ds_read_b64_tr_b16 v[154:155], v29 offset:51200
    s_waitcnt lgkmcnt(12)
    v_mfma_f32_16x16x32_bf16 v[40:43], v[132:135], v[32:35], v[40:43]
    ds_read_b128 v[116:119], v18 offset:0
    ds_read_b128 v[120:123], v18 offset:2048
    ds_read_b64_tr_b16 v[128:129], v21 offset:57344
    ds_read_b64_tr_b16 v[130:131], v21 offset:59392
    s_waitcnt lgkmcnt(12)
    v_mfma_f32_16x16x32_bf16 v[60:63], v[136:139], v[108:111], v[60:63]
    v_mfma_f32_16x16x32_bf16 v[76:79], v[136:139], v[112:115], v[76:79]
    v_mfma_f32_16x16x32_bf16 v[44:47], v[32:35], v[108:111], v[44:47]
    ds_read_b64_tr_b16 v[132:133], v23 offset:57344
    ds_read_b64_tr_b16 v[134:135], v23 offset:59392
    s_waitcnt lgkmcnt(12)
    v_mfma_f32_16x16x32_bf16 v[64:67], v[140:143], v[108:111], v[64:67]
    v_mfma_f32_16x16x32_bf16 v[80:83], v[140:143], v[112:115], v[80:83]
    v_mfma_f32_16x16x32_bf16 v[52:55], v[108:111], v[108:111], v[52:55]
    ds_read_b64_tr_b16 v[136:137], v25 offset:57344
    ds_read_b64_tr_b16 v[138:139], v25 offset:59392
    s_waitcnt lgkmcnt(12)
    v_mfma_f32_16x16x32_bf16 v[68:71], v[144:147], v[108:111], v[68:71]
    v_mfma_f32_16x16x32_bf16 v[84:87], v[144:147], v[112:115], v[84:87]
    v_mfma_f32_16x16x32_bf16 v[48:51], v[32:35], v[112:115], v[48:51]
    ds_read_b64_tr_b16 v[140:141], v27 offset:57344
    ds_read_b64_tr_b16 v[142:143], v27 offset:59392
    s_waitcnt lgkmcnt(12)
    v_mfma_f32_16x16x32_bf16 v[72:75], v[148:151], v[108:111], v[72:75]
    v_mfma_f32_16x16x32_bf16 v[88:91], v[148:151], v[112:115], v[88:91]
    v_mfma_f32_16x16x32_bf16 v[56:59], v[112:115], v[112:115], v[56:59]
    ds_read_b64_tr_b16 v[144:145], v29 offset:57344
    ds_read_b64_tr_b16 v[146:147], v29 offset:59392
    s_waitcnt lgkmcnt(12)
    v_mfma_f32_16x16x32_bf16 v[40:43], v[152:155], v[32:35], v[40:43]
    s_waitcnt vmcnt(8)
    s_barrier
    ds_read_b128 v[92:95], v15 offset:16384
    ds_read_b128 v[96:99], v15 offset:18432
    ds_read_b64_tr_b16 v[148:149], v22 offset:0
    ds_read_b64_tr_b16 v[150:151], v22 offset:2048
    s_waitcnt lgkmcnt(12)
    v_mfma_f32_16x16x32_bf16 v[60:63], v[128:131], v[116:119], v[60:63]
    v_mfma_f32_16x16x32_bf16 v[76:79], v[128:131], v[120:123], v[76:79]
    v_mfma_f32_16x16x32_bf16 v[44:47], v[32:35], v[116:119], v[44:47]
    s_mov_b32 s10, 896
    s_add_u32 m0, s15, 114688
    s_nop 0
    buffer_load_dwordx4 v12, s[40:43], s10 offen lds
    ds_read_b64_tr_b16 v[152:153], v24 offset:0
    ds_read_b64_tr_b16 v[154:155], v24 offset:2048
    s_waitcnt lgkmcnt(12)
    v_mfma_f32_16x16x32_bf16 v[64:67], v[132:135], v[116:119], v[64:67]
    v_mfma_f32_16x16x32_bf16 v[80:83], v[132:135], v[120:123], v[80:83]
    v_mfma_f32_16x16x32_bf16 v[52:55], v[116:119], v[116:119], v[52:55]
    s_mov_b32 s10, 11136
    s_add_u32 m0, s15, 115712
    s_nop 0
    buffer_load_dwordx4 v12, s[40:43], s10 offen lds
    ds_read_b64_tr_b16 v[128:129], v26 offset:0
    ds_read_b64_tr_b16 v[130:131], v26 offset:2048
    s_waitcnt lgkmcnt(12)
    v_mfma_f32_16x16x32_bf16 v[68:71], v[136:139], v[116:119], v[68:71]
    v_mfma_f32_16x16x32_bf16 v[84:87], v[136:139], v[120:123], v[84:87]
    v_mfma_f32_16x16x32_bf16 v[48:51], v[32:35], v[120:123], v[48:51]
    s_mov_b32 s10, 1720320
    s_add_u32 m0, s8, 32768
    s_nop 0
    buffer_load_dwordx4 v19, s[44:47], s10 offen lds
    ds_read_b64_tr_b16 v[132:133], v28 offset:0
    ds_read_b64_tr_b16 v[134:135], v28 offset:2048
    s_waitcnt lgkmcnt(12)
    v_mfma_f32_16x16x32_bf16 v[72:75], v[140:143], v[116:119], v[72:75]
    v_mfma_f32_16x16x32_bf16 v[88:91], v[140:143], v[120:123], v[88:91]
    v_mfma_f32_16x16x32_bf16 v[56:59], v[120:123], v[120:123], v[56:59]
    s_mov_b32 s10, 1720320
    s_add_u32 m0, s8, 40960
    s_nop 0
    buffer_load_dwordx4 v20, s[44:47], s10 offen lds
    ds_read_b64_tr_b16 v[136:137], v30 offset:0
    ds_read_b64_tr_b16 v[138:139], v30 offset:2048
    s_waitcnt lgkmcnt(12)
    v_mfma_f32_16x16x32_bf16 v[40:43], v[144:147], v[32:35], v[40:43]
    ds_read_b128 v[100:103], v18 offset:16384
    ds_read_b128 v[104:107], v18 offset:18432
    ds_read_b64_tr_b16 v[140:141], v22 offset:8192
    ds_read_b64_tr_b16 v[142:143], v22 offset:10240
    s_waitcnt lgkmcnt(12)
    v_mfma_f32_16x16x32_bf16 v[60:63], v[148:151], v[92:95], v[60:63]
    v_mfma_f32_16x16x32_bf16 v[76:79], v[148:151], v[96:99], v[76:79]
    v_mfma_f32_16x16x32_bf16 v[44:47], v[32:35], v[92:95], v[44:47]
    ds_read_b64_tr_b16 v[144:145], v24 offset:8192
    ds_read_b64_tr_b16 v[146:147], v24 offset:10240
    s_waitcnt lgkmcnt(12)
    v_mfma_f32_16x16x32_bf16 v[64:67], v[152:155], v[92:95], v[64:67]
    v_mfma_f32_16x16x32_bf16 v[80:83], v[152:155], v[96:99], v[80:83]
    v_mfma_f32_16x16x32_bf16 v[52:55], v[92:95], v[92:95], v[52:55]
    ds_read_b64_tr_b16 v[148:149], v26 offset:8192
    ds_read_b64_tr_b16 v[150:151], v26 offset:10240
    s_waitcnt lgkmcnt(12)
    v_mfma_f32_16x16x32_bf16 v[68:71], v[128:131], v[92:95], v[68:71]
    v_mfma_f32_16x16x32_bf16 v[84:87], v[128:131], v[96:99], v[84:87]
    v_mfma_f32_16x16x32_bf16 v[48:51], v[32:35], v[96:99], v[48:51]
    ds_read_b64_tr_b16 v[152:153], v28 offset:8192
    ds_read_b64_tr_b16 v[154:155], v28 offset:10240
    s_waitcnt lgkmcnt(12)
    v_mfma_f32_16x16x32_bf16 v[72:75], v[132:135], v[92:95], v[72:75]
    v_mfma_f32_16x16x32_bf16 v[88:91], v[132:135], v[96:99], v[88:91]
    v_mfma_f32_16x16x32_bf16 v[56:59], v[96:99], v[96:99], v[56:59]
    ds_read_b64_tr_b16 v[128:129], v30 offset:8192
    ds_read_b64_tr_b16 v[130:131], v30 offset:10240
    s_waitcnt lgkmcnt(12)
    v_mfma_f32_16x16x32_bf16 v[40:43], v[136:139], v[32:35], v[40:43]
    s_waitcnt vmcnt(8)
    s_barrier
    ds_read_b128 v[108:111], v14 offset:16384
    ds_read_b128 v[112:115], v14 offset:18432
    ds_read_b64_tr_b16 v[132:133], v21 offset:0
    ds_read_b64_tr_b16 v[134:135], v21 offset:2048
    s_waitcnt lgkmcnt(12)
    v_mfma_f32_16x16x32_bf16 v[60:63], v[140:143], v[100:103], v[60:63]
    v_mfma_f32_16x16x32_bf16 v[76:79], v[140:143], v[104:107], v[76:79]
    v_mfma_f32_16x16x32_bf16 v[44:47], v[32:35], v[100:103], v[44:47]
    s_mov_b32 s10, 1024
    s_add_u32 m0, s15, 131072
    s_nop 0
    buffer_load_dwordx4 v12, s[40:43], s10 offen lds
    ds_read_b64_tr_b16 v[136:137], v23 offset:0
    ds_read_b64_tr_b16 v[138:139], v23 offset:2048
    s_waitcnt lgkmcnt(12)
    v_mfma_f32_16x16x32_bf16 v[64:67], v[144:147], v[100:103], v[64:67]
    v_mfma_f32_16x16x32_bf16 v[80:83], v[144:147], v[104:107], v[80:83]
    v_mfma_f32_16x16x32_bf16 v[52:55], v[100:103], v[100:103], v[52:55]
    s_mov_b32 s10, 11264
    s_add_u32 m0, s15, 132096
    s_nop 0
    buffer_load_dwordx4 v12, s[40:43], s10 offen lds
    ds_read_b64_tr_b16 v[140:141], v25 offset:0
    ds_read_b64_tr_b16 v[142:143], v25 offset:2048
    s_waitcnt lgkmcnt(12)
    v_mfma_f32_16x16x32_bf16 v[68:71], v[148:151], v[100:103], v[68:71]
    v_mfma_f32_16x16x32_bf16 v[84:87], v[148:151], v[104:107], v[84:87]
    v_mfma_f32_16x16x32_bf16 v[48:51], v[32:35], v[104:107], v[48:51]
    s_mov_b32 s10, 1966080
    s_add_u32 m0, s8, 49152
    s_nop 0
    buffer_load_dwordx4 v19, s[44:47], s10 offen lds
    ds_read_b64_tr_b16 v[144:145], v27 offset:0
    ds_read_b64_tr_b16 v[146:147], v27 offset:2048
    s_waitcnt lgkmcnt(12)
    v_mfma_f32_16x16x32_bf16 v[72:75], v[152:155], v[100:103], v[72:75]
    v_mfma_f32_16x16x32_bf16 v[88:91], v[152:155], v[104:107], v[88:91]
    v_mfma_f32_16x16x32_bf16 v[56:59], v[104:107], v[104:107], v[56:59]
    s_mov_b32 s10, 1966080
    s_add_u32 m0, s8, 57344
    s_nop 0
    buffer_load_dwordx4 v20, s[44:47], s10 offen lds
    ds_read_b64_tr_b16 v[148:149], v29 offset:0
    ds_read_b64_tr_b16 v[150:151], v29 offset:2048
    s_waitcnt lgkmcnt(12)
    v_mfma_f32_16x16x32_bf16 v[40:43], v[128:131], v[32:35], v[40:43]
    ds_read_b128 v[116:119], v17 offset:16384
    ds_read_b128 v[120:123], v17 offset:18432
    ds_read_b64_tr_b16 v[152:153], v21 offset:8192
    ds_read_b64_tr_b16 v[154:155], v21 offset:10240
    s_waitcnt lgkmcnt(12)
    v_mfma_f32_16x16x32_bf16 v[60:63], v[132:135], v[108:111], v[60:63]
    v_mfma_f32_16x16x32_bf16 v[76:79], v[132:135], v[112:115], v[76:79]
    v_mfma_f32_16x16x32_bf16 v[44:47], v[32:35], v[108:111], v[44:47]
    ds_read_b64_tr_b16 v[128:129], v23 offset:8192
    ds_read_b64_tr_b16 v[130:131], v23 offset:10240
    s_waitcnt lgkmcnt(12)
    v_mfma_f32_16x16x32_bf16 v[64:67], v[136:139], v[108:111], v[64:67]
    v_mfma_f32_16x16x32_bf16 v[80:83], v[136:139], v[112:115], v[80:83]
    v_mfma_f32_16x16x32_bf16 v[52:55], v[108:111], v[108:111], v[52:55]
    ds_read_b64_tr_b16 v[132:133], v25 offset:8192
    ds_read_b64_tr_b16 v[134:135], v25 offset:10240
    s_waitcnt lgkmcnt(12)
    v_mfma_f32_16x16x32_bf16 v[68:71], v[140:143], v[108:111], v[68:71]
    v_mfma_f32_16x16x32_bf16 v[84:87], v[140:143], v[112:115], v[84:87]
    v_mfma_f32_16x16x32_bf16 v[48:51], v[32:35], v[112:115], v[48:51]
    ds_read_b64_tr_b16 v[136:137], v27 offset:8192
    ds_read_b64_tr_b16 v[138:139], v27 offset:10240
    s_waitcnt lgkmcnt(12)
    v_mfma_f32_16x16x32_bf16 v[72:75], v[144:147], v[108:111], v[72:75]
    v_mfma_f32_16x16x32_bf16 v[88:91], v[144:147], v[112:115], v[88:91]
    v_mfma_f32_16x16x32_bf16 v[56:59], v[112:115], v[112:115], v[56:59]
    ds_read_b64_tr_b16 v[140:141], v29 offset:8192
    ds_read_b64_tr_b16 v[142:143], v29 offset:10240
    s_waitcnt lgkmcnt(12)
    v_mfma_f32_16x16x32_bf16 v[40:43], v[148:151], v[32:35], v[40:43]
    s_waitcnt vmcnt(8)
    s_barrier
    ds_read_b128 v[92:95], v14 offset:32768
    ds_read_b128 v[96:99], v14 offset:34816
    ds_read_b64_tr_b16 v[144:145], v21 offset:16384
    ds_read_b64_tr_b16 v[146:147], v21 offset:18432
    s_waitcnt lgkmcnt(12)
    v_mfma_f32_16x16x32_bf16 v[60:63], v[152:155], v[116:119], v[60:63]
    v_mfma_f32_16x16x32_bf16 v[76:79], v[152:155], v[120:123], v[76:79]
    v_mfma_f32_16x16x32_bf16 v[44:47], v[32:35], v[116:119], v[44:47]
    s_mov_b32 s10, 1152
    s_add_u32 m0, s15, 147456
    s_nop 0
    buffer_load_dwordx4 v12, s[40:43], s10 offen lds
    ds_read_b64_tr_b16 v[148:149], v23 offset:16384
    ds_read_b64_tr_b16 v[150:151], v23 offset:18432
    s_waitcnt lgkmcnt(12)
    v_mfma_f32_16x16x32_bf16 v[64:67], v[128:131], v[116:119], v[64:67]
    v_mfma_f32_16x16x32_bf16 v[80:83], v[128:131], v[120:123], v[80:83]
    v_mfma_f32_16x16x32_bf16 v[52:55], v[116:119], v[116:119], v[52:55]
    s_mov_b32 s10, 11392
    s_add_u32 m0, s15, 148480
    s_nop 0
    buffer_load_dwordx4 v12, s[40:43], s10 offen lds
    ds_read_b64_tr_b16 v[152:153], v25 offset:16384
    ds_read_b64_tr_b16 v[154:155], v25 offset:18432
    s_waitcnt lgkmcnt(12)
    v_mfma_f32_16x16x32_bf16 v[68:71], v[132:135], v[116:119], v[68:71]
    v_mfma_f32_16x16x32_bf16 v[84:87], v[132:135], v[120:123], v[84:87]
    v_mfma_f32_16x16x32_bf16 v[48:51], v[32:35], v[120:123], v[48:51]
    s_mov_b32 s10, 2211840
    s_add_u32 m0, s8, 65536
    s_nop 0
    buffer_load_dwordx4 v19, s[44:47], s10 offen lds
    ds_read_b64_tr_b16 v[128:129], v27 offset:16384
    ds_read_b64_tr_b16 v[130:131], v27 offset:18432
    s_waitcnt lgkmcnt(12)
    v_mfma_f32_16x16x32_bf16 v[72:75], v[136:139], v[116:119], v[72:75]
    v_mfma_f32_16x16x32_bf16 v[88:91], v[136:139], v[120:123], v[88:91]
    v_mfma_f32_16x16x32_bf16 v[56:59], v[120:123], v[120:123], v[56:59]
    s_mov_b32 s10, 2211840
    s_add_u32 m0, s8, 73728
    s_nop 0
    buffer_load_dwordx4 v20, s[44:47], s10 offen lds
    ds_read_b64_tr_b16 v[132:133], v29 offset:16384
    ds_read_b64_tr_b16 v[134:135], v29 offset:18432
    s_waitcnt lgkmcnt(12)
    v_mfma_f32_16x16x32_bf16 v[40:43], v[140:143], v[32:35], v[40:43]
    ds_read_b128 v[100:103], v17 offset:32768
    ds_read_b128 v[104:107], v17 offset:34816
    ds_read_b64_tr_b16 v[136:137], v21 offset:24576
    ds_read_b64_tr_b16 v[138:139], v21 offset:26624
    s_waitcnt lgkmcnt(12)
    v_mfma_f32_16x16x32_bf16 v[60:63], v[144:147], v[92:95], v[60:63]
    v_mfma_f32_16x16x32_bf16 v[76:79], v[144:147], v[96:99], v[76:79]
    v_mfma_f32_16x16x32_bf16 v[44:47], v[32:35], v[92:95], v[44:47]
    ds_read_b64_tr_b16 v[140:141], v23 offset:24576
    ds_read_b64_tr_b16 v[142:143], v23 offset:26624
    s_waitcnt lgkmcnt(12)
    v_mfma_f32_16x16x32_bf16 v[64:67], v[148:151], v[92:95], v[64:67]
    v_mfma_f32_16x16x32_bf16 v[80:83], v[148:151], v[96:99], v[80:83]
    v_mfma_f32_16x16x32_bf16 v[52:55], v[92:95], v[92:95], v[52:55]
    ds_read_b64_tr_b16 v[144:145], v25 offset:24576
    ds_read_b64_tr_b16 v[146:147], v25 offset:26624
    s_waitcnt lgkmcnt(12)
    v_mfma_f32_16x16x32_bf16 v[68:71], v[152:155], v[92:95], v[68:71]
    v_mfma_f32_16x16x32_bf16 v[84:87], v[152:155], v[96:99], v[84:87]
    v_mfma_f32_16x16x32_bf16 v[48:51], v[32:35], v[96:99], v[48:51]
    ds_read_b64_tr_b16 v[148:149], v27 offset:24576
    ds_read_b64_tr_b16 v[150:151], v27 offset:26624
    s_waitcnt lgkmcnt(12)
    v_mfma_f32_16x16x32_bf16 v[72:75], v[128:131], v[92:95], v[72:75]
    v_mfma_f32_16x16x32_bf16 v[88:91], v[128:131], v[96:99], v[88:91]
    v_mfma_f32_16x16x32_bf16 v[56:59], v[96:99], v[96:99], v[56:59]
    ds_read_b64_tr_b16 v[152:153], v29 offset:24576
    ds_read_b64_tr_b16 v[154:155], v29 offset:26624
    s_waitcnt lgkmcnt(12)
    v_mfma_f32_16x16x32_bf16 v[40:43], v[132:135], v[32:35], v[40:43]
    s_waitcnt vmcnt(8)
    s_barrier
    ds_read_b128 v[108:111], v14 offset:49152
    ds_read_b128 v[112:115], v14 offset:51200
    ds_read_b64_tr_b16 v[128:129], v21 offset:32768
    ds_read_b64_tr_b16 v[130:131], v21 offset:34816
    s_waitcnt lgkmcnt(12)
    v_mfma_f32_16x16x32_bf16 v[60:63], v[136:139], v[100:103], v[60:63]
    v_mfma_f32_16x16x32_bf16 v[76:79], v[136:139], v[104:107], v[76:79]
    v_mfma_f32_16x16x32_bf16 v[44:47], v[32:35], v[100:103], v[44:47]
    s_mov_b32 s96, s20
    s_and_b32 s97, s21, 0xffff
    s_mov_b32 s98, 819200
    s_mov_b32 s99, 0x00020000
    s_lshr_b32 s10, s2, 3
    s_mul_i32 s10, s10, 25600
    s_add_u32 s10, s10, 0
    buffer_load_dword v124, v125, s[96:99], s10 offen
    ds_read_b64_tr_b16 v[132:133], v23 offset:32768
    ds_read_b64_tr_b16 v[134:135], v23 offset:34816
    s_waitcnt lgkmcnt(12)
    v_mfma_f32_16x16x32_bf16 v[64:67], v[140:143], v[100:103], v[64:67]
    v_mfma_f32_16x16x32_bf16 v[80:83], v[140:143], v[104:107], v[80:83]
    v_mfma_f32_16x16x32_bf16 v[52:55], v[100:103], v[100:103], v[52:55]
    ds_read_b64_tr_b16 v[136:137], v25 offset:32768
    ds_read_b64_tr_b16 v[138:139], v25 offset:34816
    s_waitcnt lgkmcnt(12)
    v_mfma_f32_16x16x32_bf16 v[68:71], v[144:147], v[100:103], v[68:71]
    v_mfma_f32_16x16x32_bf16 v[84:87], v[144:147], v[104:107], v[84:87]
    v_mfma_f32_16x16x32_bf16 v[48:51], v[32:35], v[104:107], v[48:51]
    ds_read_b64_tr_b16 v[140:141], v27 offset:32768
    ds_read_b64_tr_b16 v[142:143], v27 offset:34816
    s_waitcnt lgkmcnt(12)
    v_mfma_f32_16x16x32_bf16 v[72:75], v[148:151], v[100:103], v[72:75]
    v_mfma_f32_16x16x32_bf16 v[88:91], v[148:151], v[104:107], v[88:91]
    v_mfma_f32_16x16x32_bf16 v[56:59], v[104:107], v[104:107], v[56:59]
    ds_read_b64_tr_b16 v[144:145], v29 offset:32768
    ds_read_b64_tr_b16 v[146:147], v29 offset:34816
    s_waitcnt lgkmcnt(12)
    v_mfma_f32_16x16x32_bf16 v[40:43], v[152:155], v[32:35], v[40:43]
    ds_read_b128 v[116:119], v17 offset:49152
    ds_read_b128 v[120:123], v17 offset:51200
    ds_read_b64_tr_b16 v[148:149], v21 offset:40960
    ds_read_b64_tr_b16 v[150:151], v21 offset:43008
    s_waitcnt lgkmcnt(12)
    v_mfma_f32_16x16x32_bf16 v[60:63], v[128:131], v[108:111], v[60:63]
    v_mfma_f32_16x16x32_bf16 v[76:79], v[128:131], v[112:115], v[76:79]
    v_mfma_f32_16x16x32_bf16 v[44:47], v[32:35], v[108:111], v[44:47]
    ds_read_b64_tr_b16 v[152:153], v23 offset:40960
    ds_read_b64_tr_b16 v[154:155], v23 offset:43008
    s_waitcnt lgkmcnt(12)
    v_mfma_f32_16x16x32_bf16 v[64:67], v[132:135], v[108:111], v[64:67]
    v_mfma_f32_16x16x32_bf16 v[80:83], v[132:135], v[112:115], v[80:83]
    v_mfma_f32_16x16x32_bf16 v[52:55], v[108:111], v[108:111], v[52:55]
    ds_read_b64_tr_b16 v[128:129], v25 offset:40960
    ds_read_b64_tr_b16 v[130:131], v25 offset:43008
    s_waitcnt lgkmcnt(12)
    v_mfma_f32_16x16x32_bf16 v[68:71], v[136:139], v[108:111], v[68:71]
    v_mfma_f32_16x16x32_bf16 v[84:87], v[136:139], v[112:115], v[84:87]
    v_mfma_f32_16x16x32_bf16 v[48:51], v[32:35], v[112:115], v[48:51]
    ds_read_b64_tr_b16 v[132:133], v27 offset:40960
    ds_read_b64_tr_b16 v[134:135], v27 offset:43008
    s_waitcnt lgkmcnt(12)
    v_mfma_f32_16x16x32_bf16 v[72:75], v[140:143], v[108:111], v[72:75]
    v_mfma_f32_16x16x32_bf16 v[88:91], v[140:143], v[112:115], v[88:91]
    v_mfma_f32_16x16x32_bf16 v[56:59], v[112:115], v[112:115], v[56:59]
    ds_read_b64_tr_b16 v[136:137], v29 offset:40960
    ds_read_b64_tr_b16 v[138:139], v29 offset:43008
    s_waitcnt lgkmcnt(12)
    v_mfma_f32_16x16x32_bf16 v[40:43], v[144:147], v[32:35], v[40:43]
    s_waitcnt vmcnt(5)
    s_barrier
    ds_read_b128 v[92:95], v15 offset:0
    ds_read_b128 v[96:99], v15 offset:2048
    ds_read_b64_tr_b16 v[140:141], v21 offset:49152
    ds_read_b64_tr_b16 v[142:143], v21 offset:51200
    s_waitcnt lgkmcnt(12)
    v_mfma_f32_16x16x32_bf16 v[60:63], v[148:151], v[116:119], v[60:63]
    v_mfma_f32_16x16x32_bf16 v[76:79], v[148:151], v[120:123], v[76:79]
    v_mfma_f32_16x16x32_bf16 v[44:47], v[32:35], v[116:119], v[44:47]
    ds_read_b64_tr_b16 v[144:145], v23 offset:49152
    ds_read_b64_tr_b16 v[146:147], v23 offset:51200
    s_waitcnt lgkmcnt(12)
    v_mfma_f32_16x16x32_bf16 v[64:67], v[152:155], v[116:119], v[64:67]
    v_mfma_f32_16x16x32_bf16 v[80:83], v[152:155], v[120:123], v[80:83]
    v_mfma_f32_16x16x32_bf16 v[52:55], v[116:119], v[116:119], v[52:55]
    ds_read_b64_tr_b16 v[148:149], v25 offset:49152
    ds_read_b64_tr_b16 v[150:151], v25 offset:51200
    s_waitcnt lgkmcnt(12)
    v_mfma_f32_16x16x32_bf16 v[68:71], v[128:131], v[116:119], v[68:71]
    v_mfma_f32_16x16x32_bf16 v[84:87], v[128:131], v[120:123], v[84:87]
    v_mfma_f32_16x16x32_bf16 v[48:51], v[32:35], v[120:123], v[48:51]
    ds_read_b64_tr_b16 v[152:153], v27 offset:49152
    ds_read_b64_tr_b16 v[154:155], v27 offset:51200
    s_waitcnt lgkmcnt(12)
    v_mfma_f32_16x16x32_bf16 v[72:75], v[132:135], v[116:119], v[72:75]
    v_mfma_f32_16x16x32_bf16 v[88:91], v[132:135], v[120:123], v[88:91]
    v_mfma_f32_16x16x32_bf16 v[56:59], v[120:123], v[120:123], v[56:59]
    ds_read_b64_tr_b16 v[128:129], v29 offset:49152
    ds_read_b64_tr_b16 v[130:131], v29 offset:51200
    s_waitcnt lgkmcnt(12)
    v_mfma_f32_16x16x32_bf16 v[40:43], v[136:139], v[32:35], v[40:43]
    ds_read_b128 v[100:103], v18 offset:0
    ds_read_b128 v[104:107], v18 offset:2048
    ds_read_b64_tr_b16 v[132:133], v21 offset:57344
    ds_read_b64_tr_b16 v[134:135], v21 offset:59392
    s_waitcnt lgkmcnt(12)
    v_mfma_f32_16x16x32_bf16 v[60:63], v[140:143], v[92:95], v[60:63]
    v_mfma_f32_16x16x32_bf16 v[76:79], v[140:143], v[96:99], v[76:79]
    v_mfma_f32_16x16x32_bf16 v[44:47], v[32:35], v[92:95], v[44:47]
    ds_read_b64_tr_b16 v[136:137], v23 offset:57344
    ds_read_b64_tr_b16 v[138:139], v23 offset:59392
    s_waitcnt lgkmcnt(12)
    v_mfma_f32_16x16x32_bf16 v[64:67], v[144:147], v[92:95], v[64:67]
    v_mfma_f32_16x16x32_bf16 v[80:83], v[144:147], v[96:99], v[80:83]
    v_mfma_f32_16x16x32_bf16 v[52:55], v[92:95], v[92:95], v[52:55]
    ds_read_b64_tr_b16 v[140:141], v25 offset:57344
    ds_read_b64_tr_b16 v[142:143], v25 offset:59392
    s_waitcnt lgkmcnt(12)
    v_mfma_f32_16x16x32_bf16 v[68:71], v[148:151], v[92:95], v[68:71]
    v_mfma_f32_16x16x32_bf16 v[84:87], v[148:151], v[96:99], v[84:87]
    v_mfma_f32_16x16x32_bf16 v[48:51], v[32:35], v[96:99], v[48:51]
    ds_read_b64_tr_b16 v[144:145], v27 offset:57344
    ds_read_b64_tr_b16 v[146:147], v27 offset:59392
    s_waitcnt lgkmcnt(12)
    v_mfma_f32_16x16x32_bf16 v[72:75], v[152:155], v[92:95], v[72:75]
    v_mfma_f32_16x16x32_bf16 v[88:91], v[152:155], v[96:99], v[88:91]
    v_mfma_f32_16x16x32_bf16 v[56:59], v[96:99], v[96:99], v[56:59]
    ds_read_b64_tr_b16 v[148:149], v29 offset:57344
    ds_read_b64_tr_b16 v[150:151], v29 offset:59392
    s_waitcnt lgkmcnt(12)
    v_mfma_f32_16x16x32_bf16 v[40:43], v[128:131], v[32:35], v[40:43]
    s_waitcnt vmcnt(1)
    s_barrier
    ds_read_b128 v[108:111], v15 offset:16384
    ds_read_b128 v[112:115], v15 offset:18432
    ds_read_b64_tr_b16 v[152:153], v22 offset:0
    ds_read_b64_tr_b16 v[154:155], v22 offset:2048
    s_waitcnt lgkmcnt(12)
    v_mfma_f32_16x16x32_bf16 v[60:63], v[132:135], v[100:103], v[60:63]
    v_mfma_f32_16x16x32_bf16 v[76:79], v[132:135], v[104:107], v[76:79]
    v_mfma_f32_16x16x32_bf16 v[44:47], v[32:35], v[100:103], v[44:47]
    ds_read_b64_tr_b16 v[128:129], v24 offset:0
    ds_read_b64_tr_b16 v[130:131], v24 offset:2048
    s_waitcnt lgkmcnt(12)
    v_mfma_f32_16x16x32_bf16 v[64:67], v[136:139], v[100:103], v[64:67]
    v_mfma_f32_16x16x32_bf16 v[80:83], v[136:139], v[104:107], v[80:83]
    v_mfma_f32_16x16x32_bf16 v[52:55], v[100:103], v[100:103], v[52:55]
    ds_read_b64_tr_b16 v[132:133], v26 offset:0
    ds_read_b64_tr_b16 v[134:135], v26 offset:2048
    s_waitcnt lgkmcnt(12)
    v_mfma_f32_16x16x32_bf16 v[68:71], v[140:143], v[100:103], v[68:71]
    v_mfma_f32_16x16x32_bf16 v[84:87], v[140:143], v[104:107], v[84:87]
    v_mfma_f32_16x16x32_bf16 v[48:51], v[32:35], v[104:107], v[48:51]
    ds_read_b64_tr_b16 v[136:137], v28 offset:0
    ds_read_b64_tr_b16 v[138:139], v28 offset:2048
    s_waitcnt lgkmcnt(12)
    v_mfma_f32_16x16x32_bf16 v[72:75], v[144:147], v[100:103], v[72:75]
    v_mfma_f32_16x16x32_bf16 v[88:91], v[144:147], v[104:107], v[88:91]
    v_mfma_f32_16x16x32_bf16 v[56:59], v[104:107], v[104:107], v[56:59]
    ds_read_b64_tr_b16 v[140:141], v30 offset:0
    ds_read_b64_tr_b16 v[142:143], v30 offset:2048
    s_waitcnt lgkmcnt(12)
    v_mfma_f32_16x16x32_bf16 v[40:43], v[148:151], v[32:35], v[40:43]
    ds_read_b128 v[116:119], v18 offset:16384
    ds_read_b128 v[120:123], v18 offset:18432
    ds_read_b64_tr_b16 v[144:145], v22 offset:8192
    ds_read_b64_tr_b16 v[146:147], v22 offset:10240
    s_waitcnt lgkmcnt(12)
    v_mfma_f32_16x16x32_bf16 v[60:63], v[152:155], v[108:111], v[60:63]
    v_mfma_f32_16x16x32_bf16 v[76:79], v[152:155], v[112:115], v[76:79]
    v_mfma_f32_16x16x32_bf16 v[44:47], v[32:35], v[108:111], v[44:47]
    ds_read_b64_tr_b16 v[148:149], v24 offset:8192
    ds_read_b64_tr_b16 v[150:151], v24 offset:10240
    s_waitcnt lgkmcnt(12)
    v_mfma_f32_16x16x32_bf16 v[64:67], v[128:131], v[108:111], v[64:67]
    v_mfma_f32_16x16x32_bf16 v[80:83], v[128:131], v[112:115], v[80:83]
    v_mfma_f32_16x16x32_bf16 v[52:55], v[108:111], v[108:111], v[52:55]
    ds_read_b64_tr_b16 v[152:153], v26 offset:8192
    ds_read_b64_tr_b16 v[154:155], v26 offset:10240
    s_waitcnt lgkmcnt(12)
    v_mfma_f32_16x16x32_bf16 v[68:71], v[132:135], v[108:111], v[68:71]
    v_mfma_f32_16x16x32_bf16 v[84:87], v[132:135], v[112:115], v[84:87]
    v_mfma_f32_16x16x32_bf16 v[48:51], v[32:35], v[112:115], v[48:51]
    ds_read_b64_tr_b16 v[128:129], v28 offset:8192
    ds_read_b64_tr_b16 v[130:131], v28 offset:10240
    s_waitcnt lgkmcnt(12)
    v_mfma_f32_16x16x32_bf16 v[72:75], v[136:139], v[108:111], v[72:75]
    v_mfma_f32_16x16x32_bf16 v[88:91], v[136:139], v[112:115], v[88:91]
    v_mfma_f32_16x16x32_bf16 v[56:59], v[112:115], v[112:115], v[56:59]
    ds_read_b64_tr_b16 v[132:133], v30 offset:8192
    ds_read_b64_tr_b16 v[134:135], v30 offset:10240
    s_waitcnt lgkmcnt(12)
    v_mfma_f32_16x16x32_bf16 v[40:43], v[140:143], v[32:35], v[40:43]
    s_waitcnt lgkmcnt(8)
    v_mfma_f32_16x16x32_bf16 v[60:63], v[144:147], v[116:119], v[60:63]
    v_mfma_f32_16x16x32_bf16 v[76:79], v[144:147], v[120:123], v[76:79]
    v_mfma_f32_16x16x32_bf16 v[44:47], v[32:35], v[116:119], v[44:47]
    s_waitcnt lgkmcnt(6)
    v_mfma_f32_16x16x32_bf16 v[64:67], v[148:151], v[116:119], v[64:67]
    v_mfma_f32_16x16x32_bf16 v[80:83], v[148:151], v[120:123], v[80:83]
    v_mfma_f32_16x16x32_bf16 v[52:55], v[116:119], v[116:119], v[52:55]
    s_waitcnt lgkmcnt(4)
    v_mfma_f32_16x16x32_bf16 v[68:71], v[152:155], v[116:119], v[68:71]
    v_mfma_f32_16x16x32_bf16 v[84:87], v[152:155], v[120:123], v[84:87]
    v_mfma_f32_16x16x32_bf16 v[48:51], v[32:35], v[120:123], v[48:51]
    s_waitcnt lgkmcnt(2)
    v_mfma_f32_16x16x32_bf16 v[72:75], v[128:131], v[116:119], v[72:75]
    v_mfma_f32_16x16x32_bf16 v[88:91], v[128:131], v[120:123], v[88:91]
    v_mfma_f32_16x16x32_bf16 v[56:59], v[120:123], v[120:123], v[56:59]
    s_waitcnt lgkmcnt(0)
    v_mfma_f32_16x16x32_bf16 v[40:43], v[132:135], v[32:35], v[40:43]
    s_nop 7
    s_nop 1
    s_barrier
    v_lshlrev_b32 v8, 4, v4
    s_add_u32 s9, s7, 0
    s_min_u32 s9, s9, 7
    s_lshl_b32 s9, s9, 6
    v_add_u32 v9, s9, v8
    ds_write_b128 v9, v[40:43]
    v_mov_b32 v36, v44
    v_and_b32 v10, 3, v3
    v_mov_b32 v11, v52
    v_cmp_eq_u32 vcc, 1, v10
    s_nop 1
    v_cndmask_b32 v11, v11, v53, vcc
    v_cmp_eq_u32 vcc, 2, v10
    s_nop 1
    v_cndmask_b32 v11, v11, v54, vcc
    v_cmp_eq_u32 vcc, 3, v10
    s_nop 1
    v_cndmask_b32 v11, v11, v55, vcc
    v_lshrrev_b32 v10, 2, v3
    v_lshl_add_u32 v10, v10, 4, v3
    v_lshlrev_b32 v10, 2, v10
    ds_bpermute_b32 v38, v10, v11
    v_mov_b32 v37, v48
    v_and_b32 v10, 3, v3
    v_mov_b32 v11, v56
    v_cmp_eq_u32 vcc, 1, v10
    s_nop 1
    v_cndmask_b32 v11, v11, v57, vcc
    v_cmp_eq_u32 vcc, 2, v10
    s_nop 1
    v_cndmask_b32 v11, v11, v58, vcc
    v_cmp_eq_u32 vcc, 3, v10
    s_nop 1
    v_cndmask_b32 v11, v11, v59, vcc
    v_lshrrev_b32 v10, 2, v3
    v_lshl_add_u32 v10, v10, 4, v3
    v_lshlrev_b32 v10, 2, v10
    ds_bpermute_b32 v39, v10, v11
    s_waitcnt lgkmcnt(0)
    s_barrier
    s_lshl_b32 s9, s13, 6
    v_add_u32 v8, s9, v8
    ds_read_b128 v[128:131], v8 offset:0
    ds_read_b128 v[132:135], v8 offset:64
    ds_read_b128 v[136:139], v8 offset:128
    ds_read_b128 v[140:143], v8 offset:192
    s_mov_b32 s9, 0x3acccccd
    v_mul_f32 v36, s9, v36
    v_mul_f32 v38, s9, v38
    v_fma_f32 v38, -v36, v36, v38
    v_max_f32 v38, 0, v38
    s_mov_b32 s9, 0x3727c5ac
    v_cvt_pk_bf16_f32 v156, v36, v36
    v_lshlrev_b32 v156, 16, v156
    v_cvt_pk_bf16_f32 v157, v38, v38
    v_lshlrev_b32 v157, 16, v157
    v_add_f32 v157, s9, v157
    v_cvt_pk_bf16_f32 v157, v157, v157
    v_lshlrev_b32 v157, 16, v157
    v_sqrt_f32 v157, v157
    s_nop 0
    v_cvt_pk_bf16_f32 v157, v157, v157
    v_lshlrev_b32 v157, 16, v157
    v_rcp_f32 v158, v157
    s_nop 0
    v_mul_f32 v159, v156, v158
    v_sub_f32 v159, 0, v159
    s_mov_b32 s9, 0x3acccccd
    v_mul_f32 v37, s9, v37
    v_mul_f32 v39, s9, v39
    v_fma_f32 v39, -v37, v37, v39
    v_max_f32 v39, 0, v39
    s_mov_b32 s9, 0x3727c5ac
    v_cvt_pk_bf16_f32 v160, v37, v37
    v_lshlrev_b32 v160, 16, v160
    v_cvt_pk_bf16_f32 v161, v39, v39
    v_lshlrev_b32 v161, 16, v161
    v_add_f32 v161, s9, v161
    v_cvt_pk_bf16_f32 v161, v161, v161
    v_lshlrev_b32 v161, 16, v161
    v_sqrt_f32 v161, v161
    s_nop 0
    v_cvt_pk_bf16_f32 v161, v161, v161
    v_lshlrev_b32 v161, 16, v161
    v_rcp_f32 v162, v161
    s_nop 0
    v_mul_f32 v163, v160, v162
    v_sub_f32 v163, 0, v163
    s_waitcnt lgkmcnt(0)
    v_mov_b32 v8, v158
    v_mov_b32 v9, v158
    v_mov_b32 v10, v159
    v_mov_b32 v11, v159
    v_pk_mul_f32 v[60:61], v[60:61], v[8:9]
    v_pk_fma_f32 v[60:61], v[128:129], v[10:11], v[60:61]
    v_pk_mul_f32 v[62:63], v[62:63], v[8:9]
    v_pk_fma_f32 v[62:63], v[130:131], v[10:11], v[62:63]
    v_pk_mul_f32 v[64:65], v[64:65], v[8:9]
    v_pk_fma_f32 v[64:65], v[132:133], v[10:11], v[64:65]
    v_pk_mul_f32 v[66:67], v[66:67], v[8:9]
    v_pk_fma_f32 v[66:67], v[134:135], v[10:11], v[66:67]
    v_pk_mul_f32 v[68:69], v[68:69], v[8:9]
    v_pk_fma_f32 v[68:69], v[136:137], v[10:11], v[68:69]
    v_pk_mul_f32 v[70:71], v[70:71], v[8:9]
    v_pk_fma_f32 v[70:71], v[138:139], v[10:11], v[70:71]
    v_pk_mul_f32 v[72:73], v[72:73], v[8:9]
    v_pk_fma_f32 v[72:73], v[140:141], v[10:11], v[72:73]
    v_pk_mul_f32 v[74:75], v[74:75], v[8:9]
    v_pk_fma_f32 v[74:75], v[142:143], v[10:11], v[74:75]
    v_mov_b32 v8, v162
    v_mov_b32 v9, v162
    v_mov_b32 v10, v163
    v_mov_b32 v11, v163
    v_pk_mul_f32 v[76:77], v[76:77], v[8:9]
    v_pk_fma_f32 v[76:77], v[128:129], v[10:11], v[76:77]
    v_pk_mul_f32 v[78:79], v[78:79], v[8:9]
    v_pk_fma_f32 v[78:79], v[130:131], v[10:11], v[78:79]
    v_pk_mul_f32 v[80:81], v[80:81], v[8:9]
    v_pk_fma_f32 v[80:81], v[132:133], v[10:11], v[80:81]
    v_pk_mul_f32 v[82:83], v[82:83], v[8:9]
    v_pk_fma_f32 v[82:83], v[134:135], v[10:11], v[82:83]
    v_pk_mul_f32 v[84:85], v[84:85], v[8:9]
    v_pk_fma_f32 v[84:85], v[136:137], v[10:11], v[84:85]
    v_pk_mul_f32 v[86:87], v[86:87], v[8:9]
    v_pk_fma_f32 v[86:87], v[138:139], v[10:11], v[86:87]
    v_pk_mul_f32 v[88:89], v[88:89], v[8:9]
    v_pk_fma_f32 v[88:89], v[140:141], v[10:11], v[88:89]
    v_pk_mul_f32 v[90:91], v[90:91], v[8:9]
    v_pk_fma_f32 v[90:91], v[142:143], v[10:11], v[90:91]
    v_cvt_pk_bf16_f32 v60, v60, v61
    v_cvt_pk_bf16_f32 v61, v62, v63
    buffer_store_dwordx2 v[60:61], v126, s[48:51], 0 offen offset:0
    v_cvt_pk_bf16_f32 v64, v64, v65
    v_cvt_pk_bf16_f32 v65, v66, v67
    buffer_store_dwordx2 v[64:65], v126, s[48:51], 0 offen offset:512
    v_cvt_pk_bf16_f32 v68, v68, v69
    v_cvt_pk_bf16_f32 v69, v70, v71
    buffer_store_dwordx2 v[68:69], v126, s[48:51], 0 offen offset:1024
    v_cvt_pk_bf16_f32 v72, v72, v73
    v_cvt_pk_bf16_f32 v73, v74, v75
    buffer_store_dwordx2 v[72:73], v126, s[48:51], 0 offen offset:1536
    v_cvt_pk_bf16_f32 v76, v76, v77
    v_cvt_pk_bf16_f32 v77, v78, v79
    buffer_store_dwordx2 v[76:77], v127, s[48:51], 0 offen offset:0
    v_cvt_pk_bf16_f32 v80, v80, v81
    v_cvt_pk_bf16_f32 v81, v82, v83
    buffer_store_dwordx2 v[80:81], v127, s[48:51], 0 offen offset:512
    v_cvt_pk_bf16_f32 v84, v84, v85
    v_cvt_pk_bf16_f32 v85, v86, v87
    buffer_store_dwordx2 v[84:85], v127, s[48:51], 0 offen offset:1024
    v_cvt_pk_bf16_f32 v88, v88, v89
    v_cvt_pk_bf16_f32 v89, v90, v91
    buffer_store_dwordx2 v[88:89], v127, s[48:51], 0 offen offset:1536
k1_qkv_kernel_end:
    s_endpgm
.globl k2_attn_kernel
.p2align 8
.type k2_attn_kernel,@function
k2_attn_kernel:
    s_cmp_ge_u32 s2, 256
    s_cbranch_scc1 k2_attn_kernel_end
    s_load_dwordx16 s[16:31], s[0:1], 0
    s_load_dwordx4 s[32:35], s[0:1], 64
    s_load_dwordx2 s[36:37], s[0:1], 80
    s_and_b32 s4, s2, 7
    s_lshr_b32 s3, s2, 3
    s_lshl_b32 s4, s4, 2
    s_and_b32 s5, s3, 3
    s_add_u32 s4, s4, s5
    s_lshr_b32 s3, s3, 2
    s_lshl_b32 s5, s3, 8
    v_lshrrev_b32 v1, 6, v0
    v_and_b32 v2, 63, v0
    v_and_b32 v3, 15, v0
    v_bfe_u32 v4, v0, 4, 2
    s_nop 0
    v_readfirstlane_b32 s7, v1
    s_lshl_b32 s8, s7, 10
    s_mul_i32 s6, s4, 20
    s_lshr_b32 s6, s6, 3
    s_lshl_b32 s6, s6, 8
    s_and_b32 s66, s4, 1
    s_sub_u32 s9, s5, 256
    s_mov_b32 s12, 0x80000000
    v_add_u32 v6, s9, v0
    v_ashrrev_i32 v7, 4, v6
    v_mul_i32_i24 v7, 61440, v7
    v_lshl_add_u32 v7, v3, 4, v7
    v_cmp_gt_i32 vcc, 0, v6
    v_mov_b32 v8, s12
    s_nop 1
    v_cndmask_b32 v7, v7, v8, vcc
    s_waitcnt lgkmcnt(0)
    s_mov_b32 s40, s36
    s_mov_b32 s41, s37
    s_and_b32 s41, s41, 0xffff
    s_mov_b32 s42, 7864320
    s_mov_b32 s43, 0x00020000
    s_add_u32 s52, s36, 8388608
    s_addc_u32 s53, s37, 0
    s_and_b32 s53, s53, 0xffff
    s_mov_b32 s54, 2621440
    s_mov_b32 s55, 0x00020000
    s_cmp_ge_u32 s2, 32
    s_cbranch_scc1 k2_attn_kernel_nz
    s_add_u32 s56, s36, 28835840
    s_addc_u32 s57, s37, 0
    s_and_b32 s57, s57, 0xffff
    s_mov_b32 s58, 8192
    s_mov_b32 s59, 0x00020000
    s_lshl_b32 s10, s2, 8
    v_mov_b32 v5, 0
    buffer_store_dword v5, v5, s[56:59], s10 offen
k2_attn_kernel_nz:
    s_add_u32 s10, s6, 20480
    s_add_u32 m0, s8, 0
    s_nop 0
    buffer_load_dwordx4 v7, s[40:43], s10 offen lds
    s_add_u32 s10, s6, 20736
    s_add_u32 m0, s8, 8192
    s_nop 0
    buffer_load_dwordx4 v7, s[40:43], s10 offen lds
    s_add_u32 s10, s6, 20992
    s_add_u32 m0, s8, 16384
    s_nop 0
    buffer_load_dwordx4 v7, s[40:43], s10 offen lds
    s_add_u32 s10, s6, 40960
    s_add_u32 m0, s8, 32768
    s_nop 0
    buffer_load_dwordx4 v7, s[40:43], s10 offen lds
    s_add_u32 s10, s6, 41216
    s_add_u32 m0, s8, 41088
    s_nop 0
    buffer_load_dwordx4 v7, s[40:43], s10 offen lds
    s_add_u32 s10, s6, 41472
    s_add_u32 m0, s8, 49408
    s_nop 0
    buffer_load_dwordx4 v7, s[40:43], s10 offen lds
    v_mov_b32 v12, 0
    v_mov_b32 v8, 0xf149
    v_cndmask_b32 v12, v12, v8, vcc
    v_mov_b32 v13, 0
    v_mov_b32 v14, 0
    v_mov_b32 v15, 0
    v_lshlrev_b32 v5, 4, v0
    ds_write_b128 v5, v[12:15] offset:24576
    v_mov_b32 v12, 0x3f80
    ds_write_b128 v5, v[12:15] offset:57728
    v_lshl_add_u32 v24, v1, 5, v3
    v_add_u32 v24, s5, v24
    v_lshrrev_b32 v5, 4, v24
    v_mul_u32_u24 v5, 61440, v5
    v_lshl_add_u32 v5, v3, 4, v5
    v_lshl_add_u32 v5, v4, 8, v5
    v_mov_b32 v8, s12
    v_cmp_gt_u32 vcc, 3, v4
    s_nop 1
    v_cndmask_b32 v6, v8, v5, vcc
    s_add_u32 s10, s6, 0
    buffer_load_dwordx4 v[16:19], v6, s[40:43], s10 offen
    s_add_u32 s10, s6, 61440
    buffer_load_dwordx4 v[20:23], v6, s[40:43], s10 offen
    v_mov_b32 v8, 0xf149f2ca
    v_lshlrev_b32 v5, 2, v4
    v_add_u32 v6, 0, v5
    v_cmp_gt_u32 vcc, v6, v3
    s_nop 1
    v_cndmask_b32 v28, v8, 0, vcc
    v_cndmask_b32 v32, 0, v8, vcc
    v_add_u32 v6, 1, v5
    v_cmp_gt_u32 vcc, v6, v3
    s_nop 1
    v_cndmask_b32 v29, v8, 0, vcc
    v_cndmask_b32 v33, 0, v8, vcc
    v_add_u32 v6, 2, v5
    v_cmp_gt_u32 vcc, v6, v3
    s_nop 1
    v_cndmask_b32 v30, v8, 0, vcc
    v_cndmask_b32 v34, 0, v8, vcc
    v_add_u32 v6, 3, v5
    v_cmp_gt_u32 vcc, v6, v3
    s_nop 1
    v_cndmask_b32 v31, v8, 0, vcc
    v_cndmask_b32 v35, 0, v8, vcc
    v_lshlrev_b32 v5, 4, v3
    v_lshl_add_u32 v5, v1, 9, v5
    v_mul_u32_u24 v6, 8192, v4
    v_add_u32 v36, v5, v6
    v_bfe_u32 v5, v0, 2, 2
    v_lshl_add_u32 v5, v4, 2, v5
    v_lshl_add_u32 v5, v1, 5, v5
    v_lshlrev_b32 v5, 4, v5
    v_add_u32 v5, 32768, v5
    v_and_b32 v6, 3, v0
    v_add_u32 v7, s66, v6
    v_lshrrev_b32 v8, 1, v7
    v_mul_u32_u24 v8, 8320, v8
    v_and_b32 v7, 1, v7
    v_lshl_add_u32 v8, v7, 3, v8
    v_add_u32 v37, v5, v8
    s_lshl_b32 s67, s66, 3
    s_add_u32 s67, s67, 16640
    v_add_u32 v38, s67, v5
    v_cmp_eq_u32 vcc, 1, v6
    v_add_u32 v8, 24960, v5
    s_nop 0
    v_cndmask_b32 v38, v38, v8, vcc
    v_mov_b32 v40, 0x3e64f92e
    v_mov_b32 v41, 0x3e64f92e
    s_mov_b32 s13, 0x3ea52b5c
    s_waitcnt vmcnt(0) lgkmcnt(0)
    v_cmp_eq_u32 vcc, 3, v4
    v_mov_b32 v8, 0x3f80
    s_nop 0
    v_cndmask_b32 v16, v16, v8, vcc
    v_cndmask_b32 v20, v20, v8, vcc
    s_lshl_b32 s10, s66, 1
    s_sub_u32 s10, 2, s10
    v_cmp_eq_u32 vcc, s10, v4
    s_cmp_eq_u32 s66, 0
    s_cbranch_scc1 k2_attn_kernel_even
    v_cndmask_b32 v16, v16, 0, vcc
    v_cndmask_b32 v17, v17, 0, vcc
    v_cndmask_b32 v20, v20, 0, vcc
    v_cndmask_b32 v21, v21, 0, vcc
    s_branch k2_attn_kernel_qdone
k2_attn_kernel_even:
    v_cndmask_b32 v18, v18, 0, vcc
    v_cndmask_b32 v19, v19, 0, vcc
    v_cndmask_b32 v22, v22, 0, vcc
    v_cndmask_b32 v23, v23, 0, vcc
k2_attn_kernel_qdone:
    s_barrier
    s_mov_b32 s96, s24
    s_mov_b32 s97, s25
    s_and_b32 s97, s97, 0xffff
    s_mov_b32 s98, 819200
    s_mov_b32 s99, 0x00020000
    s_lshr_b32 s15, s2, 3
    s_mul_i32 s15, s15, 25600
    v_lshlrev_b32 v5, 6, v0
    v_add_u32 v5, s15, v5
    buffer_load_dword v44, v5, s[96:99], 0 offen
    s_mov_b32 s92, s26
    s_mov_b32 s93, s27
    s_and_b32 s93, s93, 0xffff
    s_mov_b32 s94, 819200
    s_mov_b32 s95, 0x00020000
    buffer_load_dword v45, v5, s[92:95], 0 offen
    ds_read_b128 v[120:123], v36 offset:0
    ds_read_b128 v[124:127], v36 offset:256
    ds_read_b128 v[128:131], v36 offset:512
    ds_read_b128 v[132:135], v36 offset:768
    s_waitcnt lgkmcnt(3)
    v_mfma_f32_16x16x32_bf16 v[48:51], v[120:123], v[16:19], v[28:31]
    ds_read_b128 v[120:123], v36 offset:1024
    s_waitcnt lgkmcnt(3)
    v_mfma_f32_16x16x32_bf16 v[52:55], v[124:127], v[16:19], 0
    ds_read_b128 v[124:127], v36 offset:1280
    s_waitcnt lgkmcnt(3)
    v_mfma_f32_16x16x32_bf16 v[56:59], v[128:131], v[16:19], 0
    ds_read_b128 v[128:131], v36 offset:1536
    s_waitcnt lgkmcnt(3)
    v_mfma_f32_16x16x32_bf16 v[60:63], v[132:135], v[16:19], 0
    ds_read_b128 v[132:135], v36 offset:1792
    s_waitcnt lgkmcnt(3)
    v_mfma_f32_16x16x32_bf16 v[64:67], v[120:123], v[16:19], 0
    ds_read_b128 v[120:123], v36 offset:2048
    s_waitcnt lgkmcnt(3)
    v_mfma_f32_16x16x32_bf16 v[68:71], v[124:127], v[16:19], 0
    ds_read_b128 v[124:127], v36 offset:2304
    s_waitcnt lgkmcnt(3)
    v_mfma_f32_16x16x32_bf16 v[72:75], v[128:131], v[16:19], 0
    ds_read_b128 v[128:131], v36 offset:2560
    s_waitcnt lgkmcnt(3)
    v_mfma_f32_16x16x32_bf16 v[76:79], v[132:135], v[16:19], 0
    ds_read_b128 v[132:135], v36 offset:2816
    s_waitcnt lgkmcnt(3)
    v_mfma_f32_16x16x32_bf16 v[80:83], v[120:123], v[16:19], 0
    ds_read_b128 v[120:123], v36 offset:3072
    s_waitcnt lgkmcnt(3)
    v_mfma_f32_16x16x32_bf16 v[84:87], v[124:127], v[16:19], 0
    ds_read_b128 v[124:127], v36 offset:3328
    s_waitcnt lgkmcnt(3)
    v_mfma_f32_16x16x32_bf16 v[88:91], v[128:131], v[16:19], 0
    ds_read_b128 v[128:131], v36 offset:3584
    s_waitcnt lgkmcnt(3)
    v_mfma_f32_16x16x32_bf16 v[92:95], v[132:135], v[16:19], 0
    ds_read_b128 v[132:135], v36 offset:3840
    s_waitcnt lgkmcnt(3)
    v_mfma_f32_16x16x32_bf16 v[96:99], v[120:123], v[16:19], 0
    ds_read_b128 v[120:123], v36 offset:4096
    s_waitcnt lgkmcnt(3)
    v_mfma_f32_16x16x32_bf16 v[100:103], v[124:127], v[16:19], 0
    s_waitcnt lgkmcnt(2)
    v_mfma_f32_16x16x32_bf16 v[104:107], v[128:131], v[16:19], 0
    s_waitcnt lgkmcnt(1)
    v_mfma_f32_16x16x32_bf16 v[108:111], v[132:135], v[16:19], 0
    s_waitcnt lgkmcnt(0)
    v_mfma_f32_16x16x32_bf16 v[112:115], v[120:123], v[16:19], v[32:35]
    s_nop 7
    s_nop 1
    v_max3_f32 v206, v48, v49, v50
    v_max3_f32 v206, v206, v51, v52
    v_max3_f32 v206, v206, v53, v54
    v_max3_f32 v206, v206, v55, v56
    v_max3_f32 v206, v206, v57, v58
    v_max3_f32 v206, v206, v59, v60
    v_max3_f32 v206, v206, v61, v62
    v_max3_f32 v206, v206, v63, v64
    v_max3_f32 v206, v206, v65, v66
    v_max3_f32 v206, v206, v67, v68
    v_max3_f32 v206, v206, v69, v70
    v_max3_f32 v206, v206, v71, v72
    v_max3_f32 v206, v206, v73, v74
    v_max3_f32 v206, v206, v75, v76
    v_max3_f32 v206, v206, v77, v78
    v_max3_f32 v206, v206, v79, v80
    v_max3_f32 v206, v206, v81, v82
    v_max3_f32 v206, v206, v83, v84
    v_max3_f32 v206, v206, v85, v86
    v_max3_f32 v206, v206, v87, v88
    v_max3_f32 v206, v206, v89, v90
    v_max3_f32 v206, v206, v91, v92
    v_max3_f32 v206, v206, v93, v94
    v_max3_f32 v206, v206, v95, v96
    v_max3_f32 v206, v206, v97, v98
    v_max3_f32 v206, v206, v99, v100
    v_max3_f32 v206, v206, v101, v102
    v_max3_f32 v206, v206, v103, v104
    v_max3_f32 v206, v206, v105, v106
    v_max3_f32 v206, v206, v107, v108
    v_max3_f32 v206, v206, v109, v110
    v_max3_f32 v206, v206, v111, v112
    v_max3_f32 v206, v206, v113, v114
    v_max_f32 v206, v206, v115
    v_mov_b32 v204, v206
    s_nop 1
    v_permlane16_swap_b32 v206, v204
    s_nop 1
    v_max_f32 v206, v206, v204
    v_mov_b32 v204, v206
    s_nop 1
    v_permlane32_swap_b32 v206, v204
    s_nop 1
    v_max_f32 v206, v206, v204
    v_mul_f32 v207, s13, v206
    ds_read_b64_tr_b16 v[136:137], v37 offset:0
    ds_read_b64_tr_b16 v[138:139], v37 offset:256
    ds_read_b64_tr_b16 v[140:141], v38 offset:0
    ds_read_b64_tr_b16 v[142:143], v38 offset:256
    ds_read_b64_tr_b16 v[144:145], v37 offset:512
    ds_read_b64_tr_b16 v[146:147], v37 offset:768
    ds_read_b64_tr_b16 v[148:149], v38 offset:512
    ds_read_b64_tr_b16 v[150:151], v38 offset:768
    v_fma_f32 v48, v48, s13, -v207
    v_fma_f32 v49, v49, s13, -v207
    v_fma_f32 v50, v50, s13, -v207
    v_fma_f32 v51, v51, s13, -v207
    v_fma_f32 v52, v52, s13, -v207
    v_fma_f32 v53, v53, s13, -v207
    v_fma_f32 v54, v54, s13, -v207
    v_fma_f32 v55, v55, s13, -v207
    v_fma_f32 v56, v56, s13, -v207
    v_fma_f32 v57, v57, s13, -v207
    v_fma_f32 v58, v58, s13, -v207
    v_fma_f32 v59, v59, s13, -v207
    v_fma_f32 v60, v60, s13, -v207
    v_fma_f32 v61, v61, s13, -v207
    v_fma_f32 v62, v62, s13, -v207
    v_fma_f32 v63, v63, s13, -v207
    v_fma_f32 v64, v64, s13, -v207
    v_fma_f32 v65, v65, s13, -v207
    v_fma_f32 v66, v66, s13, -v207
    v_fma_f32 v67, v67, s13, -v207
    v_fma_f32 v68, v68, s13, -v207
    v_fma_f32 v69, v69, s13, -v207
    v_fma_f32 v70, v70, s13, -v207
    v_fma_f32 v71, v71, s13, -v207
    v_fma_f32 v72, v72, s13, -v207
    v_fma_f32 v73, v73, s13, -v207
    v_fma_f32 v74, v74, s13, -v207
    v_fma_f32 v75, v75, s13, -v207
    v_fma_f32 v76, v76, s13, -v207
    v_fma_f32 v77, v77, s13, -v207
    v_fma_f32 v78, v78, s13, -v207
    v_fma_f32 v79, v79, s13, -v207
    v_fma_f32 v80, v80, s13, -v207
    v_fma_f32 v81, v81, s13, -v207
    v_fma_f32 v82, v82, s13, -v207
    v_fma_f32 v83, v83, s13, -v207
    v_fma_f32 v84, v84, s13, -v207
    v_fma_f32 v85, v85, s13, -v207
    v_fma_f32 v86, v86, s13, -v207
    v_fma_f32 v87, v87, s13, -v207
    v_fma_f32 v88, v88, s13, -v207
    v_fma_f32 v89, v89, s13, -v207
    v_fma_f32 v90, v90, s13, -v207
    v_fma_f32 v91, v91, s13, -v207
    v_fma_f32 v92, v92, s13, -v207
    v_fma_f32 v93, v93, s13, -v207
    v_fma_f32 v94, v94, s13, -v207
    v_fma_f32 v95, v95, s13, -v207
    v_fma_f32 v96, v96, s13, -v207
    v_fma_f32 v97, v97, s13, -v207
    v_fma_f32 v98, v98, s13, -v207
    v_fma_f32 v99, v99, s13, -v207
    v_fma_f32 v100, v100, s13, -v207
    v_fma_f32 v101, v101, s13, -v207
    v_fma_f32 v102, v102, s13, -v207
    v_fma_f32 v103, v103, s13, -v207
    v_fma_f32 v104, v104, s13, -v207
    v_fma_f32 v105, v105, s13, -v207
    v_fma_f32 v106, v106, s13, -v207
    v_fma_f32 v107, v107, s13, -v207
    v_fma_f32 v108, v108, s13, -v207
    v_fma_f32 v109, v109, s13, -v207
    v_fma_f32 v110, v110, s13, -v207
    v_fma_f32 v111, v111, s13, -v207
    v_fma_f32 v112, v112, s13, -v207
    v_fma_f32 v113, v113, s13, -v207
    v_fma_f32 v114, v114, s13, -v207
    v_fma_f32 v115, v115, s13, -v207
    v_exp_f32 v48, v48
    v_exp_f32 v49, v49
    v_exp_f32 v50, v50
    v_exp_f32 v51, v51
    v_exp_f32 v52, v52
    v_exp_f32 v53, v53
    v_exp_f32 v54, v54
    v_exp_f32 v55, v55
    v_exp_f32 v56, v56
    v_exp_f32 v57, v57
    v_exp_f32 v58, v58
    v_exp_f32 v59, v59
    v_exp_f32 v60, v60
    v_exp_f32 v61, v61
    v_exp_f32 v62, v62
    v_exp_f32 v63, v63
    v_exp_f32 v64, v64
    v_exp_f32 v65, v65
    v_exp_f32 v66, v66
    v_exp_f32 v67, v67
    v_exp_f32 v68, v68
    v_exp_f32 v69, v69
    v_exp_f32 v70, v70
    v_exp_f32 v71, v71
    v_exp_f32 v72, v72
    v_exp_f32 v73, v73
    v_exp_f32 v74, v74
    v_exp_f32 v75, v75
    v_exp_f32 v76, v76
    v_exp_f32 v77, v77
    v_exp_f32 v78, v78
    v_exp_f32 v79, v79
    v_exp_f32 v80, v80
    v_exp_f32 v81, v81
    v_exp_f32 v82, v82
    v_exp_f32 v83, v83
    v_exp_f32 v84, v84
    v_exp_f32 v85, v85
    v_exp_f32 v86, v86
    v_exp_f32 v87, v87
    v_exp_f32 v88, v88
    v_exp_f32 v89, v89
    v_exp_f32 v90, v90
    v_exp_f32 v91, v91
    v_exp_f32 v92, v92
    v_exp_f32 v93, v93
    v_exp_f32 v94, v94
    v_exp_f32 v95, v95
    v_exp_f32 v96, v96
    v_exp_f32 v97, v97
    v_exp_f32 v98, v98
    v_exp_f32 v99, v99
    v_exp_f32 v100, v100
    v_exp_f32 v101, v101
    v_exp_f32 v102, v102
    v_exp_f32 v103, v103
    v_exp_f32 v104, v104
    v_exp_f32 v105, v105
    v_exp_f32 v106, v106
    v_exp_f32 v107, v107
    v_exp_f32 v108, v108
    v_exp_f32 v109, v109
    v_exp_f32 v110, v110
    v_exp_f32 v111, v111
    v_exp_f32 v112, v112
    v_exp_f32 v113, v113
    v_exp_f32 v114, v114
    v_exp_f32 v115, v115
    s_nop 0
    v_cvt_pk_bf16_f32 v168, v48, v49
    v_cvt_pk_bf16_f32 v169, v50, v51
    v_cvt_pk_bf16_f32 v170, v52, v53
    v_cvt_pk_bf16_f32 v171, v54, v55
    v_cvt_pk_bf16_f32 v172, v56, v57
    v_cvt_pk_bf16_f32 v173, v58, v59
    v_cvt_pk_bf16_f32 v174, v60, v61
    v_cvt_pk_bf16_f32 v175, v62, v63
    v_cvt_pk_bf16_f32 v176, v64, v65
    v_cvt_pk_bf16_f32 v177, v66, v67
    v_cvt_pk_bf16_f32 v178, v68, v69
    v_cvt_pk_bf16_f32 v179, v70, v71
    v_cvt_pk_bf16_f32 v180, v72, v73
    v_cvt_pk_bf16_f32 v181, v74, v75
    v_cvt_pk_bf16_f32 v182, v76, v77
    v_cvt_pk_bf16_f32 v183, v78, v79
    v_cvt_pk_bf16_f32 v184, v80, v81
    v_cvt_pk_bf16_f32 v185, v82, v83
    v_cvt_pk_bf16_f32 v186, v84, v85
    v_cvt_pk_bf16_f32 v187, v86, v87
    v_cvt_pk_bf16_f32 v188, v88, v89
    v_cvt_pk_bf16_f32 v189, v90, v91
    v_cvt_pk_bf16_f32 v190, v92, v93
    v_cvt_pk_bf16_f32 v191, v94, v95
    v_cvt_pk_bf16_f32 v192, v96, v97
    v_cvt_pk_bf16_f32 v193, v98, v99
    v_cvt_pk_bf16_f32 v194, v100, v101
    v_cvt_pk_bf16_f32 v195, v102, v103
    v_cvt_pk_bf16_f32 v196, v104, v105
    v_cvt_pk_bf16_f32 v197, v106, v107
    v_cvt_pk_bf16_f32 v198, v108, v109
    v_cvt_pk_bf16_f32 v199, v110, v111
    v_cvt_pk_bf16_f32 v200, v112, v113
    v_cvt_pk_bf16_f32 v201, v114, v115
    v_mov_b32 v202, 0
    v_mov_b32 v203, 0
    ds_read_b64_tr_b16 v[152:153], v37 offset:1024
    ds_read_b64_tr_b16 v[154:155], v37 offset:1280
    ds_read_b64_tr_b16 v[156:157], v38 offset:1024
    ds_read_b64_tr_b16 v[158:159], v38 offset:1280
    s_waitcnt lgkmcnt(8)
    v_mfma_f32_16x16x32_bf16 v[160:163], v[136:139], v[168:171], 0
    v_mfma_f32_16x16x32_bf16 v[164:167], v[140:143], v[168:171], 0
    ds_read_b64_tr_b16 v[136:137], v37 offset:1536
    ds_read_b64_tr_b16 v[138:139], v37 offset:1792
    ds_read_b64_tr_b16 v[140:141], v38 offset:1536
    ds_read_b64_tr_b16 v[142:143], v38 offset:1792
    s_waitcnt lgkmcnt(8)
    v_mfma_f32_16x16x32_bf16 v[160:163], v[144:147], v[172:175], v[160:163]
    v_mfma_f32_16x16x32_bf16 v[164:167], v[148:151], v[172:175], v[164:167]
    ds_read_b64_tr_b16 v[144:145], v37 offset:2048
    ds_read_b64_tr_b16 v[146:147], v37 offset:2304
    ds_read_b64_tr_b16 v[148:149], v38 offset:2048
    ds_read_b64_tr_b16 v[150:151], v38 offset:2304
    s_waitcnt lgkmcnt(8)
    v_mfma_f32_16x16x32_bf16 v[160:163], v[152:155], v[176:179], v[160:163]
    v_mfma_f32_16x16x32_bf16 v[164:167], v[156:159], v[176:179], v[164:167]
    ds_read_b64_tr_b16 v[152:153], v37 offset:2560
    ds_read_b64_tr_b16 v[154:155], v37 offset:2816
    ds_read_b64_tr_b16 v[156:157], v38 offset:2560
    ds_read_b64_tr_b16 v[158:159], v38 offset:2816
    s_waitcnt lgkmcnt(8)
    v_mfma_f32_16x16x32_bf16 v[160:163], v[136:139], v[180:183], v[160:163]
    v_mfma_f32_16x16x32_bf16 v[164:167], v[140:143], v[180:183], v[164:167]
    ds_read_b64_tr_b16 v[136:137], v37 offset:3072
    ds_read_b64_tr_b16 v[138:139], v37 offset:3328
    ds_read_b64_tr_b16 v[140:141], v38 offset:3072
    ds_read_b64_tr_b16 v[142:143], v38 offset:3328
    s_waitcnt lgkmcnt(8)
    v_mfma_f32_16x16x32_bf16 v[160:163], v[144:147], v[184:187], v[160:163]
    v_mfma_f32_16x16x32_bf16 v[164:167], v[148:151], v[184:187], v[164:167]
    ds_read_b64_tr_b16 v[144:145], v37 offset:3584
    ds_read_b64_tr_b16 v[146:147], v37 offset:3840
    ds_read_b64_tr_b16 v[148:149], v38 offset:3584
    ds_read_b64_tr_b16 v[150:151], v38 offset:3840
    s_waitcnt lgkmcnt(8)
    v_mfma_f32_16x16x32_bf16 v[160:163], v[152:155], v[188:191], v[160:163]
    v_mfma_f32_16x16x32_bf16 v[164:167], v[156:159], v[188:191], v[164:167]
    ds_read_b64_tr_b16 v[152:153], v37 offset:4096
    ds_read_b64_tr_b16 v[154:155], v37 offset:4096
    ds_read_b64_tr_b16 v[156:157], v38 offset:4096
    ds_read_b64_tr_b16 v[158:159], v38 offset:4096
    s_waitcnt lgkmcnt(8)
    v_mfma_f32_16x16x32_bf16 v[160:163], v[136:139], v[192:195], v[160:163]
    v_mfma_f32_16x16x32_bf16 v[164:167], v[140:143], v[192:195], v[164:167]
    s_waitcnt lgkmcnt(4)
    v_mfma_f32_16x16x32_bf16 v[160:163], v[144:147], v[196:199], v[160:163]
    v_mfma_f32_16x16x32_bf16 v[164:167], v[148:151], v[196:199], v[164:167]
    s_waitcnt lgkmcnt(0)
    v_mfma_f32_16x16x32_bf16 v[160:163], v[152:155], v[200:203], v[160:163]
    v_mfma_f32_16x16x32_bf16 v[164:167], v[156:159], v[200:203], v[164:167]
    s_nop 7
    s_nop 1
    v_lshlrev_b32 v204, 2, v3
    v_add_u32 v204, 64, v204
    ds_bpermute_b32 v206, v204, v164
    s_waitcnt lgkmcnt(0)
    v_rcp_f32 v206, v206
    s_nop 0
    v_mul_f32 v160, v160, v206
    v_mul_f32 v164, v164, v206
    v_mul_f32 v161, v161, v206
    v_mul_f32 v165, v165, v206
    v_mul_f32 v162, v162, v206
    v_mul_f32 v166, v166, v206
    v_mul_f32 v163, v163, v206
    v_mul_f32 v167, v167, v206
    v_cvt_pk_bf16_f32 v160, v160, v161
    v_cvt_pk_bf16_f32 v161, v162, v163
    v_cvt_pk_bf16_f32 v164, v164, v165
    v_cvt_pk_bf16_f32 v165, v166, v167
    v_add_u32 v204, 0, v24
    v_lshrrev_b32 v204, 4, v204
    v_mul_u32_u24 v204, 20480, v204
    v_lshl_add_u32 v204, v3, 4, v204
    s_mul_i32 s14, s4, 20
    v_lshl_add_u32 v205, v4, 2, s14
    v_lshrrev_b32 v206, 3, v205
    v_and_b32 v205, 7, v205
    v_lshlrev_b32 v205, 1, v205
    v_lshl_add_u32 v205, v206, 8, v205
    v_add_u32 v205, v205, v204
    buffer_store_dwordx2 v[160:161], v205, s[52:55], 0 offen
    v_mov_b32 v205, s14
    v_add_u32 v205, 16, v205
    v_lshrrev_b32 v206, 3, v205
    v_and_b32 v205, 7, v205
    v_lshlrev_b32 v205, 1, v205
    v_lshl_add_u32 v205, v206, 8, v205
    v_add_u32 v205, v205, v204
    v_mov_b32 v206, s12
    v_cmp_eq_u32 vcc, 0, v4
    s_nop 1
    v_cndmask_b32 v205, v206, v205, vcc
    buffer_store_dwordx2 v[164:165], v205, s[52:55], 0 offen
    ds_read_b128 v[120:123], v36 offset:256
    ds_read_b128 v[124:127], v36 offset:512
    ds_read_b128 v[128:131], v36 offset:768
    ds_read_b128 v[132:135], v36 offset:1024
    s_waitcnt lgkmcnt(3)
    v_mfma_f32_16x16x32_bf16 v[48:51], v[120:123], v[20:23], v[28:31]
    ds_read_b128 v[120:123], v36 offset:1280
    s_waitcnt lgkmcnt(3)
    v_mfma_f32_16x16x32_bf16 v[52:55], v[124:127], v[20:23], 0
    ds_read_b128 v[124:127], v36 offset:1536
    s_waitcnt lgkmcnt(3)
    v_mfma_f32_16x16x32_bf16 v[56:59], v[128:131], v[20:23], 0
    ds_read_b128 v[128:131], v36 offset:1792
    s_waitcnt lgkmcnt(3)
    v_mfma_f32_16x16x32_bf16 v[60:63], v[132:135], v[20:23], 0
    ds_read_b128 v[132:135], v36 offset:2048
    s_waitcnt lgkmcnt(3)
    v_mfma_f32_16x16x32_bf16 v[64:67], v[120:123], v[20:23], 0
    ds_read_b128 v[120:123], v36 offset:2304
    s_waitcnt lgkmcnt(3)
    v_mfma_f32_16x16x32_bf16 v[68:71], v[124:127], v[20:23], 0
    ds_read_b128 v[124:127], v36 offset:2560
    s_waitcnt lgkmcnt(3)
    v_mfma_f32_16x16x32_bf16 v[72:75], v[128:131], v[20:23], 0
    ds_read_b128 v[128:131], v36 offset:2816
    s_waitcnt lgkmcnt(3)
    v_mfma_f32_16x16x32_bf16 v[76:79], v[132:135], v[20:23], 0
    ds_read_b128 v[132:135], v36 offset:3072
    s_waitcnt lgkmcnt(3)
    v_mfma_f32_16x16x32_bf16 v[80:83], v[120:123], v[20:23], 0
    ds_read_b128 v[120:123], v36 offset:3328
    s_waitcnt lgkmcnt(3)
    v_mfma_f32_16x16x32_bf16 v[84:87], v[124:127], v[20:23], 0
    ds_read_b128 v[124:127], v36 offset:3584
    s_waitcnt lgkmcnt(3)
    v_mfma_f32_16x16x32_bf16 v[88:91], v[128:131], v[20:23], 0
    ds_read_b128 v[128:131], v36 offset:3840
    s_waitcnt lgkmcnt(3)
    v_mfma_f32_16x16x32_bf16 v[92:95], v[132:135], v[20:23], 0
    ds_read_b128 v[132:135], v36 offset:4096
    s_waitcnt lgkmcnt(3)
    v_mfma_f32_16x16x32_bf16 v[96:99], v[120:123], v[20:23], 0
    ds_read_b128 v[120:123], v36 offset:4352
    s_waitcnt lgkmcnt(3)
    v_mfma_f32_16x16x32_bf16 v[100:103], v[124:127], v[20:23], 0
    s_waitcnt lgkmcnt(2)
    v_mfma_f32_16x16x32_bf16 v[104:107], v[128:131], v[20:23], 0
    s_waitcnt lgkmcnt(1)
    v_mfma_f32_16x16x32_bf16 v[108:111], v[132:135], v[20:23], 0
    s_waitcnt lgkmcnt(0)
    v_mfma_f32_16x16x32_bf16 v[112:115], v[120:123], v[20:23], v[32:35]
    s_nop 7
    s_nop 1
    v_max3_f32 v206, v48, v49, v50
    v_max3_f32 v206, v206, v51, v52
    v_max3_f32 v206, v206, v53, v54
    v_max3_f32 v206, v206, v55, v56
    v_max3_f32 v206, v206, v57, v58
    v_max3_f32 v206, v206, v59, v60
    v_max3_f32 v206, v206, v61, v62
    v_max3_f32 v206, v206, v63, v64
    v_max3_f32 v206, v206, v65, v66
    v_max3_f32 v206, v206, v67, v68
    v_max3_f32 v206, v206, v69, v70
    v_max3_f32 v206, v206, v71, v72
    v_max3_f32 v206, v206, v73, v74
    v_max3_f32 v206, v206, v75, v76
    v_max3_f32 v206, v206, v77, v78
    v_max3_f32 v206, v206, v79, v80
    v_max3_f32 v206, v206, v81, v82
    v_max3_f32 v206, v206, v83, v84
    v_max3_f32 v206, v206, v85, v86
    v_max3_f32 v206, v206, v87, v88
    v_max3_f32 v206, v206, v89, v90
    v_max3_f32 v206, v206, v91, v92
    v_max3_f32 v206, v206, v93, v94
    v_max3_f32 v206, v206, v95, v96
    v_max3_f32 v206, v206, v97, v98
    v_max3_f32 v206, v206, v99, v100
    v_max3_f32 v206, v206, v101, v102
    v_max3_f32 v206, v206, v103, v104
    v_max3_f32 v206, v206, v105, v106
    v_max3_f32 v206, v206, v107, v108
    v_max3_f32 v206, v206, v109, v110
    v_max3_f32 v206, v206, v111, v112
    v_max3_f32 v206, v206, v113, v114
    v_max_f32 v206, v206, v115
    v_mov_b32 v204, v206
    s_nop 1
    v_permlane16_swap_b32 v206, v204
    s_nop 1
    v_max_f32 v206, v206, v204
    v_mov_b32 v204, v206
    s_nop 1
    v_permlane32_swap_b32 v206, v204
    s_nop 1
    v_max_f32 v206, v206, v204
    v_mul_f32 v207, s13, v206
    ds_read_b64_tr_b16 v[136:137], v37 offset:256
    ds_read_b64_tr_b16 v[138:139], v37 offset:512
    ds_read_b64_tr_b16 v[140:141], v38 offset:256
    ds_read_b64_tr_b16 v[142:143], v38 offset:512
    ds_read_b64_tr_b16 v[144:145], v37 offset:768
    ds_read_b64_tr_b16 v[146:147], v37 offset:1024
    ds_read_b64_tr_b16 v[148:149], v38 offset:768
    ds_read_b64_tr_b16 v[150:151], v38 offset:1024
    v_fma_f32 v48, v48, s13, -v207
    v_fma_f32 v49, v49, s13, -v207
    v_fma_f32 v50, v50, s13, -v207
    v_fma_f32 v51, v51, s13, -v207
    v_fma_f32 v52, v52, s13, -v207
    v_fma_f32 v53, v53, s13, -v207
    v_fma_f32 v54, v54, s13, -v207
    v_fma_f32 v55, v55, s13, -v207
    v_fma_f32 v56, v56, s13, -v207
    v_fma_f32 v57, v57, s13, -v207
    v_fma_f32 v58, v58, s13, -v207
    v_fma_f32 v59, v59, s13, -v207
    v_fma_f32 v60, v60, s13, -v207
    v_fma_f32 v61, v61, s13, -v207
    v_fma_f32 v62, v62, s13, -v207
    v_fma_f32 v63, v63, s13, -v207
    v_fma_f32 v64, v64, s13, -v207
    v_fma_f32 v65, v65, s13, -v207
    v_fma_f32 v66, v66, s13, -v207
    v_fma_f32 v67, v67, s13, -v207
    v_fma_f32 v68, v68, s13, -v207
    v_fma_f32 v69, v69, s13, -v207
    v_fma_f32 v70, v70, s13, -v207
    v_fma_f32 v71, v71, s13, -v207
    v_fma_f32 v72, v72, s13, -v207
    v_fma_f32 v73, v73, s13, -v207
    v_fma_f32 v74, v74, s13, -v207
    v_fma_f32 v75, v75, s13, -v207
    v_fma_f32 v76, v76, s13, -v207
    v_fma_f32 v77, v77, s13, -v207
    v_fma_f32 v78, v78, s13, -v207
    v_fma_f32 v79, v79, s13, -v207
    v_fma_f32 v80, v80, s13, -v207
    v_fma_f32 v81, v81, s13, -v207
    v_fma_f32 v82, v82, s13, -v207
    v_fma_f32 v83, v83, s13, -v207
    v_fma_f32 v84, v84, s13, -v207
    v_fma_f32 v85, v85, s13, -v207
    v_fma_f32 v86, v86, s13, -v207
    v_fma_f32 v87, v87, s13, -v207
    v_fma_f32 v88, v88, s13, -v207
    v_fma_f32 v89, v89, s13, -v207
    v_fma_f32 v90, v90, s13, -v207
    v_fma_f32 v91, v91, s13, -v207
    v_fma_f32 v92, v92, s13, -v207
    v_fma_f32 v93, v93, s13, -v207
    v_fma_f32 v94, v94, s13, -v207
    v_fma_f32 v95, v95, s13, -v207
    v_fma_f32 v96, v96, s13, -v207
    v_fma_f32 v97, v97, s13, -v207
    v_fma_f32 v98, v98, s13, -v207
    v_fma_f32 v99, v99, s13, -v207
    v_fma_f32 v100, v100, s13, -v207
    v_fma_f32 v101, v101, s13, -v207
    v_fma_f32 v102, v102, s13, -v207
    v_fma_f32 v103, v103, s13, -v207
    v_fma_f32 v104, v104, s13, -v207
    v_fma_f32 v105, v105, s13, -v207
    v_fma_f32 v106, v106, s13, -v207
    v_fma_f32 v107, v107, s13, -v207
    v_fma_f32 v108, v108, s13, -v207
    v_fma_f32 v109, v109, s13, -v207
    v_fma_f32 v110, v110, s13, -v207
    v_fma_f32 v111, v111, s13, -v207
    v_fma_f32 v112, v112, s13, -v207
    v_fma_f32 v113, v113, s13, -v207
    v_fma_f32 v114, v114, s13, -v207
    v_fma_f32 v115, v115, s13, -v207
    v_exp_f32 v48, v48
    v_exp_f32 v49, v49
    v_exp_f32 v50, v50
    v_exp_f32 v51, v51
    v_exp_f32 v52, v52
    v_exp_f32 v53, v53
    v_exp_f32 v54, v54
    v_exp_f32 v55, v55
    v_exp_f32 v56, v56
    v_exp_f32 v57, v57
    v_exp_f32 v58, v58
    v_exp_f32 v59, v59
    v_exp_f32 v60, v60
    v_exp_f32 v61, v61
    v_exp_f32 v62, v62
    v_exp_f32 v63, v63
    v_exp_f32 v64, v64
    v_exp_f32 v65, v65
    v_exp_f32 v66, v66
    v_exp_f32 v67, v67
    v_exp_f32 v68, v68
    v_exp_f32 v69, v69
    v_exp_f32 v70, v70
    v_exp_f32 v71, v71
    v_exp_f32 v72, v72
    v_exp_f32 v73, v73
    v_exp_f32 v74, v74
    v_exp_f32 v75, v75
    v_exp_f32 v76, v76
    v_exp_f32 v77, v77
    v_exp_f32 v78, v78
    v_exp_f32 v79, v79
    v_exp_f32 v80, v80
    v_exp_f32 v81, v81
    v_exp_f32 v82, v82
    v_exp_f32 v83, v83
    v_exp_f32 v84, v84
    v_exp_f32 v85, v85
    v_exp_f32 v86, v86
    v_exp_f32 v87, v87
    v_exp_f32 v88, v88
    v_exp_f32 v89, v89
    v_exp_f32 v90, v90
    v_exp_f32 v91, v91
    v_exp_f32 v92, v92
    v_exp_f32 v93, v93
    v_exp_f32 v94, v94
    v_exp_f32 v95, v95
    v_exp_f32 v96, v96
    v_exp_f32 v97, v97
    v_exp_f32 v98, v98
    v_exp_f32 v99, v99
    v_exp_f32 v100, v100
    v_exp_f32 v101, v101
    v_exp_f32 v102, v102
    v_exp_f32 v103, v103
    v_exp_f32 v104, v104
    v_exp_f32 v105, v105
    v_exp_f32 v106, v106
    v_exp_f32 v107, v107
    v_exp_f32 v108, v108
    v_exp_f32 v109, v109
    v_exp_f32 v110, v110
    v_exp_f32 v111, v111
    v_exp_f32 v112, v112
    v_exp_f32 v113, v113
    v_exp_f32 v114, v114
    v_exp_f32 v115, v115
    s_nop 0
    v_cvt_pk_bf16_f32 v168, v48, v49
    v_cvt_pk_bf16_f32 v169, v50, v51
    v_cvt_pk_bf16_f32 v170, v52, v53
    v_cvt_pk_bf16_f32 v171, v54, v55
    v_cvt_pk_bf16_f32 v172, v56, v57
    v_cvt_pk_bf16_f32 v173, v58, v59
    v_cvt_pk_bf16_f32 v174, v60, v61
    v_cvt_pk_bf16_f32 v175, v62, v63
    v_cvt_pk_bf16_f32 v176, v64, v65
    v_cvt_pk_bf16_f32 v177, v66, v67
    v_cvt_pk_bf16_f32 v178, v68, v69
    v_cvt_pk_bf16_f32 v179, v70, v71
    v_cvt_pk_bf16_f32 v180, v72, v73
    v_cvt_pk_bf16_f32 v181, v74, v75
    v_cvt_pk_bf16_f32 v182, v76, v77
    v_cvt_pk_bf16_f32 v183, v78, v79
    v_cvt_pk_bf16_f32 v184, v80, v81
    v_cvt_pk_bf16_f32 v185, v82, v83
    v_cvt_pk_bf16_f32 v186, v84, v85
    v_cvt_pk_bf16_f32 v187, v86, v87
    v_cvt_pk_bf16_f32 v188, v88, v89
    v_cvt_pk_bf16_f32 v189, v90, v91
    v_cvt_pk_bf16_f32 v190, v92, v93
    v_cvt_pk_bf16_f32 v191, v94, v95
    v_cvt_pk_bf16_f32 v192, v96, v97
    v_cvt_pk_bf16_f32 v193, v98, v99
    v_cvt_pk_bf16_f32 v194, v100, v101
    v_cvt_pk_bf16_f32 v195, v102, v103
    v_cvt_pk_bf16_f32 v196, v104, v105
    v_cvt_pk_bf16_f32 v197, v106, v107
    v_cvt_pk_bf16_f32 v198, v108, v109
    v_cvt_pk_bf16_f32 v199, v110, v111
    v_cvt_pk_bf16_f32 v200, v112, v113
    v_cvt_pk_bf16_f32 v201, v114, v115
    v_mov_b32 v202, 0
    v_mov_b32 v203, 0
    ds_read_b64_tr_b16 v[152:153], v37 offset:1280
    ds_read_b64_tr_b16 v[154:155], v37 offset:1536
    ds_read_b64_tr_b16 v[156:157], v38 offset:1280
    ds_read_b64_tr_b16 v[158:159], v38 offset:1536
    s_waitcnt lgkmcnt(8)
    v_mfma_f32_16x16x32_bf16 v[160:163], v[136:139], v[168:171], 0
    v_mfma_f32_16x16x32_bf16 v[164:167], v[140:143], v[168:171], 0
    ds_read_b64_tr_b16 v[136:137], v37 offset:1792
    ds_read_b64_tr_b16 v[138:139], v37 offset:2048
    ds_read_b64_tr_b16 v[140:141], v38 offset:1792
    ds_read_b64_tr_b16 v[142:143], v38 offset:2048
    s_waitcnt lgkmcnt(8)
    v_mfma_f32_16x16x32_bf16 v[160:163], v[144:147], v[172:175], v[160:163]
    v_mfma_f32_16x16x32_bf16 v[164:167], v[148:151], v[172:175], v[164:167]
    ds_read_b64_tr_b16 v[144:145], v37 offset:2304
    ds_read_b64_tr_b16 v[146:147], v37 offset:2560
    ds_read_b64_tr_b16 v[148:149], v38 offset:2304
    ds_read_b64_tr_b16 v[150:151], v38 offset:2560
    s_waitcnt lgkmcnt(8)
    v_mfma_f32_16x16x32_bf16 v[160:163], v[152:155], v[176:179], v[160:163]
    v_mfma_f32_16x16x32_bf16 v[164:167], v[156:159], v[176:179], v[164:167]
    ds_read_b64_tr_b16 v[152:153], v37 offset:2816
    ds_read_b64_tr_b16 v[154:155], v37 offset:3072
    ds_read_b64_tr_b16 v[156:157], v38 offset:2816
    ds_read_b64_tr_b16 v[158:159], v38 offset:3072
    s_waitcnt lgkmcnt(8)
    v_mfma_f32_16x16x32_bf16 v[160:163], v[136:139], v[180:183], v[160:163]
    v_mfma_f32_16x16x32_bf16 v[164:167], v[140:143], v[180:183], v[164:167]
    ds_read_b64_tr_b16 v[136:137], v37 offset:3328
    ds_read_b64_tr_b16 v[138:139], v37 offset:3584
    ds_read_b64_tr_b16 v[140:141], v38 offset:3328
    ds_read_b64_tr_b16 v[142:143], v38 offset:3584
    s_waitcnt lgkmcnt(8)
    v_mfma_f32_16x16x32_bf16 v[160:163], v[144:147], v[184:187], v[160:163]
    v_mfma_f32_16x16x32_bf16 v[164:167], v[148:151], v[184:187], v[164:167]
    ds_read_b64_tr_b16 v[144:145], v37 offset:3840
    ds_read_b64_tr_b16 v[146:147], v37 offset:4096
    ds_read_b64_tr_b16 v[148:149], v38 offset:3840
    ds_read_b64_tr_b16 v[150:151], v38 offset:4096
    s_waitcnt lgkmcnt(8)
    v_mfma_f32_16x16x32_bf16 v[160:163], v[152:155], v[188:191], v[160:163]
    v_mfma_f32_16x16x32_bf16 v[164:167], v[156:159], v[188:191], v[164:167]
    ds_read_b64_tr_b16 v[152:153], v37 offset:4352
    ds_read_b64_tr_b16 v[154:155], v37 offset:4352
    ds_read_b64_tr_b16 v[156:157], v38 offset:4352
    ds_read_b64_tr_b16 v[158:159], v38 offset:4352
    s_waitcnt lgkmcnt(8)
    v_mfma_f32_16x16x32_bf16 v[160:163], v[136:139], v[192:195], v[160:163]
    v_mfma_f32_16x16x32_bf16 v[164:167], v[140:143], v[192:195], v[164:167]
    s_waitcnt lgkmcnt(4)
    v_mfma_f32_16x16x32_bf16 v[160:163], v[144:147], v[196:199], v[160:163]
    v_mfma_f32_16x16x32_bf16 v[164:167], v[148:151], v[196:199], v[164:167]
    s_waitcnt lgkmcnt(0)
    v_mfma_f32_16x16x32_bf16 v[160:163], v[152:155], v[200:203], v[160:163]
    v_mfma_f32_16x16x32_bf16 v[164:167], v[156:159], v[200:203], v[164:167]
    s_nop 7
    s_nop 1
    v_lshlrev_b32 v204, 2, v3
    v_add_u32 v204, 64, v204
    ds_bpermute_b32 v206, v204, v164
    s_waitcnt lgkmcnt(0)
    v_rcp_f32 v206, v206
    s_nop 0
    v_mul_f32 v160, v160, v206
    v_mul_f32 v164, v164, v206
    v_mul_f32 v161, v161, v206
    v_mul_f32 v165, v165, v206
    v_mul_f32 v162, v162, v206
    v_mul_f32 v166, v166, v206
    v_mul_f32 v163, v163, v206
    v_mul_f32 v167, v167, v206
    v_cvt_pk_bf16_f32 v160, v160, v161
    v_cvt_pk_bf16_f32 v161, v162, v163
    v_cvt_pk_bf16_f32 v164, v164, v165
    v_cvt_pk_bf16_f32 v165, v166, v167
    v_add_u32 v204, 16, v24
    v_lshrrev_b32 v204, 4, v204
    v_mul_u32_u24 v204, 20480, v204
    v_lshl_add_u32 v204, v3, 4, v204
    s_mul_i32 s14, s4, 20
    v_lshl_add_u32 v205, v4, 2, s14
    v_lshrrev_b32 v206, 3, v205
    v_and_b32 v205, 7, v205
    v_lshlrev_b32 v205, 1, v205
    v_lshl_add_u32 v205, v206, 8, v205
    v_add_u32 v205, v205, v204
    buffer_store_dwordx2 v[160:161], v205, s[52:55], 0 offen
    v_mov_b32 v205, s14
    v_add_u32 v205, 16, v205
    v_lshrrev_b32 v206, 3, v205
    v_and_b32 v205, 7, v205
    v_lshlrev_b32 v205, 1, v205
    v_lshl_add_u32 v205, v206, 8, v205
    v_add_u32 v205, v205, v204
    v_mov_b32 v206, s12
    v_cmp_eq_u32 vcc, 0, v4
    s_nop 1
    v_cndmask_b32 v205, v206, v205, vcc
    buffer_store_dwordx2 v[164:165], v205, s[52:55], 0 offen
k2_attn_kernel_end:
    s_endpgm
.globl k3_fused_kernel
.p2align 8
.type k3_fused_kernel,@function
k3_fused_kernel:
    s_cmp_ge_u32 s2, 256
    s_cbranch_scc1 k3_fused_kernel_end
    s_load_dwordx16 s[16:31], s[0:1], 0
    s_load_dwordx4 s[32:35], s[0:1], 64
    s_load_dwordx2 s[36:37], s[0:1], 80
    v_lshrrev_b32 v1, 6, v0
    v_and_b32 v2, 63, v0
    v_and_b32 v3, 15, v0
    v_bfe_u32 v4, v0, 4, 2
    s_nop 0
    v_readfirstlane_b32 s7, v1
    s_lshl_b32 s8, s7, 10
    v_lshlrev_b32 v32, 7, v0
    s_cmp_eq_u32 s7, 4
    s_cbranch_scc1 k3_fused_kernel_sync
    s_and_b32 s3, s2, 7
    s_lshr_b32 s4, s2, 3
    s_lshl_b32 s3, s3, 2
    s_and_b32 s5, s4, 3
    s_add_u32 s3, s3, s5
    s_lshr_b32 s4, s4, 2
    s_mul_i32 s5, s3, 64
    s_mul_i32 s6, s4, 80
    s_lshr_b32 s9, s5, 4
    s_mul_i32 s64, s7, 1
    s_add_u32 s64, s64, s9
    v_lshl_add_u32 v44, s64, 4, v3
    v_lshlrev_b32 v8, 4, v2
    s_mul_i32 s9, s64, 20480
    v_add_u32 v45, s9, v8
    s_lshr_b32 s12, s2, 3
    s_lshr_b32 s12, s12, 2
    s_mul_i32 s12, s12, 80
    v_add_u32 v8, 0, v0
    v_mul_u32_u24 v9, 1639, v8
    v_lshrrev_b32 v9, 14, v9
    v_mul_u32_u24 v10, 10, v9
    v_sub_u32 v10, v8, v10
    v_and_b32 v34, 0xfffffff3, v9
    v_bfe_u32 v8, v9, 2, 1
    v_lshl_add_u32 v34, v8, 3, v34
    v_bfe_u32 v8, v9, 3, 1
    v_lshl_add_u32 v34, v8, 2, v34
    v_mul_u32_u24 v34, 1280, v34
    v_lshl_add_u32 v34, v10, 4, v34
    v_lshl_add_u32 v34, s12, 1, v34
    v_add_u32 v8, 256, v0
    v_mul_u32_u24 v9, 1639, v8
    v_lshrrev_b32 v9, 14, v9
    v_mul_u32_u24 v10, 10, v9
    v_sub_u32 v10, v8, v10
    v_and_b32 v35, 0xfffffff3, v9
    v_bfe_u32 v8, v9, 2, 1
    v_lshl_add_u32 v35, v8, 3, v35
    v_bfe_u32 v8, v9, 3, 1
    v_lshl_add_u32 v35, v8, 2, v35
    v_mul_u32_u24 v35, 1280, v35
    v_lshl_add_u32 v35, v10, 4, v35
    v_lshl_add_u32 v35, s12, 1, v35
    v_add_u32 v8, 512, v0
    v_mul_u32_u24 v9, 1639, v8
    v_lshrrev_b32 v9, 14, v9
    v_mul_u32_u24 v10, 10, v9
    v_sub_u32 v10, v8, v10
    v_and_b32 v36, 0xfffffff3, v9
    v_bfe_u32 v8, v9, 2, 1
    v_lshl_add_u32 v36, v8, 3, v36
    v_bfe_u32 v8, v9, 3, 1
    v_lshl_add_u32 v36, v8, 2, v36
    v_mul_u32_u24 v36, 1280, v36
    v_lshl_add_u32 v36, v10, 4, v36
    v_lshl_add_u32 v36, s12, 1, v36
    v_add_u32 v8, 768, v0
    v_mul_u32_u24 v9, 1639, v8
    v_lshrrev_b32 v9, 14, v9
    v_mul_u32_u24 v10, 10, v9
    v_sub_u32 v10, v8, v10
    v_and_b32 v37, 0xfffffff3, v9
    v_bfe_u32 v8, v9, 2, 1
    v_lshl_add_u32 v37, v8, 3, v37
    v_bfe_u32 v8, v9, 3, 1
    v_lshl_add_u32 v37, v8, 2, v37
    v_mul_u32_u24 v37, 1280, v37
    v_lshl_add_u32 v37, v10, 4, v37
    v_lshl_add_u32 v37, s12, 1, v37
    v_add_u32 v8, 1024, v0
    v_mul_u32_u24 v9, 1639, v8
    v_lshrrev_b32 v9, 14, v9
    v_mul_u32_u24 v10, 10, v9
    v_sub_u32 v10, v8, v10
    v_and_b32 v38, 0xfffffff3, v9
    v_bfe_u32 v8, v9, 2, 1
    v_lshl_add_u32 v38, v8, 3, v38
    v_bfe_u32 v8, v9, 3, 1
    v_lshl_add_u32 v38, v8, 2, v38
    v_mul_u32_u24 v38, 1280, v38
    v_lshl_add_u32 v38, v10, 4, v38
    v_lshl_add_u32 v38, s12, 1, v38
    s_lshr_b32 s12, s2, 3
    s_lshr_b32 s12, s12, 2
    s_mul_i32 s12, s12, 80
    v_add_u32 v8, 0, v0
    v_mul_u32_u24 v9, 1639, v8
    v_lshrrev_b32 v9, 14, v9
    v_mul_u32_u24 v10, 10, v9
    v_sub_u32 v10, v8, v10
    v_and_b32 v39, 0xfffffff3, v9
    v_bfe_u32 v8, v9, 2, 1
    v_lshl_add_u32 v39, v8, 3, v39
    v_bfe_u32 v8, v9, 3, 1
    v_lshl_add_u32 v39, v8, 2, v39
    v_mul_u32_u24 v39, 1280, v39
    v_lshl_add_u32 v39, v10, 4, v39
    v_lshl_add_u32 v39, s12, 1, v39
    v_add_u32 v8, 256, v0
    v_mul_u32_u24 v9, 1639, v8
    v_lshrrev_b32 v9, 14, v9
    v_mul_u32_u24 v10, 10, v9
    v_sub_u32 v10, v8, v10
    v_and_b32 v40, 0xfffffff3, v9
    v_bfe_u32 v8, v9, 2, 1
    v_lshl_add_u32 v40, v8, 3, v40
    v_bfe_u32 v8, v9, 3, 1
    v_lshl_add_u32 v40, v8, 2, v40
    v_mul_u32_u24 v40, 1280, v40
    v_lshl_add_u32 v40, v10, 4, v40
    v_lshl_add_u32 v40, s12, 1, v40
    v_add_u32 v8, 512, v0
    v_mul_u32_u24 v9, 1639, v8
    v_lshrrev_b32 v9, 14, v9
    v_mul_u32_u24 v10, 10, v9
    v_sub_u32 v10, v8, v10
    v_and_b32 v41, 0xfffffff3, v9
    v_bfe_u32 v8, v9, 2, 1
    v_lshl_add_u32 v41, v8, 3, v41
    v_bfe_u32 v8, v9, 3, 1
    v_lshl_add_u32 v41, v8, 2, v41
    v_mul_u32_u24 v41, 1280, v41
    v_lshl_add_u32 v41, v10, 4, v41
    v_lshl_add_u32 v41, s12, 1, v41
    v_add_u32 v8, 768, v0
    v_mul_u32_u24 v9, 1639, v8
    v_lshrrev_b32 v9, 14, v9
    v_mul_u32_u24 v10, 10, v9
    v_sub_u32 v10, v8, v10
    v_and_b32 v42, 0xfffffff3, v9
    v_bfe_u32 v8, v9, 2, 1
    v_lshl_add_u32 v42, v8, 3, v42
    v_bfe_u32 v8, v9, 3, 1
    v_lshl_add_u32 v42, v8, 2, v42
    v_mul_u32_u24 v42, 1280, v42
    v_lshl_add_u32 v42, v10, 4, v42
    v_lshl_add_u32 v42, s12, 1, v42
    v_add_u32 v8, 1024, v0
    v_mul_u32_u24 v9, 1639, v8
    v_lshrrev_b32 v9, 14, v9
    v_mul_u32_u24 v10, 10, v9
    v_sub_u32 v10, v8, v10
    v_and_b32 v43, 0xfffffff3, v9
    v_bfe_u32 v8, v9, 2, 1
    v_lshl_add_u32 v43, v8, 3, v43
    v_bfe_u32 v8, v9, 3, 1
    v_lshl_add_u32 v43, v8, 2, v43
    v_mul_u32_u24 v43, 1280, v43
    v_lshl_add_u32 v43, v10, 4, v43
    v_lshl_add_u32 v43, s12, 1, v43
    v_bfe_u32 v8, v0, 2, 3
    v_bfe_u32 v9, v0, 5, 1
    v_lshl_add_u32 v9, v9, 4, v8
    v_mul_u32_u24 v9, 160, v9
    v_and_b32 v10, 3, v0
    v_lshl_add_u32 v9, v10, 3, v9
    v_mov_b32 v46, v9
    v_add_u32 v47, 65536, v46
    s_waitcnt lgkmcnt(0)
    s_add_u32 s40, s36, 8388608
    s_addc_u32 s41, s37, 0
    s_and_b32 s41, s41, 0xffff
    s_mov_b32 s42, 2621440
    s_mov_b32 s43, 0x00020000
    s_mov_b32 s44, s20
    s_mov_b32 s45, s21
    s_and_b32 s45, s45, 0xffff
    s_mov_b32 s46, 819200
    s_mov_b32 s47, 0x00020000
    s_mov_b32 s84, s24
    s_mov_b32 s85, s25
    s_and_b32 s85, s85, 0xffff
    s_mov_b32 s86, 819200
    s_mov_b32 s87, 0x00020000
    s_mov_b32 s10, 0
    s_add_u32 m0, s8, 0
    s_nop 0
    buffer_load_dwordx4 v34, s[44:47], s10 offen lds
    s_mov_b32 s10, 0
    s_add_u32 m0, s8, 4096
    s_nop 0
    buffer_load_dwordx4 v35, s[44:47], s10 offen lds
    s_mov_b32 s10, 0
    s_add_u32 m0, s8, 8192
    s_nop 0
    buffer_load_dwordx4 v36, s[44:47], s10 offen lds
    s_mov_b32 s10, 0
    s_add_u32 m0, s8, 12288
    s_nop 0
    buffer_load_dwordx4 v37, s[44:47], s10 offen lds
    s_mov_b32 s10, 0
    s_add_u32 m0, s8, 16384
    s_nop 0
    buffer_load_dwordx4 v38, s[44:47], s10 offen lds
    s_mov_b32 s10, 0
    buffer_load_dwordx4 v[68:71], v45, s[40:43], s10 offen offset:0
    s_mov_b32 s10, 0
    buffer_load_dwordx4 v[72:75], v45, s[40:43], s10 offen offset:1024
    s_mov_b32 s10, 0
    buffer_load_dwordx4 v[76:79], v45, s[40:43], s10 offen offset:2048
    s_mov_b32 s10, 0
    buffer_load_dwordx4 v[80:83], v45, s[40:43], s10 offen offset:3072
    s_add_u32 s48, s36, 11534336
    s_addc_u32 s49, s37, 0
    s_and_b32 s49, s49, 0xffff
    s_mov_b32 s50, 2621440
    s_mov_b32 s51, 0x00020000
    s_mov_b32 s52, s16
    s_mov_b32 s53, s17
    s_and_b32 s53, s53, 0xffff
    s_mov_b32 s54, 2621440
    s_mov_b32 s55, 0x00020000
    v_mul_u32_u24 v148, 1280, v44
    v_lshl_add_u32 v148, v4, 3, v148
    v_lshl_add_u32 v148, s6, 1, v148
    s_mul_i32 s9, s64, 20480
    s_lshl_b32 s14, s6, 5
    s_add_u32 s9, s9, s14
    v_lshrrev_b32 v8, 1, v4
    v_lshl_add_u32 v8, v8, 4, v3
    v_lshlrev_b32 v149, 4, v8
    v_and_b32 v8, 1, v4
    v_lshl_add_u32 v149, v8, 3, v149
    v_add_u32 v149, s9, v149
    buffer_load_dwordx2 v[150:151], v148, s[52:55], 0 offen offset:0
    buffer_load_dwordx2 v[152:153], v148, s[52:55], 0 offen offset:32
    buffer_load_dwordx2 v[154:155], v148, s[52:55], 0 offen offset:64
    buffer_load_dwordx2 v[156:157], v148, s[52:55], 0 offen offset:96
    buffer_load_dwordx2 v[158:159], v148, s[52:55], 0 offen offset:128
    s_mov_b32 s10, 163840
    s_add_u32 m0, s8, 20480
    s_nop 0
    buffer_load_dwordx4 v34, s[44:47], s10 offen lds
    s_mov_b32 s10, 163840
    s_add_u32 m0, s8, 24576
    s_nop 0
    buffer_load_dwordx4 v35, s[44:47], s10 offen lds
    s_mov_b32 s10, 163840
    s_add_u32 m0, s8, 28672
    s_nop 0
    buffer_load_dwordx4 v36, s[44:47], s10 offen lds
    s_mov_b32 s10, 163840
    s_add_u32 m0, s8, 32768
    s_nop 0
    buffer_load_dwordx4 v37, s[44:47], s10 offen lds
    s_mov_b32 s10, 163840
    s_add_u32 m0, s8, 36864
    s_nop 0
    buffer_load_dwordx4 v38, s[44:47], s10 offen lds
    s_mov_b32 s10, 4096
    buffer_load_dwordx4 v[84:87], v45, s[40:43], s10 offen offset:0
    s_mov_b32 s10, 4096
    buffer_load_dwordx4 v[88:91], v45, s[40:43], s10 offen offset:1024
    s_mov_b32 s10, 4096
    buffer_load_dwordx4 v[92:95], v45, s[40:43], s10 offen offset:2048
    s_mov_b32 s10, 4096
    buffer_load_dwordx4 v[96:99], v45, s[40:43], s10 offen offset:3072
    s_mov_b32 s10, 327680
    s_add_u32 m0, s8, 40960
    s_nop 0
    buffer_load_dwordx4 v34, s[44:47], s10 offen lds
    s_mov_b32 s10, 327680
    s_add_u32 m0, s8, 45056
    s_nop 0
    buffer_load_dwordx4 v35, s[44:47], s10 offen lds
    s_mov_b32 s10, 327680
    s_add_u32 m0, s8, 49152
    s_nop 0
    buffer_load_dwordx4 v36, s[44:47], s10 offen lds
    s_mov_b32 s10, 327680
    s_add_u32 m0, s8, 53248
    s_nop 0
    buffer_load_dwordx4 v37, s[44:47], s10 offen lds
    s_mov_b32 s10, 327680
    s_add_u32 m0, s8, 57344
    s_nop 0
    buffer_load_dwordx4 v38, s[44:47], s10 offen lds
    s_mov_b32 s10, 8192
    buffer_load_dwordx4 v[100:103], v45, s[40:43], s10 offen offset:0
    s_mov_b32 s10, 8192
    buffer_load_dwordx4 v[104:107], v45, s[40:43], s10 offen offset:1024
    s_mov_b32 s10, 8192
    buffer_load_dwordx4 v[108:111], v45, s[40:43], s10 offen offset:2048
    s_mov_b32 s10, 8192
    buffer_load_dwordx4 v[112:115], v45, s[40:43], s10 offen offset:3072
    s_mov_b32 s10, 491520
    s_add_u32 m0, s8, 61440
    s_nop 0
    buffer_load_dwordx4 v34, s[44:47], s10 offen lds
    s_mov_b32 s10, 491520
    s_add_u32 m0, s8, 65536
    s_nop 0
    buffer_load_dwordx4 v35, s[44:47], s10 offen lds
    s_mov_b32 s10, 491520
    s_add_u32 m0, s8, 69632
    s_nop 0
    buffer_load_dwordx4 v36, s[44:47], s10 offen lds
    s_mov_b32 s10, 491520
    s_add_u32 m0, s8, 73728
    s_nop 0
    buffer_load_dwordx4 v37, s[44:47], s10 offen lds
    s_mov_b32 s10, 491520
    s_add_u32 m0, s8, 77824
    s_nop 0
    buffer_load_dwordx4 v38, s[44:47], s10 offen lds
    s_mov_b32 s10, 12288
    buffer_load_dwordx4 v[116:119], v45, s[40:43], s10 offen offset:0
    s_mov_b32 s10, 12288
    buffer_load_dwordx4 v[120:123], v45, s[40:43], s10 offen offset:1024
    s_mov_b32 s10, 12288
    buffer_load_dwordx4 v[124:127], v45, s[40:43], s10 offen offset:2048
    s_mov_b32 s10, 12288
    buffer_load_dwordx4 v[128:131], v45, s[40:43], s10 offen offset:3072
    s_mov_b32 s10, 655360
    s_add_u32 m0, s8, 81920
    s_nop 0
    buffer_load_dwordx4 v34, s[44:47], s10 offen lds
    s_mov_b32 s10, 655360
    s_add_u32 m0, s8, 86016
    s_nop 0
    buffer_load_dwordx4 v35, s[44:47], s10 offen lds
    s_mov_b32 s10, 655360
    s_add_u32 m0, s8, 90112
    s_nop 0
    buffer_load_dwordx4 v36, s[44:47], s10 offen lds
    s_mov_b32 s10, 655360
    s_add_u32 m0, s8, 94208
    s_nop 0
    buffer_load_dwordx4 v37, s[44:47], s10 offen lds
    s_mov_b32 s10, 655360
    s_add_u32 m0, s8, 98304
    s_nop 0
    buffer_load_dwordx4 v38, s[44:47], s10 offen lds
    s_mov_b32 s10, 16384
    buffer_load_dwordx4 v[132:135], v45, s[40:43], s10 offen offset:0
    s_mov_b32 s10, 16384
    buffer_load_dwordx4 v[136:139], v45, s[40:43], s10 offen offset:1024
    s_mov_b32 s10, 16384
    buffer_load_dwordx4 v[140:143], v45, s[40:43], s10 offen offset:2048
    s_mov_b32 s10, 16384
    buffer_load_dwordx4 v[144:147], v45, s[40:43], s10 offen offset:3072
    v_mov_b32 v48, 0
    v_mov_b32 v49, 0
    v_mov_b32 v50, 0
    v_mov_b32 v51, 0
    v_mov_b32 v52, 0
    v_mov_b32 v53, 0
    v_mov_b32 v54, 0
    v_mov_b32 v55, 0
    v_mov_b32 v56, 0
    v_mov_b32 v57, 0
    v_mov_b32 v58, 0
    v_mov_b32 v59, 0
    v_mov_b32 v60, 0
    v_mov_b32 v61, 0
    v_mov_b32 v62, 0
    v_mov_b32 v63, 0
    v_mov_b32 v64, 0
    v_mov_b32 v65, 0
    v_mov_b32 v66, 0
    v_mov_b32 v67, 0
    s_waitcnt vmcnt(41)
    s_barrier
    ds_read_b64_tr_b16 v[160:161], v46 offset:0
    ds_read_b64_tr_b16 v[162:163], v46 offset:1280
    ds_read_b64_tr_b16 v[164:165], v46 offset:32
    ds_read_b64_tr_b16 v[166:167], v46 offset:1312
    ds_read_b64_tr_b16 v[168:169], v46 offset:64
    ds_read_b64_tr_b16 v[170:171], v46 offset:1344
    ds_read_b64_tr_b16 v[172:173], v46 offset:96
    ds_read_b64_tr_b16 v[174:175], v46 offset:1376
    ds_read_b64_tr_b16 v[176:177], v46 offset:128
    ds_read_b64_tr_b16 v[178:179], v46 offset:1408
    ds_read_b64_tr_b16 v[180:181], v46 offset:5120
    ds_read_b64_tr_b16 v[182:183], v46 offset:6400
    s_waitcnt lgkmcnt(10)
    v_mfma_f32_16x16x32_bf16 v[48:51], v[160:163], v[68:71], v[48:51]
    s_mov_b32 s96, s28
    s_and_b32 s97, s29, 0xffff
    s_mov_b32 s98, 983040
    s_mov_b32 s99, 0x00020000
    s_lshr_b32 s10, s2, 3
    s_mul_i32 s10, s10, 30720
    s_add_u32 s10, s10, 0
    buffer_load_dword v33, v32, s[96:99], s10 offen
    ds_read_b64_tr_b16 v[184:185], v46 offset:5152
    ds_read_b64_tr_b16 v[186:187], v46 offset:6432
    s_waitcnt lgkmcnt(10)
    v_mfma_f32_16x16x32_bf16 v[52:55], v[164:167], v[68:71], v[52:55]
    ds_read_b64_tr_b16 v[160:161], v46 offset:5184
    ds_read_b64_tr_b16 v[162:163], v46 offset:6464
    s_waitcnt lgkmcnt(10)
    v_mfma_f32_16x16x32_bf16 v[56:59], v[168:171], v[68:71], v[56:59]
    ds_read_b64_tr_b16 v[164:165], v46 offset:5216
    ds_read_b64_tr_b16 v[166:167], v46 offset:6496
    s_waitcnt lgkmcnt(10)
    v_mfma_f32_16x16x32_bf16 v[60:63], v[172:175], v[68:71], v[60:63]
    ds_read_b64_tr_b16 v[168:169], v46 offset:5248
    ds_read_b64_tr_b16 v[170:171], v46 offset:6528
    s_waitcnt lgkmcnt(10)
    v_mfma_f32_16x16x32_bf16 v[64:67], v[176:179], v[68:71], v[64:67]
    ds_read_b64_tr_b16 v[172:173], v46 offset:10240
    ds_read_b64_tr_b16 v[174:175], v46 offset:11520
    s_waitcnt lgkmcnt(10)
    v_mfma_f32_16x16x32_bf16 v[48:51], v[180:183], v[72:75], v[48:51]
    ds_read_b64_tr_b16 v[176:177], v46 offset:10272
    ds_read_b64_tr_b16 v[178:179], v46 offset:11552
    s_waitcnt lgkmcnt(10)
    v_mfma_f32_16x16x32_bf16 v[52:55], v[184:187], v[72:75], v[52:55]
    ds_read_b64_tr_b16 v[180:181], v46 offset:10304
    ds_read_b64_tr_b16 v[182:183], v46 offset:11584
    s_waitcnt lgkmcnt(10)
    v_mfma_f32_16x16x32_bf16 v[56:59], v[160:163], v[72:75], v[56:59]
    ds_read_b64_tr_b16 v[184:185], v46 offset:10336
    ds_read_b64_tr_b16 v[186:187], v46 offset:11616
    s_waitcnt lgkmcnt(10)
    v_mfma_f32_16x16x32_bf16 v[60:63], v[164:167], v[72:75], v[60:63]
    ds_read_b64_tr_b16 v[160:161], v46 offset:10368
    ds_read_b64_tr_b16 v[162:163], v46 offset:11648
    s_waitcnt lgkmcnt(10)
    v_mfma_f32_16x16x32_bf16 v[64:67], v[168:171], v[72:75], v[64:67]
    ds_read_b64_tr_b16 v[164:165], v46 offset:15360
    ds_read_b64_tr_b16 v[166:167], v46 offset:16640
    s_waitcnt lgkmcnt(10)
    v_mfma_f32_16x16x32_bf16 v[48:51], v[172:175], v[76:79], v[48:51]
    ds_read_b64_tr_b16 v[168:169], v46 offset:15392
    ds_read_b64_tr_b16 v[170:171], v46 offset:16672
    s_waitcnt lgkmcnt(10)
    v_mfma_f32_16x16x32_bf16 v[52:55], v[176:179], v[76:79], v[52:55]
    ds_read_b64_tr_b16 v[172:173], v46 offset:15424
    ds_read_b64_tr_b16 v[174:175], v46 offset:16704
    s_waitcnt lgkmcnt(10)
    v_mfma_f32_16x16x32_bf16 v[56:59], v[180:183], v[76:79], v[56:59]
    ds_read_b64_tr_b16 v[176:177], v46 offset:15456
    ds_read_b64_tr_b16 v[178:179], v46 offset:16736
    s_waitcnt lgkmcnt(10)
    v_mfma_f32_16x16x32_bf16 v[60:63], v[184:187], v[76:79], v[60:63]
    ds_read_b64_tr_b16 v[180:181], v46 offset:15488
    ds_read_b64_tr_b16 v[182:183], v46 offset:16768
    s_waitcnt lgkmcnt(10)
    v_mfma_f32_16x16x32_bf16 v[64:67], v[160:163], v[76:79], v[64:67]
    s_waitcnt vmcnt(28)
    s_barrier
    ds_read_b64_tr_b16 v[184:185], v46 offset:20480
    ds_read_b64_tr_b16 v[186:187], v46 offset:21760
    s_waitcnt lgkmcnt(10)
    v_mfma_f32_16x16x32_bf16 v[48:51], v[164:167], v[80:83], v[48:51]
    ds_read_b64_tr_b16 v[160:161], v46 offset:20512
    ds_read_b64_tr_b16 v[162:163], v46 offset:21792
    s_waitcnt lgkmcnt(10)
    v_mfma_f32_16x16x32_bf16 v[52:55], v[168:171], v[80:83], v[52:55]
    ds_read_b64_tr_b16 v[164:165], v46 offset:20544
    ds_read_b64_tr_b16 v[166:167], v46 offset:21824
    s_waitcnt lgkmcnt(10)
    v_mfma_f32_16x16x32_bf16 v[56:59], v[172:175], v[80:83], v[56:59]
    ds_read_b64_tr_b16 v[168:169], v46 offset:20576
    ds_read_b64_tr_b16 v[170:171], v46 offset:21856
    s_waitcnt lgkmcnt(10)
    v_mfma_f32_16x16x32_bf16 v[60:63], v[176:179], v[80:83], v[60:63]
    ds_read_b64_tr_b16 v[172:173], v46 offset:20608
    ds_read_b64_tr_b16 v[174:175], v46 offset:21888
    s_waitcnt lgkmcnt(10)
    v_mfma_f32_16x16x32_bf16 v[64:67], v[180:183], v[80:83], v[64:67]
    ds_read_b64_tr_b16 v[176:177], v46 offset:25600
    ds_read_b64_tr_b16 v[178:179], v46 offset:26880
    s_waitcnt lgkmcnt(10)
    v_mfma_f32_16x16x32_bf16 v[48:51], v[184:187], v[84:87], v[48:51]
    ds_read_b64_tr_b16 v[180:181], v46 offset:25632
    ds_read_b64_tr_b16 v[182:183], v46 offset:26912
    s_waitcnt lgkmcnt(10)
    v_mfma_f32_16x16x32_bf16 v[52:55], v[160:163], v[84:87], v[52:55]
    ds_read_b64_tr_b16 v[184:185], v46 offset:25664
    ds_read_b64_tr_b16 v[186:187], v46 offset:26944
    s_waitcnt lgkmcnt(10)
    v_mfma_f32_16x16x32_bf16 v[56:59], v[164:167], v[84:87], v[56:59]
    ds_read_b64_tr_b16 v[160:161], v46 offset:25696
    ds_read_b64_tr_b16 v[162:163], v46 offset:26976
    s_waitcnt lgkmcnt(10)
    v_mfma_f32_16x16x32_bf16 v[60:63], v[168:171], v[84:87], v[60:63]
    ds_read_b64_tr_b16 v[164:165], v46 offset:25728
    ds_read_b64_tr_b16 v[166:167], v46 offset:27008
    s_waitcnt lgkmcnt(10)
    v_mfma_f32_16x16x32_bf16 v[64:67], v[172:175], v[84:87], v[64:67]
    ds_read_b64_tr_b16 v[168:169], v46 offset:30720
    ds_read_b64_tr_b16 v[170:171], v46 offset:32000
    s_waitcnt lgkmcnt(10)
    v_mfma_f32_16x16x32_bf16 v[48:51], v[176:179], v[88:91], v[48:51]
    ds_read_b64_tr_b16 v[172:173], v46 offset:30752
    ds_read_b64_tr_b16 v[174:175], v46 offset:32032
    s_waitcnt lgkmcnt(10)
    v_mfma_f32_16x16x32_bf16 v[52:55], v[180:183], v[88:91], v[52:55]
    ds_read_b64_tr_b16 v[176:177], v46 offset:30784
    ds_read_b64_tr_b16 v[178:179], v46 offset:32064
    s_waitcnt lgkmcnt(10)
    v_mfma_f32_16x16x32_bf16 v[56:59], v[184:187], v[88:91], v[56:59]
    ds_read_b64_tr_b16 v[180:181], v46 offset:30816
    ds_read_b64_tr_b16 v[182:183], v46 offset:32096
    s_waitcnt lgkmcnt(10)
    v_mfma_f32_16x16x32_bf16 v[60:63], v[160:163], v[88:91], v[60:63]
    ds_read_b64_tr_b16 v[184:185], v46 offset:30848
    ds_read_b64_tr_b16 v[186:187], v46 offset:32128
    s_waitcnt lgkmcnt(10)
    v_mfma_f32_16x16x32_bf16 v[64:67], v[164:167], v[88:91], v[64:67]
    ds_read_b64_tr_b16 v[160:161], v46 offset:35840
    ds_read_b64_tr_b16 v[162:163], v46 offset:37120
    s_waitcnt lgkmcnt(10)
    v_mfma_f32_16x16x32_bf16 v[48:51], v[168:171], v[92:95], v[48:51]
    ds_read_b64_tr_b16 v[164:165], v46 offset:35872
    ds_read_b64_tr_b16 v[166:167], v46 offset:37152
    s_waitcnt lgkmcnt(10)
    v_mfma_f32_16x16x32_bf16 v[52:55], v[172:175], v[92:95], v[52:55]
    ds_read_b64_tr_b16 v[168:169], v46 offset:35904
    ds_read_b64_tr_b16 v[170:171], v46 offset:37184
    s_waitcnt lgkmcnt(10)
    v_mfma_f32_16x16x32_bf16 v[56:59], v[176:179], v[92:95], v[56:59]
    ds_read_b64_tr_b16 v[172:173], v46 offset:35936
    ds_read_b64_tr_b16 v[174:175], v46 offset:37216
    s_waitcnt lgkmcnt(10)
    v_mfma_f32_16x16x32_bf16 v[60:63], v[180:183], v[92:95], v[60:63]
    ds_read_b64_tr_b16 v[176:177], v46 offset:35968
    ds_read_b64_tr_b16 v[178:179], v46 offset:37248
    s_waitcnt lgkmcnt(10)
    v_mfma_f32_16x16x32_bf16 v[64:67], v[184:187], v[92:95], v[64:67]
    s_waitcnt vmcnt(19)
    s_barrier
    ds_read_b64_tr_b16 v[180:181], v46 offset:40960
    ds_read_b64_tr_b16 v[182:183], v46 offset:42240
    s_waitcnt lgkmcnt(10)
    v_mfma_f32_16x16x32_bf16 v[48:51], v[160:163], v[96:99], v[48:51]
    s_mov_b32 s10, 0
    s_add_u32 m0, s8, 0
    s_nop 0
    buffer_load_dwordx4 v39, s[84:87], s10 offen lds
    ds_read_b64_tr_b16 v[184:185], v46 offset:40992
    ds_read_b64_tr_b16 v[186:187], v46 offset:42272
    s_waitcnt lgkmcnt(10)
    v_mfma_f32_16x16x32_bf16 v[52:55], v[164:167], v[96:99], v[52:55]
    s_mov_b32 s10, 0
    s_add_u32 m0, s8, 4096
    s_nop 0
    buffer_load_dwordx4 v40, s[84:87], s10 offen lds
    ds_read_b64_tr_b16 v[160:161], v46 offset:41024
    ds_read_b64_tr_b16 v[162:163], v46 offset:42304
    s_waitcnt lgkmcnt(10)
    v_mfma_f32_16x16x32_bf16 v[56:59], v[168:171], v[96:99], v[56:59]
    s_mov_b32 s10, 0
    s_add_u32 m0, s8, 8192
    s_nop 0
    buffer_load_dwordx4 v41, s[84:87], s10 offen lds
    ds_read_b64_tr_b16 v[164:165], v46 offset:41056
    ds_read_b64_tr_b16 v[166:167], v46 offset:42336
    s_waitcnt lgkmcnt(10)
    v_mfma_f32_16x16x32_bf16 v[60:63], v[172:175], v[96:99], v[60:63]
    s_mov_b32 s10, 0
    s_add_u32 m0, s8, 12288
    s_nop 0
    buffer_load_dwordx4 v42, s[84:87], s10 offen lds
    ds_read_b64_tr_b16 v[168:169], v46 offset:41088
    ds_read_b64_tr_b16 v[170:171], v46 offset:42368
    s_waitcnt lgkmcnt(10)
    v_mfma_f32_16x16x32_bf16 v[64:67], v[176:179], v[96:99], v[64:67]
    s_mov_b32 s10, 0
    s_add_u32 m0, s8, 16384
    s_nop 0
    buffer_load_dwordx4 v43, s[84:87], s10 offen lds
    ds_read_b64_tr_b16 v[172:173], v46 offset:46080
    ds_read_b64_tr_b16 v[174:175], v46 offset:47360
    s_waitcnt lgkmcnt(10)
    v_mfma_f32_16x16x32_bf16 v[48:51], v[180:183], v[100:103], v[48:51]
    ds_read_b64_tr_b16 v[176:177], v46 offset:46112
    ds_read_b64_tr_b16 v[178:179], v46 offset:47392
    s_waitcnt lgkmcnt(10)
    v_mfma_f32_16x16x32_bf16 v[52:55], v[184:187], v[100:103], v[52:55]
    ds_read_b64_tr_b16 v[180:181], v46 offset:46144
    ds_read_b64_tr_b16 v[182:183], v46 offset:47424
    s_waitcnt lgkmcnt(10)
    v_mfma_f32_16x16x32_bf16 v[56:59], v[160:163], v[100:103], v[56:59]
    ds_read_b64_tr_b16 v[184:185], v46 offset:46176
    ds_read_b64_tr_b16 v[186:187], v46 offset:47456
    s_waitcnt lgkmcnt(10)
    v_mfma_f32_16x16x32_bf16 v[60:63], v[164:167], v[100:103], v[60:63]
    ds_read_b64_tr_b16 v[160:161], v46 offset:46208
    ds_read_b64_tr_b16 v[162:163], v46 offset:47488
    s_waitcnt lgkmcnt(10)
    v_mfma_f32_16x16x32_bf16 v[64:67], v[168:171], v[100:103], v[64:67]
    ds_read_b64_tr_b16 v[164:165], v46 offset:51200
    ds_read_b64_tr_b16 v[166:167], v46 offset:52480
    s_waitcnt lgkmcnt(10)
    v_mfma_f32_16x16x32_bf16 v[48:51], v[172:175], v[104:107], v[48:51]
    ds_read_b64_tr_b16 v[168:169], v46 offset:51232
    ds_read_b64_tr_b16 v[170:171], v46 offset:52512
    s_waitcnt lgkmcnt(10)
    v_mfma_f32_16x16x32_bf16 v[52:55], v[176:179], v[104:107], v[52:55]
    ds_read_b64_tr_b16 v[172:173], v46 offset:51264
    ds_read_b64_tr_b16 v[174:175], v46 offset:52544
    s_waitcnt lgkmcnt(10)
    v_mfma_f32_16x16x32_bf16 v[56:59], v[180:183], v[104:107], v[56:59]
    ds_read_b64_tr_b16 v[176:177], v46 offset:51296
    ds_read_b64_tr_b16 v[178:179], v46 offset:52576
    s_waitcnt lgkmcnt(10)
    v_mfma_f32_16x16x32_bf16 v[60:63], v[184:187], v[104:107], v[60:63]
    ds_read_b64_tr_b16 v[180:181], v46 offset:51328
    ds_read_b64_tr_b16 v[182:183], v46 offset:52608
    s_waitcnt lgkmcnt(10)
    v_mfma_f32_16x16x32_bf16 v[64:67], v[160:163], v[104:107], v[64:67]
    ds_read_b64_tr_b16 v[184:185], v46 offset:56320
    ds_read_b64_tr_b16 v[186:187], v46 offset:57600
    s_waitcnt lgkmcnt(10)
    v_mfma_f32_16x16x32_bf16 v[48:51], v[164:167], v[108:111], v[48:51]
    ds_read_b64_tr_b16 v[160:161], v46 offset:56352
    ds_read_b64_tr_b16 v[162:163], v46 offset:57632
    s_waitcnt lgkmcnt(10)
    v_mfma_f32_16x16x32_bf16 v[52:55], v[168:171], v[108:111], v[52:55]
    ds_read_b64_tr_b16 v[164:165], v46 offset:56384
    ds_read_b64_tr_b16 v[166:167], v46 offset:57664
    s_waitcnt lgkmcnt(10)
    v_mfma_f32_16x16x32_bf16 v[56:59], v[172:175], v[108:111], v[56:59]
    ds_read_b64_tr_b16 v[168:169], v46 offset:56416
    ds_read_b64_tr_b16 v[170:171], v46 offset:57696
    s_waitcnt lgkmcnt(10)
    v_mfma_f32_16x16x32_bf16 v[60:63], v[176:179], v[108:111], v[60:63]
    ds_read_b64_tr_b16 v[172:173], v46 offset:56448
    ds_read_b64_tr_b16 v[174:175], v46 offset:57728
    s_waitcnt lgkmcnt(10)
    v_mfma_f32_16x16x32_bf16 v[64:67], v[180:183], v[108:111], v[64:67]
    s_waitcnt vmcnt(15)
    s_barrier
    ds_read_b64_tr_b16 v[176:177], v46 offset:61440
    ds_read_b64_tr_b16 v[178:179], v46 offset:62720
    s_waitcnt lgkmcnt(10)
    v_mfma_f32_16x16x32_bf16 v[48:51], v[184:187], v[112:115], v[48:51]
    s_mov_b32 s10, 163840
    s_add_u32 m0, s8, 20480
    s_nop 0
    buffer_load_dwordx4 v39, s[84:87], s10 offen lds
    ds_read_b64_tr_b16 v[180:181], v46 offset:61472
    ds_read_b64_tr_b16 v[182:183], v46 offset:62752
    s_waitcnt lgkmcnt(10)
    v_mfma_f32_16x16x32_bf16 v[52:55], v[160:163], v[112:115], v[52:55]
    s_mov_b32 s10, 163840
    s_add_u32 m0, s8, 24576
    s_nop 0
    buffer_load_dwordx4 v40, s[84:87], s10 offen lds
    ds_read_b64_tr_b16 v[184:185], v46 offset:61504
    ds_read_b64_tr_b16 v[186:187], v46 offset:62784
    s_waitcnt lgkmcnt(10)
    v_mfma_f32_16x16x32_bf16 v[56:59], v[164:167], v[112:115], v[56:59]
    s_mov_b32 s10, 163840
    s_add_u32 m0, s8, 28672
    s_nop 0
    buffer_load_dwordx4 v41, s[84:87], s10 offen lds
    ds_read_b64_tr_b16 v[160:161], v46 offset:61536
    ds_read_b64_tr_b16 v[162:163], v46 offset:62816
    s_waitcnt lgkmcnt(10)
    v_mfma_f32_16x16x32_bf16 v[60:63], v[168:171], v[112:115], v[60:63]
    s_mov_b32 s10, 163840
    s_add_u32 m0, s8, 32768
    s_nop 0
    buffer_load_dwordx4 v42, s[84:87], s10 offen lds
    ds_read_b64_tr_b16 v[164:165], v46 offset:61568
    ds_read_b64_tr_b16 v[166:167], v46 offset:62848
    s_waitcnt lgkmcnt(10)
    v_mfma_f32_16x16x32_bf16 v[64:67], v[172:175], v[112:115], v[64:67]
    s_mov_b32 s10, 163840
    s_add_u32 m0, s8, 36864
    s_nop 0
    buffer_load_dwordx4 v43, s[84:87], s10 offen lds
    ds_read_b64_tr_b16 v[168:169], v47 offset:1024
    ds_read_b64_tr_b16 v[170:171], v47 offset:2304
    s_waitcnt lgkmcnt(10)
    v_mfma_f32_16x16x32_bf16 v[48:51], v[176:179], v[116:119], v[48:51]
    ds_read_b64_tr_b16 v[172:173], v47 offset:1056
    ds_read_b64_tr_b16 v[174:175], v47 offset:2336
    s_waitcnt lgkmcnt(10)
    v_mfma_f32_16x16x32_bf16 v[52:55], v[180:183], v[116:119], v[52:55]
    ds_read_b64_tr_b16 v[176:177], v47 offset:1088
    ds_read_b64_tr_b16 v[178:179], v47 offset:2368
    s_waitcnt lgkmcnt(10)
    v_mfma_f32_16x16x32_bf16 v[56:59], v[184:187], v[116:119], v[56:59]
    ds_read_b64_tr_b16 v[180:181], v47 offset:1120
    ds_read_b64_tr_b16 v[182:183], v47 offset:2400
    s_waitcnt lgkmcnt(10)
    v_mfma_f32_16x16x32_bf16 v[60:63], v[160:163], v[116:119], v[60:63]
    ds_read_b64_tr_b16 v[184:185], v47 offset:1152
    ds_read_b64_tr_b16 v[186:187], v47 offset:2432
    s_waitcnt lgkmcnt(10)
    v_mfma_f32_16x16x32_bf16 v[64:67], v[164:167], v[116:119], v[64:67]
    ds_read_b64_tr_b16 v[160:161], v47 offset:6144
    ds_read_b64_tr_b16 v[162:163], v47 offset:7424
    s_waitcnt lgkmcnt(10)
    v_mfma_f32_16x16x32_bf16 v[48:51], v[168:171], v[120:123], v[48:51]
    ds_read_b64_tr_b16 v[164:165], v47 offset:6176
    ds_read_b64_tr_b16 v[166:167], v47 offset:7456
    s_waitcnt lgkmcnt(10)
    v_mfma_f32_16x16x32_bf16 v[52:55], v[172:175], v[120:123], v[52:55]
    ds_read_b64_tr_b16 v[168:169], v47 offset:6208
    ds_read_b64_tr_b16 v[170:171], v47 offset:7488
    s_waitcnt lgkmcnt(10)
    v_mfma_f32_16x16x32_bf16 v[56:59], v[176:179], v[120:123], v[56:59]
    ds_read_b64_tr_b16 v[172:173], v47 offset:6240
    ds_read_b64_tr_b16 v[174:175], v47 offset:7520
    s_waitcnt lgkmcnt(10)
    v_mfma_f32_16x16x32_bf16 v[60:63], v[180:183], v[120:123], v[60:63]
    ds_read_b64_tr_b16 v[176:177], v47 offset:6272
    ds_read_b64_tr_b16 v[178:179], v47 offset:7552
    s_waitcnt lgkmcnt(10)
    v_mfma_f32_16x16x32_bf16 v[64:67], v[184:187], v[120:123], v[64:67]
    ds_read_b64_tr_b16 v[180:181], v47 offset:11264
    ds_read_b64_tr_b16 v[182:183], v47 offset:12544
    s_waitcnt lgkmcnt(10)
    v_mfma_f32_16x16x32_bf16 v[48:51], v[160:163], v[124:127], v[48:51]
    ds_read_b64_tr_b16 v[184:185], v47 offset:11296
    ds_read_b64_tr_b16 v[186:187], v47 offset:12576
    s_waitcnt lgkmcnt(10)
    v_mfma_f32_16x16x32_bf16 v[52:55], v[164:167], v[124:127], v[52:55]
    ds_read_b64_tr_b16 v[160:161], v47 offset:11328
    ds_read_b64_tr_b16 v[162:163], v47 offset:12608
    s_waitcnt lgkmcnt(10)
    v_mfma_f32_16x16x32_bf16 v[56:59], v[168:171], v[124:127], v[56:59]
    ds_read_b64_tr_b16 v[164:165], v47 offset:11360
    ds_read_b64_tr_b16 v[166:167], v47 offset:12640
    s_waitcnt lgkmcnt(10)
    v_mfma_f32_16x16x32_bf16 v[60:63], v[172:175], v[124:127], v[60:63]
    ds_read_b64_tr_b16 v[168:169], v47 offset:11392
    ds_read_b64_tr_b16 v[170:171], v47 offset:12672
    s_waitcnt lgkmcnt(10)
    v_mfma_f32_16x16x32_bf16 v[64:67], v[176:179], v[124:127], v[64:67]
    s_waitcnt vmcnt(11)
    s_barrier
    ds_read_b64_tr_b16 v[172:173], v47 offset:16384
    ds_read_b64_tr_b16 v[174:175], v47 offset:17664
    s_waitcnt lgkmcnt(10)
    v_mfma_f32_16x16x32_bf16 v[48:51], v[180:183], v[128:131], v[48:51]
    s_mov_b32 s10, 327680
    s_add_u32 m0, s8, 40960
    s_nop 0
    buffer_load_dwordx4 v39, s[84:87], s10 offen lds
    ds_read_b64_tr_b16 v[176:177], v47 offset:16416
    ds_read_b64_tr_b16 v[178:179], v47 offset:17696
    s_waitcnt lgkmcnt(10)
    v_mfma_f32_16x16x32_bf16 v[52:55], v[184:187], v[128:131], v[52:55]
    s_mov_b32 s10, 327680
    s_add_u32 m0, s8, 45056
    s_nop 0
    buffer_load_dwordx4 v40, s[84:87], s10 offen lds
    ds_read_b64_tr_b16 v[180:181], v47 offset:16448
    ds_read_b64_tr_b16 v[182:183], v47 offset:17728
    s_waitcnt lgkmcnt(10)
    v_mfma_f32_16x16x32_bf16 v[56:59], v[160:163], v[128:131], v[56:59]
    s_mov_b32 s10, 327680
    s_add_u32 m0, s8, 49152
    s_nop 0
    buffer_load_dwordx4 v41, s[84:87], s10 offen lds
    ds_read_b64_tr_b16 v[184:185], v47 offset:16480
    ds_read_b64_tr_b16 v[186:187], v47 offset:17760
    s_waitcnt lgkmcnt(10)
    v_mfma_f32_16x16x32_bf16 v[60:63], v[164:167], v[128:131], v[60:63]
    s_mov_b32 s10, 327680
    s_add_u32 m0, s8, 53248
    s_nop 0
    buffer_load_dwordx4 v42, s[84:87], s10 offen lds
    ds_read_b64_tr_b16 v[160:161], v47 offset:16512
    ds_read_b64_tr_b16 v[162:163], v47 offset:17792
    s_waitcnt lgkmcnt(10)
    v_mfma_f32_16x16x32_bf16 v[64:67], v[168:171], v[128:131], v[64:67]
    s_mov_b32 s10, 327680
    s_add_u32 m0, s8, 57344
    s_nop 0
    buffer_load_dwordx4 v43, s[84:87], s10 offen lds
    ds_read_b64_tr_b16 v[164:165], v47 offset:21504
    ds_read_b64_tr_b16 v[166:167], v47 offset:22784
    s_waitcnt lgkmcnt(10)
    v_mfma_f32_16x16x32_bf16 v[48:51], v[172:175], v[132:135], v[48:51]
    ds_read_b64_tr_b16 v[168:169], v47 offset:21536
    ds_read_b64_tr_b16 v[170:171], v47 offset:22816
    s_waitcnt lgkmcnt(10)
    v_mfma_f32_16x16x32_bf16 v[52:55], v[176:179], v[132:135], v[52:55]
    ds_read_b64_tr_b16 v[172:173], v47 offset:21568
    ds_read_b64_tr_b16 v[174:175], v47 offset:22848
    s_waitcnt lgkmcnt(10)
    v_mfma_f32_16x16x32_bf16 v[56:59], v[180:183], v[132:135], v[56:59]
    ds_read_b64_tr_b16 v[176:177], v47 offset:21600
    ds_read_b64_tr_b16 v[178:179], v47 offset:22880
    s_waitcnt lgkmcnt(10)
    v_mfma_f32_16x16x32_bf16 v[60:63], v[184:187], v[132:135], v[60:63]
    ds_read_b64_tr_b16 v[180:181], v47 offset:21632
    ds_read_b64_tr_b16 v[182:183], v47 offset:22912
    s_waitcnt lgkmcnt(10)
    v_mfma_f32_16x16x32_bf16 v[64:67], v[160:163], v[132:135], v[64:67]
    ds_read_b64_tr_b16 v[184:185], v47 offset:26624
    ds_read_b64_tr_b16 v[186:187], v47 offset:27904
    s_waitcnt lgkmcnt(10)
    v_mfma_f32_16x16x32_bf16 v[48:51], v[164:167], v[136:139], v[48:51]
    ds_read_b64_tr_b16 v[160:161], v47 offset:26656
    ds_read_b64_tr_b16 v[162:163], v47 offset:27936
    s_waitcnt lgkmcnt(10)
    v_mfma_f32_16x16x32_bf16 v[52:55], v[168:171], v[136:139], v[52:55]
    ds_read_b64_tr_b16 v[164:165], v47 offset:26688
    ds_read_b64_tr_b16 v[166:167], v47 offset:27968
    s_waitcnt lgkmcnt(10)
    v_mfma_f32_16x16x32_bf16 v[56:59], v[172:175], v[136:139], v[56:59]
    ds_read_b64_tr_b16 v[168:169], v47 offset:26720
    ds_read_b64_tr_b16 v[170:171], v47 offset:28000
    s_waitcnt lgkmcnt(10)
    v_mfma_f32_16x16x32_bf16 v[60:63], v[176:179], v[136:139], v[60:63]
    ds_read_b64_tr_b16 v[172:173], v47 offset:26752
    ds_read_b64_tr_b16 v[174:175], v47 offset:28032
    s_waitcnt lgkmcnt(10)
    v_mfma_f32_16x16x32_bf16 v[64:67], v[180:183], v[136:139], v[64:67]
    ds_read_b64_tr_b16 v[176:177], v47 offset:31744
    ds_read_b64_tr_b16 v[178:179], v47 offset:33024
    s_waitcnt lgkmcnt(10)
    v_mfma_f32_16x16x32_bf16 v[48:51], v[184:187], v[140:143], v[48:51]
    ds_read_b64_tr_b16 v[180:181], v47 offset:31776
    ds_read_b64_tr_b16 v[182:183], v47 offset:33056
    s_waitcnt lgkmcnt(10)
    v_mfma_f32_16x16x32_bf16 v[52:55], v[160:163], v[140:143], v[52:55]
    ds_read_b64_tr_b16 v[184:185], v47 offset:31808
    ds_read_b64_tr_b16 v[186:187], v47 offset:33088
    s_waitcnt lgkmcnt(10)
    v_mfma_f32_16x16x32_bf16 v[56:59], v[164:167], v[140:143], v[56:59]
    ds_read_b64_tr_b16 v[160:161], v47 offset:31840
    ds_read_b64_tr_b16 v[162:163], v47 offset:33120
    s_waitcnt lgkmcnt(10)
    v_mfma_f32_16x16x32_bf16 v[60:63], v[168:171], v[140:143], v[60:63]
    ds_read_b64_tr_b16 v[164:165], v47 offset:31872
    ds_read_b64_tr_b16 v[166:167], v47 offset:33152
    s_waitcnt lgkmcnt(10)
    v_mfma_f32_16x16x32_bf16 v[64:67], v[172:175], v[140:143], v[64:67]
    s_waitcnt lgkmcnt(8)
    v_mfma_f32_16x16x32_bf16 v[48:51], v[176:179], v[144:147], v[48:51]
    s_waitcnt lgkmcnt(6)
    v_mfma_f32_16x16x32_bf16 v[52:55], v[180:183], v[144:147], v[52:55]
    s_waitcnt lgkmcnt(4)
    v_mfma_f32_16x16x32_bf16 v[56:59], v[184:187], v[144:147], v[56:59]
    s_waitcnt lgkmcnt(2)
    v_mfma_f32_16x16x32_bf16 v[60:63], v[160:163], v[144:147], v[60:63]
    s_waitcnt lgkmcnt(0)
    v_mfma_f32_16x16x32_bf16 v[64:67], v[164:167], v[144:147], v[64:67]
    s_nop 7
    s_nop 1
    s_barrier
    v_mov_b32 v188, 0
    v_mov_b32 v189, 0
    v_cvt_pk_bf16_f32 v8, v48, v49
    v_lshlrev_b32 v9, 16, v8
    v_and_b32 v10, 0xffff0000, v8
    v_lshlrev_b32 v8, 16, v150
    v_and_b32 v11, 0xffff0000, v150
    v_add_f32 v9, v9, v8
    v_add_f32 v10, v10, v11
    v_cvt_pk_bf16_f32 v12, v9, v10
    v_lshlrev_b32 v8, 16, v12
    v_and_b32 v9, 0xffff0000, v12
    v_add_f32 v188, v188, v8
    v_fmac_f32 v189, v8, v8
    v_add_f32 v188, v188, v9
    v_fmac_f32 v189, v9, v9
    v_cvt_pk_bf16_f32 v8, v50, v51
    v_lshlrev_b32 v9, 16, v8
    v_and_b32 v10, 0xffff0000, v8
    v_lshlrev_b32 v8, 16, v151
    v_and_b32 v11, 0xffff0000, v151
    v_add_f32 v9, v9, v8
    v_add_f32 v10, v10, v11
    v_cvt_pk_bf16_f32 v13, v9, v10
    v_lshlrev_b32 v8, 16, v13
    v_and_b32 v9, 0xffff0000, v13
    v_add_f32 v188, v188, v8
    v_fmac_f32 v189, v8, v8
    v_add_f32 v188, v188, v9
    v_fmac_f32 v189, v9, v9
    buffer_store_dwordx2 v[12:13], v149, s[48:51], 0 offen offset:0 sc1
    v_cvt_pk_bf16_f32 v8, v52, v53
    v_lshlrev_b32 v9, 16, v8
    v_and_b32 v10, 0xffff0000, v8
    v_lshlrev_b32 v8, 16, v152
    v_and_b32 v11, 0xffff0000, v152
    v_add_f32 v9, v9, v8
    v_add_f32 v10, v10, v11
    v_cvt_pk_bf16_f32 v14, v9, v10
    v_lshlrev_b32 v8, 16, v14
    v_and_b32 v9, 0xffff0000, v14
    v_add_f32 v188, v188, v8
    v_fmac_f32 v189, v8, v8
    v_add_f32 v188, v188, v9
    v_fmac_f32 v189, v9, v9
    v_cvt_pk_bf16_f32 v8, v54, v55
    v_lshlrev_b32 v9, 16, v8
    v_and_b32 v10, 0xffff0000, v8
    v_lshlrev_b32 v8, 16, v153
    v_and_b32 v11, 0xffff0000, v153
    v_add_f32 v9, v9, v8
    v_add_f32 v10, v10, v11
    v_cvt_pk_bf16_f32 v15, v9, v10
    v_lshlrev_b32 v8, 16, v15
    v_and_b32 v9, 0xffff0000, v15
    v_add_f32 v188, v188, v8
    v_fmac_f32 v189, v8, v8
    v_add_f32 v188, v188, v9
    v_fmac_f32 v189, v9, v9
    buffer_store_dwordx2 v[14:15], v149, s[48:51], 0 offen offset:512 sc1
    v_cvt_pk_bf16_f32 v8, v56, v57
    v_lshlrev_b32 v9, 16, v8
    v_and_b32 v10, 0xffff0000, v8
    v_lshlrev_b32 v8, 16, v154
    v_and_b32 v11, 0xffff0000, v154
    v_add_f32 v9, v9, v8
    v_add_f32 v10, v10, v11
    v_cvt_pk_bf16_f32 v16, v9, v10
    v_lshlrev_b32 v8, 16, v16
    v_and_b32 v9, 0xffff0000, v16
    v_add_f32 v188, v188, v8
    v_fmac_f32 v189, v8, v8
    v_add_f32 v188, v188, v9
    v_fmac_f32 v189, v9, v9
    v_cvt_pk_bf16_f32 v8, v58, v59
    v_lshlrev_b32 v9, 16, v8
    v_and_b32 v10, 0xffff0000, v8
    v_lshlrev_b32 v8, 16, v155
    v_and_b32 v11, 0xffff0000, v155
    v_add_f32 v9, v9, v8
    v_add_f32 v10, v10, v11
    v_cvt_pk_bf16_f32 v17, v9, v10
    v_lshlrev_b32 v8, 16, v17
    v_and_b32 v9, 0xffff0000, v17
    v_add_f32 v188, v188, v8
    v_fmac_f32 v189, v8, v8
    v_add_f32 v188, v188, v9
    v_fmac_f32 v189, v9, v9
    buffer_store_dwordx2 v[16:17], v149, s[48:51], 0 offen offset:1024 sc1
    v_cvt_pk_bf16_f32 v8, v60, v61
    v_lshlrev_b32 v9, 16, v8
    v_and_b32 v10, 0xffff0000, v8
    v_lshlrev_b32 v8, 16, v156
    v_and_b32 v11, 0xffff0000, v156
    v_add_f32 v9, v9, v8
    v_add_f32 v10, v10, v11
    v_cvt_pk_bf16_f32 v18, v9, v10
    v_lshlrev_b32 v8, 16, v18
    v_and_b32 v9, 0xffff0000, v18
    v_add_f32 v188, v188, v8
    v_fmac_f32 v189, v8, v8
    v_add_f32 v188, v188, v9
    v_fmac_f32 v189, v9, v9
    v_cvt_pk_bf16_f32 v8, v62, v63
    v_lshlrev_b32 v9, 16, v8
    v_and_b32 v10, 0xffff0000, v8
    v_lshlrev_b32 v8, 16, v157
    v_and_b32 v11, 0xffff0000, v157
    v_add_f32 v9, v9, v8
    v_add_f32 v10, v10, v11
    v_cvt_pk_bf16_f32 v19, v9, v10
    v_lshlrev_b32 v8, 16, v19
    v_and_b32 v9, 0xffff0000, v19
    v_add_f32 v188, v188, v8
    v_fmac_f32 v189, v8, v8
    v_add_f32 v188, v188, v9
    v_fmac_f32 v189, v9, v9
    buffer_store_dwordx2 v[18:19], v149, s[48:51], 0 offen offset:1536 sc1
    v_cvt_pk_bf16_f32 v8, v64, v65
    v_lshlrev_b32 v9, 16, v8
    v_and_b32 v10, 0xffff0000, v8
    v_lshlrev_b32 v8, 16, v158
    v_and_b32 v11, 0xffff0000, v158
    v_add_f32 v9, v9, v8
    v_add_f32 v10, v10, v11
    v_cvt_pk_bf16_f32 v20, v9, v10
    v_lshlrev_b32 v8, 16, v20
    v_and_b32 v9, 0xffff0000, v20
    v_add_f32 v188, v188, v8
    v_fmac_f32 v189, v8, v8
    v_add_f32 v188, v188, v9
    v_fmac_f32 v189, v9, v9
    v_cvt_pk_bf16_f32 v8, v66, v67
    v_lshlrev_b32 v9, 16, v8
    v_and_b32 v10, 0xffff0000, v8
    v_lshlrev_b32 v8, 16, v159
    v_and_b32 v11, 0xffff0000, v159
    v_add_f32 v9, v9, v8
    v_add_f32 v10, v10, v11
    v_cvt_pk_bf16_f32 v21, v9, v10
    v_lshlrev_b32 v8, 16, v21
    v_and_b32 v9, 0xffff0000, v21
    v_add_f32 v188, v188, v8
    v_fmac_f32 v189, v8, v8
    v_add_f32 v188, v188, v9
    v_fmac_f32 v189, v9, v9
    buffer_store_dwordx2 v[20:21], v149, s[48:51], 0 offen offset:2048 sc1
    v_mov_b32 v8, v188
    s_nop 1
    v_permlane16_swap_b32 v188, v8
    s_nop 1
    v_add_f32 v188, v188, v8
    v_mov_b32 v8, v188
    s_nop 1
    v_permlane32_swap_b32 v188, v8
    s_nop 1
    v_add_f32 v188, v188, v8
    v_mov_b32 v8, v189
    s_nop 1
    v_permlane16_swap_b32 v189, v8
    s_nop 1
    v_add_f32 v189, v189, v8
    v_mov_b32 v8, v189
    s_nop 1
    v_permlane32_swap_b32 v189, v8
    s_nop 1
    v_add_f32 v189, v189, v8
    s_add_u32 s60, s36, 28311552
    s_addc_u32 s61, s37, 0
    s_and_b32 s61, s61, 0xffff
    s_mov_b32 s62, 131072
    s_mov_b32 s63, 0x00020000
    v_lshlrev_b32 v8, 6, v44
    s_lshl_b32 s9, s4, 3
    v_add_u32 v8, s9, v8
    s_mov_b32 s9, 0x80000000
    v_mov_b32 v9, s9
    v_cmp_eq_u32 vcc, 0, v4
    s_nop 1
    v_cndmask_b32 v8, v9, v8, vcc
    buffer_store_dwordx2 v[188:189], v8, s[60:63], 0 offen sc1
    s_waitcnt vmcnt(0)
    s_barrier
    s_and_b32 s3, s2, 7
    s_lshr_b32 s4, s2, 3
    s_lshl_b32 s3, s3, 2
    s_and_b32 s5, s4, 3
    s_add_u32 s3, s3, s5
    s_lshr_b32 s4, s4, 2
    s_mul_i32 s5, s3, 64
    s_mul_i32 s6, s4, 80
    s_lshr_b32 s9, s5, 4
    s_mul_i32 s64, s7, 1
    s_add_u32 s64, s64, s9
    v_lshl_add_u32 v44, s64, 4, v3
    v_lshlrev_b32 v8, 4, v2
    s_mul_i32 s9, s64, 20480
    v_add_u32 v45, s9, v8
    s_lshr_b32 s12, s2, 3
    s_lshr_b32 s12, s12, 2
    s_mul_i32 s12, s12, 80
    v_add_u32 v8, 0, v0
    v_mul_u32_u24 v9, 1639, v8
    v_lshrrev_b32 v9, 14, v9
    v_mul_u32_u24 v10, 10, v9
    v_sub_u32 v10, v8, v10
    v_and_b32 v34, 0xfffffff3, v9
    v_bfe_u32 v8, v9, 2, 1
    v_lshl_add_u32 v34, v8, 3, v34
    v_bfe_u32 v8, v9, 3, 1
    v_lshl_add_u32 v34, v8, 2, v34
    v_mul_u32_u24 v34, 1280, v34
    v_lshl_add_u32 v34, v10, 4, v34
    v_lshl_add_u32 v34, s12, 1, v34
    v_add_u32 v8, 256, v0
    v_mul_u32_u24 v9, 1639, v8
    v_lshrrev_b32 v9, 14, v9
    v_mul_u32_u24 v10, 10, v9
    v_sub_u32 v10, v8, v10
    v_and_b32 v35, 0xfffffff3, v9
    v_bfe_u32 v8, v9, 2, 1
    v_lshl_add_u32 v35, v8, 3, v35
    v_bfe_u32 v8, v9, 3, 1
    v_lshl_add_u32 v35, v8, 2, v35
    v_mul_u32_u24 v35, 1280, v35
    v_lshl_add_u32 v35, v10, 4, v35
    v_lshl_add_u32 v35, s12, 1, v35
    v_add_u32 v8, 512, v0
    v_mul_u32_u24 v9, 1639, v8
    v_lshrrev_b32 v9, 14, v9
    v_mul_u32_u24 v10, 10, v9
    v_sub_u32 v10, v8, v10
    v_and_b32 v36, 0xfffffff3, v9
    v_bfe_u32 v8, v9, 2, 1
    v_lshl_add_u32 v36, v8, 3, v36
    v_bfe_u32 v8, v9, 3, 1
    v_lshl_add_u32 v36, v8, 2, v36
    v_mul_u32_u24 v36, 1280, v36
    v_lshl_add_u32 v36, v10, 4, v36
    v_lshl_add_u32 v36, s12, 1, v36
    v_add_u32 v8, 768, v0
    v_mul_u32_u24 v9, 1639, v8
    v_lshrrev_b32 v9, 14, v9
    v_mul_u32_u24 v10, 10, v9
    v_sub_u32 v10, v8, v10
    v_and_b32 v37, 0xfffffff3, v9
    v_bfe_u32 v8, v9, 2, 1
    v_lshl_add_u32 v37, v8, 3, v37
    v_bfe_u32 v8, v9, 3, 1
    v_lshl_add_u32 v37, v8, 2, v37
    v_mul_u32_u24 v37, 1280, v37
    v_lshl_add_u32 v37, v10, 4, v37
    v_lshl_add_u32 v37, s12, 1, v37
    v_add_u32 v8, 1024, v0
    v_mul_u32_u24 v9, 1639, v8
    v_lshrrev_b32 v9, 14, v9
    v_mul_u32_u24 v10, 10, v9
    v_sub_u32 v10, v8, v10
    v_and_b32 v38, 0xfffffff3, v9
    v_bfe_u32 v8, v9, 2, 1
    v_lshl_add_u32 v38, v8, 3, v38
    v_bfe_u32 v8, v9, 3, 1
    v_lshl_add_u32 v38, v8, 2, v38
    v_mul_u32_u24 v38, 1280, v38
    v_lshl_add_u32 v38, v10, 4, v38
    v_lshl_add_u32 v38, s12, 1, v38
    v_bfe_u32 v8, v0, 2, 3
    v_bfe_u32 v9, v0, 5, 1
    v_lshl_add_u32 v9, v9, 4, v8
    v_mul_u32_u24 v9, 160, v9
    v_and_b32 v10, 3, v0
    v_lshl_add_u32 v9, v10, 3, v9
    v_mov_b32 v46, v9
    v_add_u32 v47, 65536, v46
    s_add_u32 s9, s7, 0
    s_min_u32 s9, s9, 4
    v_mov_b32 v10, s9
    v_lshl_add_u32 v48, v10, 5, v9
    v_add_u32 v49, 65536, v48
    s_add_u32 s9, s7, 4
    s_min_u32 s9, s9, 4
    v_mov_b32 v10, s9
    v_lshl_add_u32 v50, v10, 5, v9
    v_add_u32 v51, 65536, v50
    v_mov_b32 v52, 0x3f803f80
    v_mov_b32 v53, 0x3f803f80
    v_mov_b32 v54, 0x3f803f80
    v_mov_b32 v55, 0x3f803f80
    s_add_u32 s40, s36, 11534336
    s_addc_u32 s41, s37, 0
    s_and_b32 s41, s41, 0xffff
    s_mov_b32 s42, 2621440
    s_mov_b32 s43, 0x00020000
    s_mov_b32 s44, s26
    s_mov_b32 s45, s27
    s_and_b32 s45, s45, 0xffff
    s_mov_b32 s46, 819200
    s_mov_b32 s47, 0x00020000
    s_mov_b32 s10, 491520
    s_add_u32 m0, s8, 61440
    s_nop 0
    buffer_load_dwordx4 v39, s[84:87], s10 offen lds
    s_mov_b32 s10, 491520
    s_add_u32 m0, s8, 65536
    s_nop 0
    buffer_load_dwordx4 v40, s[84:87], s10 offen lds
    s_mov_b32 s10, 491520
    s_add_u32 m0, s8, 69632
    s_nop 0
    buffer_load_dwordx4 v41, s[84:87], s10 offen lds
    s_mov_b32 s10, 491520
    s_add_u32 m0, s8, 73728
    s_nop 0
    buffer_load_dwordx4 v42, s[84:87], s10 offen lds
    s_mov_b32 s10, 491520
    s_add_u32 m0, s8, 77824
    s_nop 0
    buffer_load_dwordx4 v43, s[84:87], s10 offen lds
    s_mov_b32 s10, 655360
    s_add_u32 m0, s8, 81920
    s_nop 0
    buffer_load_dwordx4 v39, s[84:87], s10 offen lds
    s_mov_b32 s10, 655360
    s_add_u32 m0, s8, 86016
    s_nop 0
    buffer_load_dwordx4 v40, s[84:87], s10 offen lds
    s_mov_b32 s10, 655360
    s_add_u32 m0, s8, 90112
    s_nop 0
    buffer_load_dwordx4 v41, s[84:87], s10 offen lds
    s_mov_b32 s10, 655360
    s_add_u32 m0, s8, 94208
    s_nop 0
    buffer_load_dwordx4 v42, s[84:87], s10 offen lds
    s_mov_b32 s10, 655360
    s_add_u32 m0, s8, 98304
    s_nop 0
    buffer_load_dwordx4 v43, s[84:87], s10 offen lds
    s_barrier
    s_mov_b32 s10, 0
    buffer_load_dwordx4 v[88:91], v45, s[40:43], s10 offen offset:0 sc1
    s_mov_b32 s10, 0
    buffer_load_dwordx4 v[92:95], v45, s[40:43], s10 offen offset:1024 sc1
    s_mov_b32 s10, 0
    buffer_load_dwordx4 v[96:99], v45, s[40:43], s10 offen offset:2048 sc1
    s_mov_b32 s10, 0
    buffer_load_dwordx4 v[100:103], v45, s[40:43], s10 offen offset:3072 sc1
    s_add_u32 s60, s36, 28311552
    s_addc_u32 s61, s37, 0
    s_and_b32 s61, s61, 0xffff
    s_mov_b32 s62, 131072
    s_mov_b32 s63, 0x00020000
    v_lshlrev_b32 v8, 6, v44
    v_lshl_add_u32 v8, v4, 4, v8
    buffer_load_dwordx4 v[168:171], v8, s[60:63], 0 offen sc1
    s_add_u32 s48, s36, 14680064
    s_addc_u32 s49, s37, 0
    s_and_b32 s49, s49, 0xffff
    s_mov_b32 s50, 2621440
    s_mov_b32 s51, 0x00020000
    s_mul_i32 s9, s64, 20480
    s_lshl_b32 s14, s6, 5
    s_add_u32 s9, s9, s14
    v_lshrrev_b32 v8, 1, v4
    v_lshl_add_u32 v8, v8, 4, v3
    v_lshlrev_b32 v172, 4, v8
    v_and_b32 v8, 1, v4
    v_lshl_add_u32 v172, v8, 3, v172
    v_add_u32 v172, s9, v172
    v_mov_b32 v174, 0xc0135761
    v_mov_b32 v175, 0xc0135761
    v_mov_b32 v176, 0xbdd2d3e8
    v_mov_b32 v177, 0xbdd2d3e8
    v_mov_b32 v178, 0x3f800000
    v_mov_b32 v179, 0x3f800000
    s_mov_b32 s10, 4096
    buffer_load_dwordx4 v[104:107], v45, s[40:43], s10 offen offset:0 sc1
    s_mov_b32 s10, 4096
    buffer_load_dwordx4 v[108:111], v45, s[40:43], s10 offen offset:1024 sc1
    s_mov_b32 s10, 4096
    buffer_load_dwordx4 v[112:115], v45, s[40:43], s10 offen offset:2048 sc1
    s_mov_b32 s10, 4096
    buffer_load_dwordx4 v[116:119], v45, s[40:43], s10 offen offset:3072 sc1
    s_mov_b32 s10, 8192
    buffer_load_dwordx4 v[120:123], v45, s[40:43], s10 offen offset:0 sc1
    s_mov_b32 s10, 8192
    buffer_load_dwordx4 v[124:127], v45, s[40:43], s10 offen offset:1024 sc1
    s_mov_b32 s10, 8192
    buffer_load_dwordx4 v[128:131], v45, s[40:43], s10 offen offset:2048 sc1
    s_mov_b32 s10, 8192
    buffer_load_dwordx4 v[132:135], v45, s[40:43], s10 offen offset:3072 sc1
    s_mov_b32 s10, 12288
    buffer_load_dwordx4 v[136:139], v45, s[40:43], s10 offen offset:0 sc1
    s_mov_b32 s10, 12288
    buffer_load_dwordx4 v[140:143], v45, s[40:43], s10 offen offset:1024 sc1
    s_mov_b32 s10, 12288
    buffer_load_dwordx4 v[144:147], v45, s[40:43], s10 offen offset:2048 sc1
    s_mov_b32 s10, 12288
    buffer_load_dwordx4 v[148:151], v45, s[40:43], s10 offen offset:3072 sc1
    s_mov_b32 s10, 16384
    buffer_load_dwordx4 v[152:155], v45, s[40:43], s10 offen offset:0 sc1
    s_mov_b32 s10, 16384
    buffer_load_dwordx4 v[156:159], v45, s[40:43], s10 offen offset:1024 sc1
    s_mov_b32 s10, 16384
    buffer_load_dwordx4 v[160:163], v45, s[40:43], s10 offen offset:2048 sc1
    s_mov_b32 s10, 16384
    buffer_load_dwordx4 v[164:167], v45, s[40:43], s10 offen offset:3072 sc1
    v_mov_b32 v68, 0
    v_mov_b32 v69, 0
    v_mov_b32 v70, 0
    v_mov_b32 v71, 0
    v_mov_b32 v72, 0
    v_mov_b32 v73, 0
    v_mov_b32 v74, 0
    v_mov_b32 v75, 0
    v_mov_b32 v76, 0
    v_mov_b32 v77, 0
    v_mov_b32 v78, 0
    v_mov_b32 v79, 0
    v_mov_b32 v80, 0
    v_mov_b32 v81, 0
    v_mov_b32 v82, 0
    v_mov_b32 v83, 0
    v_mov_b32 v84, 0
    v_mov_b32 v85, 0
    v_mov_b32 v86, 0
    v_mov_b32 v87, 0
    v_mov_b32 v60, 0
    v_mov_b32 v61, 0
    v_mov_b32 v62, 0
    v_mov_b32 v63, 0
    v_mov_b32 v64, 0
    v_mov_b32 v65, 0
    v_mov_b32 v66, 0
    v_mov_b32 v67, 0
    s_waitcnt vmcnt(17)
    s_barrier
    ds_read_b64_tr_b16 v[180:181], v46 offset:0
    ds_read_b64_tr_b16 v[182:183], v46 offset:1280
    ds_read_b64_tr_b16 v[184:185], v46 offset:32
    ds_read_b64_tr_b16 v[186:187], v46 offset:1312
    ds_read_b64_tr_b16 v[188:189], v46 offset:64
    ds_read_b64_tr_b16 v[190:191], v46 offset:1344
    ds_read_b64_tr_b16 v[192:193], v46 offset:96
    ds_read_b64_tr_b16 v[194:195], v46 offset:1376
    ds_read_b64_tr_b16 v[196:197], v46 offset:128
    ds_read_b64_tr_b16 v[198:199], v46 offset:1408
    ds_read_b64_tr_b16 v[200:201], v48 offset:0
    ds_read_b64_tr_b16 v[202:203], v48 offset:1280
    s_waitcnt lgkmcnt(10)
    v_mfma_f32_16x16x32_bf16 v[68:71], v[180:183], v[88:91], v[68:71]
    s_mov_b32 s96, s28
    s_and_b32 s97, s29, 0xffff
    s_mov_b32 s98, 1966080
    s_mov_b32 s99, 0x00020000
    s_lshr_b32 s10, s2, 3
    s_mul_i32 s10, s10, 30720
    s_add_u32 s10, s10, 983040
    buffer_load_dword v33, v32, s[96:99], s10 offen
    ds_read_b64_tr_b16 v[204:205], v50 offset:0
    ds_read_b64_tr_b16 v[206:207], v50 offset:1280
    s_waitcnt lgkmcnt(10)
    v_mfma_f32_16x16x32_bf16 v[72:75], v[184:187], v[88:91], v[72:75]
    ds_read_b64_tr_b16 v[180:181], v46 offset:5120
    ds_read_b64_tr_b16 v[182:183], v46 offset:6400
    s_waitcnt lgkmcnt(10)
    v_mfma_f32_16x16x32_bf16 v[76:79], v[188:191], v[88:91], v[76:79]
    ds_read_b64_tr_b16 v[184:185], v46 offset:5152
    ds_read_b64_tr_b16 v[186:187], v46 offset:6432
    s_waitcnt lgkmcnt(10)
    v_mfma_f32_16x16x32_bf16 v[80:83], v[192:195], v[88:91], v[80:83]
    ds_read_b64_tr_b16 v[188:189], v46 offset:5184
    ds_read_b64_tr_b16 v[190:191], v46 offset:6464
    s_waitcnt lgkmcnt(10)
    v_mfma_f32_16x16x32_bf16 v[84:87], v[196:199], v[88:91], v[84:87]
    ds_read_b64_tr_b16 v[192:193], v46 offset:5216
    ds_read_b64_tr_b16 v[194:195], v46 offset:6496
    s_waitcnt lgkmcnt(10)
    v_mfma_f32_16x16x32_bf16 v[60:63], v[200:203], v[52:55], v[60:63]
    ds_read_b64_tr_b16 v[196:197], v46 offset:5248
    ds_read_b64_tr_b16 v[198:199], v46 offset:6528
    s_waitcnt lgkmcnt(10)
    v_mfma_f32_16x16x32_bf16 v[64:67], v[204:207], v[52:55], v[64:67]
    ds_read_b64_tr_b16 v[200:201], v48 offset:5120
    ds_read_b64_tr_b16 v[202:203], v48 offset:6400
    s_waitcnt lgkmcnt(10)
    v_mfma_f32_16x16x32_bf16 v[68:71], v[180:183], v[92:95], v[68:71]
    ds_read_b64_tr_b16 v[204:205], v50 offset:5120
    ds_read_b64_tr_b16 v[206:207], v50 offset:6400
    s_waitcnt lgkmcnt(10)
    v_mfma_f32_16x16x32_bf16 v[72:75], v[184:187], v[92:95], v[72:75]
    ds_read_b64_tr_b16 v[180:181], v46 offset:10240
    ds_read_b64_tr_b16 v[182:183], v46 offset:11520
    s_waitcnt lgkmcnt(10)
    v_mfma_f32_16x16x32_bf16 v[76:79], v[188:191], v[92:95], v[76:79]
    ds_read_b64_tr_b16 v[184:185], v46 offset:10272
    ds_read_b64_tr_b16 v[186:187], v46 offset:11552
    s_waitcnt lgkmcnt(10)
    v_mfma_f32_16x16x32_bf16 v[80:83], v[192:195], v[92:95], v[80:83]
    ds_read_b64_tr_b16 v[188:189], v46 offset:10304
    ds_read_b64_tr_b16 v[190:191], v46 offset:11584
    s_waitcnt lgkmcnt(10)
    v_mfma_f32_16x16x32_bf16 v[84:87], v[196:199], v[92:95], v[84:87]
    ds_read_b64_tr_b16 v[192:193], v46 offset:10336
    ds_read_b64_tr_b16 v[194:195], v46 offset:11616
    s_waitcnt lgkmcnt(10)
    v_mfma_f32_16x16x32_bf16 v[60:63], v[200:203], v[52:55], v[60:63]
    ds_read_b64_tr_b16 v[196:197], v46 offset:10368
    ds_read_b64_tr_b16 v[198:199], v46 offset:11648
    s_waitcnt lgkmcnt(10)
    v_mfma_f32_16x16x32_bf16 v[64:67], v[204:207], v[52:55], v[64:67]
    ds_read_b64_tr_b16 v[200:201], v48 offset:10240
    ds_read_b64_tr_b16 v[202:203], v48 offset:11520
    s_waitcnt lgkmcnt(10)
    v_mfma_f32_16x16x32_bf16 v[68:71], v[180:183], v[96:99], v[68:71]
    ds_read_b64_tr_b16 v[204:205], v50 offset:10240
    ds_read_b64_tr_b16 v[206:207], v50 offset:11520
    s_waitcnt lgkmcnt(10)
    v_mfma_f32_16x16x32_bf16 v[72:75], v[184:187], v[96:99], v[72:75]
    ds_read_b64_tr_b16 v[180:181], v46 offset:15360
    ds_read_b64_tr_b16 v[182:183], v46 offset:16640
    s_waitcnt lgkmcnt(10)
    v_mfma_f32_16x16x32_bf16 v[76:79], v[188:191], v[96:99], v[76:79]
    ds_read_b64_tr_b16 v[184:185], v46 offset:15392
    ds_read_b64_tr_b16 v[186:187], v46 offset:16672
    s_waitcnt lgkmcnt(10)
    v_mfma_f32_16x16x32_bf16 v[80:83], v[192:195], v[96:99], v[80:83]
    ds_read_b64_tr_b16 v[188:189], v46 offset:15424
    ds_read_b64_tr_b16 v[190:191], v46 offset:16704
    s_waitcnt lgkmcnt(10)
    v_mfma_f32_16x16x32_bf16 v[84:87], v[196:199], v[96:99], v[84:87]
    ds_read_b64_tr_b16 v[192:193], v46 offset:15456
    ds_read_b64_tr_b16 v[194:195], v46 offset:16736
    s_waitcnt lgkmcnt(10)
    v_mfma_f32_16x16x32_bf16 v[60:63], v[200:203], v[52:55], v[60:63]
    ds_read_b64_tr_b16 v[196:197], v46 offset:15488
    ds_read_b64_tr_b16 v[198:199], v46 offset:16768
    s_waitcnt lgkmcnt(10)
    v_mfma_f32_16x16x32_bf16 v[64:67], v[204:207], v[52:55], v[64:67]
    ds_read_b64_tr_b16 v[200:201], v48 offset:15360
    ds_read_b64_tr_b16 v[202:203], v48 offset:16640
    s_waitcnt lgkmcnt(10)
    v_mfma_f32_16x16x32_bf16 v[68:71], v[180:183], v[100:103], v[68:71]
    ds_read_b64_tr_b16 v[204:205], v50 offset:15360
    ds_read_b64_tr_b16 v[206:207], v50 offset:16640
    s_waitcnt lgkmcnt(10)
    v_mfma_f32_16x16x32_bf16 v[72:75], v[184:187], v[100:103], v[72:75]
    s_waitcnt vmcnt(13)
    s_barrier
    ds_read_b64_tr_b16 v[180:181], v46 offset:20480
    ds_read_b64_tr_b16 v[182:183], v46 offset:21760
    s_waitcnt lgkmcnt(10)
    v_mfma_f32_16x16x32_bf16 v[76:79], v[188:191], v[100:103], v[76:79]
    ds_read_b64_tr_b16 v[184:185], v46 offset:20512
    ds_read_b64_tr_b16 v[186:187], v46 offset:21792
    s_waitcnt lgkmcnt(10)
    v_mfma_f32_16x16x32_bf16 v[80:83], v[192:195], v[100:103], v[80:83]
    ds_read_b64_tr_b16 v[188:189], v46 offset:20544
    ds_read_b64_tr_b16 v[190:191], v46 offset:21824
    s_waitcnt lgkmcnt(10)
    v_mfma_f32_16x16x32_bf16 v[84:87], v[196:199], v[100:103], v[84:87]
    ds_read_b64_tr_b16 v[192:193], v46 offset:20576
    ds_read_b64_tr_b16 v[194:195], v46 offset:21856
    s_waitcnt lgkmcnt(10)
    v_mfma_f32_16x16x32_bf16 v[60:63], v[200:203], v[52:55], v[60:63]
    ds_read_b64_tr_b16 v[196:197], v46 offset:20608
    ds_read_b64_tr_b16 v[198:199], v46 offset:21888
    s_waitcnt lgkmcnt(10)
    v_mfma_f32_16x16x32_bf16 v[64:67], v[204:207], v[52:55], v[64:67]
    ds_read_b64_tr_b16 v[200:201], v48 offset:20480
    ds_read_b64_tr_b16 v[202:203], v48 offset:21760
    s_waitcnt lgkmcnt(10)
    v_mfma_f32_16x16x32_bf16 v[68:71], v[180:183], v[104:107], v[68:71]
    ds_read_b64_tr_b16 v[204:205], v50 offset:20480
    ds_read_b64_tr_b16 v[206:207], v50 offset:21760
    s_waitcnt lgkmcnt(10)
    v_mfma_f32_16x16x32_bf16 v[72:75], v[184:187], v[104:107], v[72:75]
    ds_read_b64_tr_b16 v[180:181], v46 offset:25600
    ds_read_b64_tr_b16 v[182:183], v46 offset:26880
    s_waitcnt lgkmcnt(10)
    v_mfma_f32_16x16x32_bf16 v[76:79], v[188:191], v[104:107], v[76:79]
    ds_read_b64_tr_b16 v[184:185], v46 offset:25632
    ds_read_b64_tr_b16 v[186:187], v46 offset:26912
    s_waitcnt lgkmcnt(10)
    v_mfma_f32_16x16x32_bf16 v[80:83], v[192:195], v[104:107], v[80:83]
    ds_read_b64_tr_b16 v[188:189], v46 offset:25664
    ds_read_b64_tr_b16 v[190:191], v46 offset:26944
    s_waitcnt lgkmcnt(10)
    v_mfma_f32_16x16x32_bf16 v[84:87], v[196:199], v[104:107], v[84:87]
    ds_read_b64_tr_b16 v[192:193], v46 offset:25696
    ds_read_b64_tr_b16 v[194:195], v46 offset:26976
    s_waitcnt lgkmcnt(10)
    v_mfma_f32_16x16x32_bf16 v[60:63], v[200:203], v[52:55], v[60:63]
    ds_read_b64_tr_b16 v[196:197], v46 offset:25728
    ds_read_b64_tr_b16 v[198:199], v46 offset:27008
    s_waitcnt lgkmcnt(10)
    v_mfma_f32_16x16x32_bf16 v[64:67], v[204:207], v[52:55], v[64:67]
    ds_read_b64_tr_b16 v[200:201], v48 offset:25600
    ds_read_b64_tr_b16 v[202:203], v48 offset:26880
    s_waitcnt lgkmcnt(10)
    v_mfma_f32_16x16x32_bf16 v[68:71], v[180:183], v[108:111], v[68:71]
    ds_read_b64_tr_b16 v[204:205], v50 offset:25600
    ds_read_b64_tr_b16 v[206:207], v50 offset:26880
    s_waitcnt lgkmcnt(10)
    v_mfma_f32_16x16x32_bf16 v[72:75], v[184:187], v[108:111], v[72:75]
    ds_read_b64_tr_b16 v[180:181], v46 offset:30720
    ds_read_b64_tr_b16 v[182:183], v46 offset:32000
    s_waitcnt lgkmcnt(10)
    v_mfma_f32_16x16x32_bf16 v[76:79], v[188:191], v[108:111], v[76:79]
    ds_read_b64_tr_b16 v[184:185], v46 offset:30752
    ds_read_b64_tr_b16 v[186:187], v46 offset:32032
    s_waitcnt lgkmcnt(10)
    v_mfma_f32_16x16x32_bf16 v[80:83], v[192:195], v[108:111], v[80:83]
    ds_read_b64_tr_b16 v[188:189], v46 offset:30784
    ds_read_b64_tr_b16 v[190:191], v46 offset:32064
    s_waitcnt lgkmcnt(10)
    v_mfma_f32_16x16x32_bf16 v[84:87], v[196:199], v[108:111], v[84:87]
    ds_read_b64_tr_b16 v[192:193], v46 offset:30816
    ds_read_b64_tr_b16 v[194:195], v46 offset:32096
    s_waitcnt lgkmcnt(10)
    v_mfma_f32_16x16x32_bf16 v[60:63], v[200:203], v[52:55], v[60:63]
    ds_read_b64_tr_b16 v[196:197], v46 offset:30848
    ds_read_b64_tr_b16 v[198:199], v46 offset:32128
    s_waitcnt lgkmcnt(10)
    v_mfma_f32_16x16x32_bf16 v[64:67], v[204:207], v[52:55], v[64:67]
    ds_read_b64_tr_b16 v[200:201], v48 offset:30720
    ds_read_b64_tr_b16 v[202:203], v48 offset:32000
    s_waitcnt lgkmcnt(10)
    v_mfma_f32_16x16x32_bf16 v[68:71], v[180:183], v[112:115], v[68:71]
    ds_read_b64_tr_b16 v[204:205], v50 offset:30720
    ds_read_b64_tr_b16 v[206:207], v50 offset:32000
    s_waitcnt lgkmcnt(10)
    v_mfma_f32_16x16x32_bf16 v[72:75], v[184:187], v[112:115], v[72:75]
    ds_read_b64_tr_b16 v[180:181], v46 offset:35840
    ds_read_b64_tr_b16 v[182:183], v46 offset:37120
    s_waitcnt lgkmcnt(10)
    v_mfma_f32_16x16x32_bf16 v[76:79], v[188:191], v[112:115], v[76:79]
    ds_read_b64_tr_b16 v[184:185], v46 offset:35872
    ds_read_b64_tr_b16 v[186:187], v46 offset:37152
    s_waitcnt lgkmcnt(10)
    v_mfma_f32_16x16x32_bf16 v[80:83], v[192:195], v[112:115], v[80:83]
    ds_read_b64_tr_b16 v[188:189], v46 offset:35904
    ds_read_b64_tr_b16 v[190:191], v46 offset:37184
    s_waitcnt lgkmcnt(10)
    v_mfma_f32_16x16x32_bf16 v[84:87], v[196:199], v[112:115], v[84:87]
    ds_read_b64_tr_b16 v[192:193], v46 offset:35936
    ds_read_b64_tr_b16 v[194:195], v46 offset:37216
    s_waitcnt lgkmcnt(10)
    v_mfma_f32_16x16x32_bf16 v[60:63], v[200:203], v[52:55], v[60:63]
    ds_read_b64_tr_b16 v[196:197], v46 offset:35968
    ds_read_b64_tr_b16 v[198:199], v46 offset:37248
    s_waitcnt lgkmcnt(10)
    v_mfma_f32_16x16x32_bf16 v[64:67], v[204:207], v[52:55], v[64:67]
    ds_read_b64_tr_b16 v[200:201], v48 offset:35840
    ds_read_b64_tr_b16 v[202:203], v48 offset:37120
    s_waitcnt lgkmcnt(10)
    v_mfma_f32_16x16x32_bf16 v[68:71], v[180:183], v[116:119], v[68:71]
    ds_read_b64_tr_b16 v[204:205], v50 offset:35840
    ds_read_b64_tr_b16 v[206:207], v50 offset:37120
    s_waitcnt lgkmcnt(10)
    v_mfma_f32_16x16x32_bf16 v[72:75], v[184:187], v[116:119], v[72:75]
    s_waitcnt vmcnt(9)
    s_barrier
    ds_read_b64_tr_b16 v[180:181], v46 offset:40960
    ds_read_b64_tr_b16 v[182:183], v46 offset:42240
    s_waitcnt lgkmcnt(10)
    v_mfma_f32_16x16x32_bf16 v[76:79], v[188:191], v[116:119], v[76:79]
    s_mov_b32 s10, 0
    s_add_u32 m0, s8, 0
    s_nop 0
    buffer_load_dwordx4 v34, s[44:47], s10 offen lds
    ds_read_b64_tr_b16 v[184:185], v46 offset:40992
    ds_read_b64_tr_b16 v[186:187], v46 offset:42272
    s_waitcnt lgkmcnt(10)
    v_mfma_f32_16x16x32_bf16 v[80:83], v[192:195], v[116:119], v[80:83]
    s_mov_b32 s10, 0
    s_add_u32 m0, s8, 4096
    s_nop 0
    buffer_load_dwordx4 v35, s[44:47], s10 offen lds
    ds_read_b64_tr_b16 v[188:189], v46 offset:41024
    ds_read_b64_tr_b16 v[190:191], v46 offset:42304
    s_waitcnt lgkmcnt(10)
    v_mfma_f32_16x16x32_bf16 v[84:87], v[196:199], v[116:119], v[84:87]
    s_mov_b32 s10, 0
    s_add_u32 m0, s8, 8192
    s_nop 0
    buffer_load_dwordx4 v36, s[44:47], s10 offen lds
    ds_read_b64_tr_b16 v[192:193], v46 offset:41056
    ds_read_b64_tr_b16 v[194:195], v46 offset:42336
    s_waitcnt lgkmcnt(10)
    v_mfma_f32_16x16x32_bf16 v[60:63], v[200:203], v[52:55], v[60:63]
    s_mov_b32 s10, 0
    s_add_u32 m0, s8, 12288
    s_nop 0
    buffer_load_dwordx4 v37, s[44:47], s10 offen lds
    ds_read_b64_tr_b16 v[196:197], v46 offset:41088
    ds_read_b64_tr_b16 v[198:199], v46 offset:42368
    s_waitcnt lgkmcnt(10)
    v_mfma_f32_16x16x32_bf16 v[64:67], v[204:207], v[52:55], v[64:67]
    s_mov_b32 s10, 0
    s_add_u32 m0, s8, 16384
    s_nop 0
    buffer_load_dwordx4 v38, s[44:47], s10 offen lds
    ds_read_b64_tr_b16 v[200:201], v48 offset:40960
    ds_read_b64_tr_b16 v[202:203], v48 offset:42240
    s_waitcnt lgkmcnt(10)
    v_mfma_f32_16x16x32_bf16 v[68:71], v[180:183], v[120:123], v[68:71]
    ds_read_b64_tr_b16 v[204:205], v50 offset:40960
    ds_read_b64_tr_b16 v[206:207], v50 offset:42240
    s_waitcnt lgkmcnt(10)
    v_mfma_f32_16x16x32_bf16 v[72:75], v[184:187], v[120:123], v[72:75]
    ds_read_b64_tr_b16 v[180:181], v46 offset:46080
    ds_read_b64_tr_b16 v[182:183], v46 offset:47360
    s_waitcnt lgkmcnt(10)
    v_mfma_f32_16x16x32_bf16 v[76:79], v[188:191], v[120:123], v[76:79]
    ds_read_b64_tr_b16 v[184:185], v46 offset:46112
    ds_read_b64_tr_b16 v[186:187], v46 offset:47392
    s_waitcnt lgkmcnt(10)
    v_mfma_f32_16x16x32_bf16 v[80:83], v[192:195], v[120:123], v[80:83]
    ds_read_b64_tr_b16 v[188:189], v46 offset:46144
    ds_read_b64_tr_b16 v[190:191], v46 offset:47424
    s_waitcnt lgkmcnt(10)
    v_mfma_f32_16x16x32_bf16 v[84:87], v[196:199], v[120:123], v[84:87]
    ds_read_b64_tr_b16 v[192:193], v46 offset:46176
    ds_read_b64_tr_b16 v[194:195], v46 offset:47456
    s_waitcnt lgkmcnt(10)
    v_mfma_f32_16x16x32_bf16 v[60:63], v[200:203], v[52:55], v[60:63]
    ds_read_b64_tr_b16 v[196:197], v46 offset:46208
    ds_read_b64_tr_b16 v[198:199], v46 offset:47488
    s_waitcnt lgkmcnt(10)
    v_mfma_f32_16x16x32_bf16 v[64:67], v[204:207], v[52:55], v[64:67]
    ds_read_b64_tr_b16 v[200:201], v48 offset:46080
    ds_read_b64_tr_b16 v[202:203], v48 offset:47360
    s_waitcnt lgkmcnt(10)
    v_mfma_f32_16x16x32_bf16 v[68:71], v[180:183], v[124:127], v[68:71]
    ds_read_b64_tr_b16 v[204:205], v50 offset:46080
    ds_read_b64_tr_b16 v[206:207], v50 offset:47360
    s_waitcnt lgkmcnt(10)
    v_mfma_f32_16x16x32_bf16 v[72:75], v[184:187], v[124:127], v[72:75]
    ds_read_b64_tr_b16 v[180:181], v46 offset:51200
    ds_read_b64_tr_b16 v[182:183], v46 offset:52480
    s_waitcnt lgkmcnt(10)
    v_mfma_f32_16x16x32_bf16 v[76:79], v[188:191], v[124:127], v[76:79]
    ds_read_b64_tr_b16 v[184:185], v46 offset:51232
    ds_read_b64_tr_b16 v[186:187], v46 offset:52512
    s_waitcnt lgkmcnt(10)
    v_mfma_f32_16x16x32_bf16 v[80:83], v[192:195], v[124:127], v[80:83]
    ds_read_b64_tr_b16 v[188:189], v46 offset:51264
    ds_read_b64_tr_b16 v[190:191], v46 offset:52544
    s_waitcnt lgkmcnt(10)
    v_mfma_f32_16x16x32_bf16 v[84:87], v[196:199], v[124:127], v[84:87]
    ds_read_b64_tr_b16 v[192:193], v46 offset:51296
    ds_read_b64_tr_b16 v[194:195], v46 offset:52576
    s_waitcnt lgkmcnt(10)
    v_mfma_f32_16x16x32_bf16 v[60:63], v[200:203], v[52:55], v[60:63]
    ds_read_b64_tr_b16 v[196:197], v46 offset:51328
    ds_read_b64_tr_b16 v[198:199], v46 offset:52608
    s_waitcnt lgkmcnt(10)
    v_mfma_f32_16x16x32_bf16 v[64:67], v[204:207], v[52:55], v[64:67]
    ds_read_b64_tr_b16 v[200:201], v48 offset:51200
    ds_read_b64_tr_b16 v[202:203], v48 offset:52480
    s_waitcnt lgkmcnt(10)
    v_mfma_f32_16x16x32_bf16 v[68:71], v[180:183], v[128:131], v[68:71]
    ds_read_b64_tr_b16 v[204:205], v50 offset:51200
    ds_read_b64_tr_b16 v[206:207], v50 offset:52480
    s_waitcnt lgkmcnt(10)
    v_mfma_f32_16x16x32_bf16 v[72:75], v[184:187], v[128:131], v[72:75]
    ds_read_b64_tr_b16 v[180:181], v46 offset:56320
    ds_read_b64_tr_b16 v[182:183], v46 offset:57600
    s_waitcnt lgkmcnt(10)
    v_mfma_f32_16x16x32_bf16 v[76:79], v[188:191], v[128:131], v[76:79]
    ds_read_b64_tr_b16 v[184:185], v46 offset:56352
    ds_read_b64_tr_b16 v[186:187], v46 offset:57632
    s_waitcnt lgkmcnt(10)
    v_mfma_f32_16x16x32_bf16 v[80:83], v[192:195], v[128:131], v[80:83]
    ds_read_b64_tr_b16 v[188:189], v46 offset:56384
    ds_read_b64_tr_b16 v[190:191], v46 offset:57664
    s_waitcnt lgkmcnt(10)
    v_mfma_f32_16x16x32_bf16 v[84:87], v[196:199], v[128:131], v[84:87]
    ds_read_b64_tr_b16 v[192:193], v46 offset:56416
    ds_read_b64_tr_b16 v[194:195], v46 offset:57696
    s_waitcnt lgkmcnt(10)
    v_mfma_f32_16x16x32_bf16 v[60:63], v[200:203], v[52:55], v[60:63]
    ds_read_b64_tr_b16 v[196:197], v46 offset:56448
    ds_read_b64_tr_b16 v[198:199], v46 offset:57728
    s_waitcnt lgkmcnt(10)
    v_mfma_f32_16x16x32_bf16 v[64:67], v[204:207], v[52:55], v[64:67]
    ds_read_b64_tr_b16 v[200:201], v48 offset:56320
    ds_read_b64_tr_b16 v[202:203], v48 offset:57600
    s_waitcnt lgkmcnt(10)
    v_mfma_f32_16x16x32_bf16 v[68:71], v[180:183], v[132:135], v[68:71]
    ds_read_b64_tr_b16 v[204:205], v50 offset:56320
    ds_read_b64_tr_b16 v[206:207], v50 offset:57600
    s_waitcnt lgkmcnt(10)
    v_mfma_f32_16x16x32_bf16 v[72:75], v[184:187], v[132:135], v[72:75]
    s_waitcnt vmcnt(10)
    s_barrier
    ds_read_b64_tr_b16 v[180:181], v46 offset:61440
    ds_read_b64_tr_b16 v[182:183], v46 offset:62720
    s_waitcnt lgkmcnt(10)
    v_mfma_f32_16x16x32_bf16 v[76:79], v[188:191], v[132:135], v[76:79]
    s_mov_b32 s10, 163840
    s_add_u32 m0, s8, 20480
    s_nop 0
    buffer_load_dwordx4 v34, s[44:47], s10 offen lds
    ds_read_b64_tr_b16 v[184:185], v46 offset:61472
    ds_read_b64_tr_b16 v[186:187], v46 offset:62752
    s_waitcnt lgkmcnt(10)
    v_mfma_f32_16x16x32_bf16 v[80:83], v[192:195], v[132:135], v[80:83]
    s_mov_b32 s10, 163840
    s_add_u32 m0, s8, 24576
    s_nop 0
    buffer_load_dwordx4 v35, s[44:47], s10 offen lds
    ds_read_b64_tr_b16 v[188:189], v46 offset:61504
    ds_read_b64_tr_b16 v[190:191], v46 offset:62784
    s_waitcnt lgkmcnt(10)
    v_mfma_f32_16x16x32_bf16 v[84:87], v[196:199], v[132:135], v[84:87]
    s_mov_b32 s10, 163840
    s_add_u32 m0, s8, 28672
    s_nop 0
    buffer_load_dwordx4 v36, s[44:47], s10 offen lds
    ds_read_b64_tr_b16 v[192:193], v46 offset:61536
    ds_read_b64_tr_b16 v[194:195], v46 offset:62816
    s_waitcnt lgkmcnt(10)
    v_mfma_f32_16x16x32_bf16 v[60:63], v[200:203], v[52:55], v[60:63]
    s_mov_b32 s10, 163840
    s_add_u32 m0, s8, 32768
    s_nop 0
    buffer_load_dwordx4 v37, s[44:47], s10 offen lds
    ds_read_b64_tr_b16 v[196:197], v46 offset:61568
    ds_read_b64_tr_b16 v[198:199], v46 offset:62848
    s_waitcnt lgkmcnt(10)
    v_mfma_f32_16x16x32_bf16 v[64:67], v[204:207], v[52:55], v[64:67]
    s_mov_b32 s10, 163840
    s_add_u32 m0, s8, 36864
    s_nop 0
    buffer_load_dwordx4 v38, s[44:47], s10 offen lds
    ds_read_b64_tr_b16 v[200:201], v48 offset:61440
    ds_read_b64_tr_b16 v[202:203], v48 offset:62720
    s_waitcnt lgkmcnt(10)
    v_mfma_f32_16x16x32_bf16 v[68:71], v[180:183], v[136:139], v[68:71]
    ds_read_b64_tr_b16 v[204:205], v50 offset:61440
    ds_read_b64_tr_b16 v[206:207], v50 offset:62720
    s_waitcnt lgkmcnt(10)
    v_mfma_f32_16x16x32_bf16 v[72:75], v[184:187], v[136:139], v[72:75]
    ds_read_b64_tr_b16 v[180:181], v47 offset:1024
    ds_read_b64_tr_b16 v[182:183], v47 offset:2304
    s_waitcnt lgkmcnt(10)
    v_mfma_f32_16x16x32_bf16 v[76:79], v[188:191], v[136:139], v[76:79]
    ds_read_b64_tr_b16 v[184:185], v47 offset:1056
    ds_read_b64_tr_b16 v[186:187], v47 offset:2336
    s_waitcnt lgkmcnt(10)
    v_mfma_f32_16x16x32_bf16 v[80:83], v[192:195], v[136:139], v[80:83]
    ds_read_b64_tr_b16 v[188:189], v47 offset:1088
    ds_read_b64_tr_b16 v[190:191], v47 offset:2368
    s_waitcnt lgkmcnt(10)
    v_mfma_f32_16x16x32_bf16 v[84:87], v[196:199], v[136:139], v[84:87]
    ds_read_b64_tr_b16 v[192:193], v47 offset:1120
    ds_read_b64_tr_b16 v[194:195], v47 offset:2400
    s_waitcnt lgkmcnt(10)
    v_mfma_f32_16x16x32_bf16 v[60:63], v[200:203], v[52:55], v[60:63]
    ds_read_b64_tr_b16 v[196:197], v47 offset:1152
    ds_read_b64_tr_b16 v[198:199], v47 offset:2432
    s_waitcnt lgkmcnt(10)
    v_mfma_f32_16x16x32_bf16 v[64:67], v[204:207], v[52:55], v[64:67]
    ds_read_b64_tr_b16 v[200:201], v49 offset:1024
    ds_read_b64_tr_b16 v[202:203], v49 offset:2304
    s_waitcnt lgkmcnt(10)
    v_mfma_f32_16x16x32_bf16 v[68:71], v[180:183], v[140:143], v[68:71]
    ds_read_b64_tr_b16 v[204:205], v51 offset:1024
    ds_read_b64_tr_b16 v[206:207], v51 offset:2304
    s_waitcnt lgkmcnt(10)
    v_mfma_f32_16x16x32_bf16 v[72:75], v[184:187], v[140:143], v[72:75]
    ds_read_b64_tr_b16 v[180:181], v47 offset:6144
    ds_read_b64_tr_b16 v[182:183], v47 offset:7424
    s_waitcnt lgkmcnt(10)
    v_mfma_f32_16x16x32_bf16 v[76:79], v[188:191], v[140:143], v[76:79]
    ds_read_b64_tr_b16 v[184:185], v47 offset:6176
    ds_read_b64_tr_b16 v[186:187], v47 offset:7456
    s_waitcnt lgkmcnt(10)
    v_mfma_f32_16x16x32_bf16 v[80:83], v[192:195], v[140:143], v[80:83]
    ds_read_b64_tr_b16 v[188:189], v47 offset:6208
    ds_read_b64_tr_b16 v[190:191], v47 offset:7488
    s_waitcnt lgkmcnt(10)
    v_mfma_f32_16x16x32_bf16 v[84:87], v[196:199], v[140:143], v[84:87]
    ds_read_b64_tr_b16 v[192:193], v47 offset:6240
    ds_read_b64_tr_b16 v[194:195], v47 offset:7520
    s_waitcnt lgkmcnt(10)
    v_mfma_f32_16x16x32_bf16 v[60:63], v[200:203], v[52:55], v[60:63]
    ds_read_b64_tr_b16 v[196:197], v47 offset:6272
    ds_read_b64_tr_b16 v[198:199], v47 offset:7552
    s_waitcnt lgkmcnt(10)
    v_mfma_f32_16x16x32_bf16 v[64:67], v[204:207], v[52:55], v[64:67]
    ds_read_b64_tr_b16 v[200:201], v49 offset:6144
    ds_read_b64_tr_b16 v[202:203], v49 offset:7424
    s_waitcnt lgkmcnt(10)
    v_mfma_f32_16x16x32_bf16 v[68:71], v[180:183], v[144:147], v[68:71]
    ds_read_b64_tr_b16 v[204:205], v51 offset:6144
    ds_read_b64_tr_b16 v[206:207], v51 offset:7424
    s_waitcnt lgkmcnt(10)
    v_mfma_f32_16x16x32_bf16 v[72:75], v[184:187], v[144:147], v[72:75]
    ds_read_b64_tr_b16 v[180:181], v47 offset:11264
    ds_read_b64_tr_b16 v[182:183], v47 offset:12544
    s_waitcnt lgkmcnt(10)
    v_mfma_f32_16x16x32_bf16 v[76:79], v[188:191], v[144:147], v[76:79]
    ds_read_b64_tr_b16 v[184:185], v47 offset:11296
    ds_read_b64_tr_b16 v[186:187], v47 offset:12576
    s_waitcnt lgkmcnt(10)
    v_mfma_f32_16x16x32_bf16 v[80:83], v[192:195], v[144:147], v[80:83]
    ds_read_b64_tr_b16 v[188:189], v47 offset:11328
    ds_read_b64_tr_b16 v[190:191], v47 offset:12608
    s_waitcnt lgkmcnt(10)
    v_mfma_f32_16x16x32_bf16 v[84:87], v[196:199], v[144:147], v[84:87]
    ds_read_b64_tr_b16 v[192:193], v47 offset:11360
    ds_read_b64_tr_b16 v[194:195], v47 offset:12640
    s_waitcnt lgkmcnt(10)
    v_mfma_f32_16x16x32_bf16 v[60:63], v[200:203], v[52:55], v[60:63]
    ds_read_b64_tr_b16 v[196:197], v47 offset:11392
    ds_read_b64_tr_b16 v[198:199], v47 offset:12672
    s_waitcnt lgkmcnt(10)
    v_mfma_f32_16x16x32_bf16 v[64:67], v[204:207], v[52:55], v[64:67]
    ds_read_b64_tr_b16 v[200:201], v49 offset:11264
    ds_read_b64_tr_b16 v[202:203], v49 offset:12544
    s_waitcnt lgkmcnt(10)
    v_mfma_f32_16x16x32_bf16 v[68:71], v[180:183], v[148:151], v[68:71]
    ds_read_b64_tr_b16 v[204:205], v51 offset:11264
    ds_read_b64_tr_b16 v[206:207], v51 offset:12544
    s_waitcnt lgkmcnt(10)
    v_mfma_f32_16x16x32_bf16 v[72:75], v[184:187], v[148:151], v[72:75]
    s_waitcnt vmcnt(11)
    s_barrier
    ds_read_b64_tr_b16 v[180:181], v47 offset:16384
    ds_read_b64_tr_b16 v[182:183], v47 offset:17664
    s_waitcnt lgkmcnt(10)
    v_mfma_f32_16x16x32_bf16 v[76:79], v[188:191], v[148:151], v[76:79]
    s_mov_b32 s10, 327680
    s_add_u32 m0, s8, 40960
    s_nop 0
    buffer_load_dwordx4 v34, s[44:47], s10 offen lds
    ds_read_b64_tr_b16 v[184:185], v47 offset:16416
    ds_read_b64_tr_b16 v[186:187], v47 offset:17696
    s_waitcnt lgkmcnt(10)
    v_mfma_f32_16x16x32_bf16 v[80:83], v[192:195], v[148:151], v[80:83]
    s_mov_b32 s10, 327680
    s_add_u32 m0, s8, 45056
    s_nop 0
    buffer_load_dwordx4 v35, s[44:47], s10 offen lds
    ds_read_b64_tr_b16 v[188:189], v47 offset:16448
    ds_read_b64_tr_b16 v[190:191], v47 offset:17728
    s_waitcnt lgkmcnt(10)
    v_mfma_f32_16x16x32_bf16 v[84:87], v[196:199], v[148:151], v[84:87]
    s_mov_b32 s10, 327680
    s_add_u32 m0, s8, 49152
    s_nop 0
    buffer_load_dwordx4 v36, s[44:47], s10 offen lds
    ds_read_b64_tr_b16 v[192:193], v47 offset:16480
    ds_read_b64_tr_b16 v[194:195], v47 offset:17760
    s_waitcnt lgkmcnt(10)
    v_mfma_f32_16x16x32_bf16 v[60:63], v[200:203], v[52:55], v[60:63]
    s_mov_b32 s10, 327680
    s_add_u32 m0, s8, 53248
    s_nop 0
    buffer_load_dwordx4 v37, s[44:47], s10 offen lds
    ds_read_b64_tr_b16 v[196:197], v47 offset:16512
    ds_read_b64_tr_b16 v[198:199], v47 offset:17792
    s_waitcnt lgkmcnt(10)
    v_mfma_f32_16x16x32_bf16 v[64:67], v[204:207], v[52:55], v[64:67]
    s_mov_b32 s10, 327680
    s_add_u32 m0, s8, 57344
    s_nop 0
    buffer_load_dwordx4 v38, s[44:47], s10 offen lds
    ds_read_b64_tr_b16 v[200:201], v49 offset:16384
    ds_read_b64_tr_b16 v[202:203], v49 offset:17664
    s_waitcnt lgkmcnt(10)
    v_mfma_f32_16x16x32_bf16 v[68:71], v[180:183], v[152:155], v[68:71]
    ds_read_b64_tr_b16 v[204:205], v51 offset:16384
    ds_read_b64_tr_b16 v[206:207], v51 offset:17664
    s_waitcnt lgkmcnt(10)
    v_mfma_f32_16x16x32_bf16 v[72:75], v[184:187], v[152:155], v[72:75]
    ds_read_b64_tr_b16 v[180:181], v47 offset:21504
    ds_read_b64_tr_b16 v[182:183], v47 offset:22784
    s_waitcnt lgkmcnt(10)
    v_mfma_f32_16x16x32_bf16 v[76:79], v[188:191], v[152:155], v[76:79]
    ds_read_b64_tr_b16 v[184:185], v47 offset:21536
    ds_read_b64_tr_b16 v[186:187], v47 offset:22816
    s_waitcnt lgkmcnt(10)
    v_mfma_f32_16x16x32_bf16 v[80:83], v[192:195], v[152:155], v[80:83]
    ds_read_b64_tr_b16 v[188:189], v47 offset:21568
    ds_read_b64_tr_b16 v[190:191], v47 offset:22848
    s_waitcnt lgkmcnt(10)
    v_mfma_f32_16x16x32_bf16 v[84:87], v[196:199], v[152:155], v[84:87]
    ds_read_b64_tr_b16 v[192:193], v47 offset:21600
    ds_read_b64_tr_b16 v[194:195], v47 offset:22880
    s_waitcnt lgkmcnt(10)
    v_mfma_f32_16x16x32_bf16 v[60:63], v[200:203], v[52:55], v[60:63]
    ds_read_b64_tr_b16 v[196:197], v47 offset:21632
    ds_read_b64_tr_b16 v[198:199], v47 offset:22912
    s_waitcnt lgkmcnt(10)
    v_mfma_f32_16x16x32_bf16 v[64:67], v[204:207], v[52:55], v[64:67]
    ds_read_b64_tr_b16 v[200:201], v49 offset:21504
    ds_read_b64_tr_b16 v[202:203], v49 offset:22784
    s_waitcnt lgkmcnt(10)
    v_mfma_f32_16x16x32_bf16 v[68:71], v[180:183], v[156:159], v[68:71]
    ds_read_b64_tr_b16 v[204:205], v51 offset:21504
    ds_read_b64_tr_b16 v[206:207], v51 offset:22784
    s_waitcnt lgkmcnt(10)
    v_mfma_f32_16x16x32_bf16 v[72:75], v[184:187], v[156:159], v[72:75]
    ds_read_b64_tr_b16 v[180:181], v47 offset:26624
    ds_read_b64_tr_b16 v[182:183], v47 offset:27904
    s_waitcnt lgkmcnt(10)
    v_mfma_f32_16x16x32_bf16 v[76:79], v[188:191], v[156:159], v[76:79]
    ds_read_b64_tr_b16 v[184:185], v47 offset:26656
    ds_read_b64_tr_b16 v[186:187], v47 offset:27936
    s_waitcnt lgkmcnt(10)
    v_mfma_f32_16x16x32_bf16 v[80:83], v[192:195], v[156:159], v[80:83]
    ds_read_b64_tr_b16 v[188:189], v47 offset:26688
    ds_read_b64_tr_b16 v[190:191], v47 offset:27968
    s_waitcnt lgkmcnt(10)
    v_mfma_f32_16x16x32_bf16 v[84:87], v[196:199], v[156:159], v[84:87]
    ds_read_b64_tr_b16 v[192:193], v47 offset:26720
    ds_read_b64_tr_b16 v[194:195], v47 offset:28000
    s_waitcnt lgkmcnt(10)
    v_mfma_f32_16x16x32_bf16 v[60:63], v[200:203], v[52:55], v[60:63]
    ds_read_b64_tr_b16 v[196:197], v47 offset:26752
    ds_read_b64_tr_b16 v[198:199], v47 offset:28032
    s_waitcnt lgkmcnt(10)
    v_mfma_f32_16x16x32_bf16 v[64:67], v[204:207], v[52:55], v[64:67]
    ds_read_b64_tr_b16 v[200:201], v49 offset:26624
    ds_read_b64_tr_b16 v[202:203], v49 offset:27904
    s_waitcnt lgkmcnt(10)
    v_mfma_f32_16x16x32_bf16 v[68:71], v[180:183], v[160:163], v[68:71]
    ds_read_b64_tr_b16 v[204:205], v51 offset:26624
    ds_read_b64_tr_b16 v[206:207], v51 offset:27904
    s_waitcnt lgkmcnt(10)
    v_mfma_f32_16x16x32_bf16 v[72:75], v[184:187], v[160:163], v[72:75]
    ds_read_b64_tr_b16 v[180:181], v47 offset:31744
    ds_read_b64_tr_b16 v[182:183], v47 offset:33024
    s_waitcnt lgkmcnt(10)
    v_mfma_f32_16x16x32_bf16 v[76:79], v[188:191], v[160:163], v[76:79]
    ds_read_b64_tr_b16 v[184:185], v47 offset:31776
    ds_read_b64_tr_b16 v[186:187], v47 offset:33056
    s_waitcnt lgkmcnt(10)
    v_mfma_f32_16x16x32_bf16 v[80:83], v[192:195], v[160:163], v[80:83]
    ds_read_b64_tr_b16 v[188:189], v47 offset:31808
    ds_read_b64_tr_b16 v[190:191], v47 offset:33088
    s_waitcnt lgkmcnt(10)
    v_mfma_f32_16x16x32_bf16 v[84:87], v[196:199], v[160:163], v[84:87]
    ds_read_b64_tr_b16 v[192:193], v47 offset:31840
    ds_read_b64_tr_b16 v[194:195], v47 offset:33120
    s_waitcnt lgkmcnt(10)
    v_mfma_f32_16x16x32_bf16 v[60:63], v[200:203], v[52:55], v[60:63]
    ds_read_b64_tr_b16 v[196:197], v47 offset:31872
    ds_read_b64_tr_b16 v[198:199], v47 offset:33152
    s_waitcnt lgkmcnt(10)
    v_mfma_f32_16x16x32_bf16 v[64:67], v[204:207], v[52:55], v[64:67]
    ds_read_b64_tr_b16 v[200:201], v49 offset:31744
    ds_read_b64_tr_b16 v[202:203], v49 offset:33024
    s_waitcnt lgkmcnt(10)
    v_mfma_f32_16x16x32_bf16 v[68:71], v[180:183], v[164:167], v[68:71]
    ds_read_b64_tr_b16 v[204:205], v51 offset:31744
    ds_read_b64_tr_b16 v[206:207], v51 offset:33024
    s_waitcnt lgkmcnt(10)
    v_mfma_f32_16x16x32_bf16 v[72:75], v[184:187], v[164:167], v[72:75]
    s_waitcnt lgkmcnt(8)
    v_mfma_f32_16x16x32_bf16 v[76:79], v[188:191], v[164:167], v[76:79]
    s_waitcnt lgkmcnt(6)
    v_mfma_f32_16x16x32_bf16 v[80:83], v[192:195], v[164:167], v[80:83]
    s_waitcnt lgkmcnt(4)
    v_mfma_f32_16x16x32_bf16 v[84:87], v[196:199], v[164:167], v[84:87]
    s_waitcnt lgkmcnt(2)
    v_mfma_f32_16x16x32_bf16 v[60:63], v[200:203], v[52:55], v[60:63]
    s_waitcnt lgkmcnt(0)
    v_mfma_f32_16x16x32_bf16 v[64:67], v[204:207], v[52:55], v[64:67]
    s_nop 7
    s_nop 1
    s_barrier
    v_lshlrev_b32 v8, 4, v4
    v_add_u32 v8, 147456, v8
    s_add_u32 s9, s7, 0
    s_min_u32 s9, s9, 4
    s_lshl_b32 s9, s9, 6
    v_add_u32 v9, s9, v8
    ds_write_b128 v9, v[60:63]
    s_add_u32 s9, s7, 4
    s_min_u32 s9, s9, 4
    s_lshl_b32 s9, s9, 6
    v_add_u32 v9, s9, v8
    ds_write_b128 v9, v[64:67]
    v_add_f32 v56, v168, v170
    v_add_f32 v57, v169, v171
    v_mov_b32 v10, v56
    s_nop 1
    v_permlane16_swap_b32 v56, v10
    s_nop 1
    v_add_f32 v56, v56, v10
    v_mov_b32 v10, v56
    s_nop 1
    v_permlane32_swap_b32 v56, v10
    s_nop 1
    v_add_f32 v56, v56, v10
    v_mov_b32 v10, v57
    s_nop 1
    v_permlane16_swap_b32 v57, v10
    s_nop 1
    v_add_f32 v57, v57, v10
    v_mov_b32 v10, v57
    s_nop 1
    v_permlane32_swap_b32 v57, v10
    s_nop 1
    v_add_f32 v57, v57, v10
    s_waitcnt lgkmcnt(0)
    s_barrier
    ds_read_b128 v[180:183], v8 offset:0
    ds_read_b128 v[184:187], v8 offset:64
    ds_read_b128 v[188:191], v8 offset:128
    ds_read_b128 v[192:195], v8 offset:192
    ds_read_b128 v[196:199], v8 offset:256
    s_mov_b32 s9, 0x3acccccd
    v_mul_f32 v56, s9, v56
    v_mul_f32 v57, s9, v57
    v_fma_f32 v57, -v56, v56, v57
    v_max_f32 v57, 0, v57
    s_mov_b32 s9, 0x3727c5ac
    v_cvt_pk_bf16_f32 v208, v56, v56
    v_lshlrev_b32 v208, 16, v208
    v_cvt_pk_bf16_f32 v209, v57, v57
    v_lshlrev_b32 v209, 16, v209
    v_add_f32 v209, s9, v209
    v_cvt_pk_bf16_f32 v209, v209, v209
    v_lshlrev_b32 v209, 16, v209
    v_sqrt_f32 v209, v209
    s_nop 0
    v_cvt_pk_bf16_f32 v209, v209, v209
    v_lshlrev_b32 v209, 16, v209
    v_rcp_f32 v210, v209
    s_nop 0
    v_mul_f32 v211, v208, v210
    v_sub_f32 v211, 0, v211
    v_sub_f32 v10, v56, v208
    v_mul_f32 v10, v10, v210
    v_mul_f32 v11, v57, v210
    v_mul_f32 v11, v11, v210
    v_cvt_pk_bf16_f32 v212, v10, v10
    v_lshlrev_b32 v212, 16, v212
    v_cvt_pk_bf16_f32 v213, v11, v11
    v_lshlrev_b32 v213, 16, v213
    v_add_f32 v213, s9, v213
    v_cvt_pk_bf16_f32 v213, v213, v213
    v_lshlrev_b32 v213, 16, v213
    v_sqrt_f32 v213, v213
    s_nop 0
    v_cvt_pk_bf16_f32 v213, v213, v213
    v_lshlrev_b32 v213, 16, v213
    v_rcp_f32 v213, v213
    s_nop 0
    v_sub_f32 v211, v211, v212
    v_mul_f32 v211, v211, v213
    v_mul_f32 v210, v210, v213
    s_waitcnt lgkmcnt(0)
    v_mov_b32 v8, v210
    v_mov_b32 v9, v210
    v_mov_b32 v10, v211
    v_mov_b32 v11, v211
    v_pk_mul_f32 v[68:69], v[68:69], v[8:9]
    v_pk_fma_f32 v[68:69], v[180:181], v[10:11], v[68:69]
    v_pk_mul_f32 v[70:71], v[70:71], v[8:9]
    v_pk_fma_f32 v[70:71], v[182:183], v[10:11], v[70:71]
    v_pk_mul_f32 v[72:73], v[72:73], v[8:9]
    v_pk_fma_f32 v[72:73], v[184:185], v[10:11], v[72:73]
    v_pk_mul_f32 v[74:75], v[74:75], v[8:9]
    v_pk_fma_f32 v[74:75], v[186:187], v[10:11], v[74:75]
    v_pk_mul_f32 v[76:77], v[76:77], v[8:9]
    v_pk_fma_f32 v[76:77], v[188:189], v[10:11], v[76:77]
    v_pk_mul_f32 v[78:79], v[78:79], v[8:9]
    v_pk_fma_f32 v[78:79], v[190:191], v[10:11], v[78:79]
    v_pk_mul_f32 v[80:81], v[80:81], v[8:9]
    v_pk_fma_f32 v[80:81], v[192:193], v[10:11], v[80:81]
    v_pk_mul_f32 v[82:83], v[82:83], v[8:9]
    v_pk_fma_f32 v[82:83], v[194:195], v[10:11], v[82:83]
    v_pk_mul_f32 v[84:85], v[84:85], v[8:9]
    v_pk_fma_f32 v[84:85], v[196:197], v[10:11], v[84:85]
    v_pk_mul_f32 v[86:87], v[86:87], v[8:9]
    v_pk_fma_f32 v[86:87], v[198:199], v[10:11], v[86:87]
    v_cvt_pk_bf16_f32 v8, v68, v69
    v_cvt_pk_bf16_f32 v9, v70, v71
    v_lshlrev_b32 v68, 16, v8
    v_and_b32 v69, 0xffff0000, v8
    v_lshlrev_b32 v70, 16, v9
    v_and_b32 v71, 0xffff0000, v9
    v_pk_mul_f32 v[8:9], v[68:69], v[68:69]
    v_pk_mul_f32 v[10:11], v[70:71], v[70:71]
    v_pk_fma_f32 v[8:9], v[8:9], v[176:177], v[174:175]
    v_pk_fma_f32 v[10:11], v[10:11], v[176:177], v[174:175]
    v_pk_mul_f32 v[8:9], v[8:9], v[68:69]
    v_pk_mul_f32 v[10:11], v[10:11], v[70:71]
    v_exp_f32 v8, v8
    v_exp_f32 v9, v9
    v_exp_f32 v10, v10
    v_exp_f32 v11, v11
    s_nop 0
    v_pk_add_f32 v[8:9], v[8:9], v[178:179]
    v_pk_add_f32 v[10:11], v[10:11], v[178:179]
    v_rcp_f32 v8, v8
    v_rcp_f32 v9, v9
    v_rcp_f32 v10, v10
    v_rcp_f32 v11, v11
    s_nop 0
    v_pk_mul_f32 v[68:69], v[68:69], v[8:9]
    v_pk_mul_f32 v[70:71], v[70:71], v[10:11]
    v_cvt_pk_bf16_f32 v68, v68, v69
    v_cvt_pk_bf16_f32 v69, v70, v71
    buffer_store_dwordx2 v[68:69], v172, s[48:51], 0 offen offset:0 sc1
    v_cvt_pk_bf16_f32 v8, v72, v73
    v_cvt_pk_bf16_f32 v9, v74, v75
    v_lshlrev_b32 v72, 16, v8
    v_and_b32 v73, 0xffff0000, v8
    v_lshlrev_b32 v74, 16, v9
    v_and_b32 v75, 0xffff0000, v9
    v_pk_mul_f32 v[8:9], v[72:73], v[72:73]
    v_pk_mul_f32 v[10:11], v[74:75], v[74:75]
    v_pk_fma_f32 v[8:9], v[8:9], v[176:177], v[174:175]
    v_pk_fma_f32 v[10:11], v[10:11], v[176:177], v[174:175]
    v_pk_mul_f32 v[8:9], v[8:9], v[72:73]
    v_pk_mul_f32 v[10:11], v[10:11], v[74:75]
    v_exp_f32 v8, v8
    v_exp_f32 v9, v9
    v_exp_f32 v10, v10
    v_exp_f32 v11, v11
    s_nop 0
    v_pk_add_f32 v[8:9], v[8:9], v[178:179]
    v_pk_add_f32 v[10:11], v[10:11], v[178:179]
    v_rcp_f32 v8, v8
    v_rcp_f32 v9, v9
    v_rcp_f32 v10, v10
    v_rcp_f32 v11, v11
    s_nop 0
    v_pk_mul_f32 v[72:73], v[72:73], v[8:9]
    v_pk_mul_f32 v[74:75], v[74:75], v[10:11]
    v_cvt_pk_bf16_f32 v72, v72, v73
    v_cvt_pk_bf16_f32 v73, v74, v75
    buffer_store_dwordx2 v[72:73], v172, s[48:51], 0 offen offset:512 sc1
    v_cvt_pk_bf16_f32 v8, v76, v77
    v_cvt_pk_bf16_f32 v9, v78, v79
    v_lshlrev_b32 v76, 16, v8
    v_and_b32 v77, 0xffff0000, v8
    v_lshlrev_b32 v78, 16, v9
    v_and_b32 v79, 0xffff0000, v9
    v_pk_mul_f32 v[8:9], v[76:77], v[76:77]
    v_pk_mul_f32 v[10:11], v[78:79], v[78:79]
    v_pk_fma_f32 v[8:9], v[8:9], v[176:177], v[174:175]
    v_pk_fma_f32 v[10:11], v[10:11], v[176:177], v[174:175]
    v_pk_mul_f32 v[8:9], v[8:9], v[76:77]
    v_pk_mul_f32 v[10:11], v[10:11], v[78:79]
    v_exp_f32 v8, v8
    v_exp_f32 v9, v9
    v_exp_f32 v10, v10
    v_exp_f32 v11, v11
    s_nop 0
    v_pk_add_f32 v[8:9], v[8:9], v[178:179]
    v_pk_add_f32 v[10:11], v[10:11], v[178:179]
    v_rcp_f32 v8, v8
    v_rcp_f32 v9, v9
    v_rcp_f32 v10, v10
    v_rcp_f32 v11, v11
    s_nop 0
    v_pk_mul_f32 v[76:77], v[76:77], v[8:9]
    v_pk_mul_f32 v[78:79], v[78:79], v[10:11]
    v_cvt_pk_bf16_f32 v76, v76, v77
    v_cvt_pk_bf16_f32 v77, v78, v79
    buffer_store_dwordx2 v[76:77], v172, s[48:51], 0 offen offset:1024 sc1
    v_cvt_pk_bf16_f32 v8, v80, v81
    v_cvt_pk_bf16_f32 v9, v82, v83
    v_lshlrev_b32 v80, 16, v8
    v_and_b32 v81, 0xffff0000, v8
    v_lshlrev_b32 v82, 16, v9
    v_and_b32 v83, 0xffff0000, v9
    v_pk_mul_f32 v[8:9], v[80:81], v[80:81]
    v_pk_mul_f32 v[10:11], v[82:83], v[82:83]
    v_pk_fma_f32 v[8:9], v[8:9], v[176:177], v[174:175]
    v_pk_fma_f32 v[10:11], v[10:11], v[176:177], v[174:175]
    v_pk_mul_f32 v[8:9], v[8:9], v[80:81]
    v_pk_mul_f32 v[10:11], v[10:11], v[82:83]
    v_exp_f32 v8, v8
    v_exp_f32 v9, v9
    v_exp_f32 v10, v10
    v_exp_f32 v11, v11
    s_nop 0
    v_pk_add_f32 v[8:9], v[8:9], v[178:179]
    v_pk_add_f32 v[10:11], v[10:11], v[178:179]
    v_rcp_f32 v8, v8
    v_rcp_f32 v9, v9
    v_rcp_f32 v10, v10
    v_rcp_f32 v11, v11
    s_nop 0
    v_pk_mul_f32 v[80:81], v[80:81], v[8:9]
    v_pk_mul_f32 v[82:83], v[82:83], v[10:11]
    v_cvt_pk_bf16_f32 v80, v80, v81
    v_cvt_pk_bf16_f32 v81, v82, v83
    buffer_store_dwordx2 v[80:81], v172, s[48:51], 0 offen offset:1536 sc1
    v_cvt_pk_bf16_f32 v8, v84, v85
    v_cvt_pk_bf16_f32 v9, v86, v87
    v_lshlrev_b32 v84, 16, v8
    v_and_b32 v85, 0xffff0000, v8
    v_lshlrev_b32 v86, 16, v9
    v_and_b32 v87, 0xffff0000, v9
    v_pk_mul_f32 v[8:9], v[84:85], v[84:85]
    v_pk_mul_f32 v[10:11], v[86:87], v[86:87]
    v_pk_fma_f32 v[8:9], v[8:9], v[176:177], v[174:175]
    v_pk_fma_f32 v[10:11], v[10:11], v[176:177], v[174:175]
    v_pk_mul_f32 v[8:9], v[8:9], v[84:85]
    v_pk_mul_f32 v[10:11], v[10:11], v[86:87]
    v_exp_f32 v8, v8
    v_exp_f32 v9, v9
    v_exp_f32 v10, v10
    v_exp_f32 v11, v11
    s_nop 0
    v_pk_add_f32 v[8:9], v[8:9], v[178:179]
    v_pk_add_f32 v[10:11], v[10:11], v[178:179]
    v_rcp_f32 v8, v8
    v_rcp_f32 v9, v9
    v_rcp_f32 v10, v10
    v_rcp_f32 v11, v11
    s_nop 0
    v_pk_mul_f32 v[84:85], v[84:85], v[8:9]
    v_pk_mul_f32 v[86:87], v[86:87], v[10:11]
    v_cvt_pk_bf16_f32 v84, v84, v85
    v_cvt_pk_bf16_f32 v85, v86, v87
    buffer_store_dwordx2 v[84:85], v172, s[48:51], 0 offen offset:2048 sc1
    s_waitcnt vmcnt(0)
    s_barrier
    s_and_b32 s3, s2, 7
    s_lshr_b32 s4, s2, 3
    s_lshl_b32 s3, s3, 2
    s_and_b32 s5, s4, 3
    s_add_u32 s3, s3, s5
    s_lshr_b32 s4, s4, 2
    s_mul_i32 s5, s3, 64
    s_mul_i32 s6, s4, 80
    s_lshr_b32 s9, s5, 4
    s_mul_i32 s64, s7, 1
    s_add_u32 s64, s64, s9
    v_lshl_add_u32 v44, s64, 4, v3
    s_mov_b32 s9, 0x80000000
    v_add_u32 v8, -1, v44
    v_lshrrev_b32 v10, 4, v8
    v_mul_u32_u24 v10, 20480, v10
    v_and_b32 v11, 15, v8
    v_lshl_add_u32 v11, v4, 4, v11
    v_lshl_add_u32 v45, v11, 4, v10
    v_cmp_gt_u32 vcc, 2048, v8
    v_mov_b32 v9, s9
    s_nop 1
    v_cndmask_b32 v45, v9, v45, vcc
    v_add_u32 v8, 1, v44
    v_lshrrev_b32 v10, 4, v8
    v_mul_u32_u24 v10, 20480, v10
    v_and_b32 v11, 15, v8
    v_lshl_add_u32 v11, v4, 4, v11
    v_lshl_add_u32 v46, v11, 4, v10
    v_cmp_gt_u32 vcc, 2048, v8
    v_mov_b32 v9, s9
    s_nop 1
    v_cndmask_b32 v46, v9, v46, vcc
    v_add_u32 v8, -2, v44
    v_lshrrev_b32 v10, 4, v8
    v_mul_u32_u24 v10, 20480, v10
    v_and_b32 v11, 15, v8
    v_lshl_add_u32 v11, v4, 4, v11
    v_lshl_add_u32 v47, v11, 4, v10
    v_cmp_gt_u32 vcc, 2048, v8
    v_mov_b32 v9, s9
    s_nop 1
    v_cndmask_b32 v47, v9, v47, vcc
    v_add_u32 v8, 2, v44
    v_lshrrev_b32 v10, 4, v8
    v_mul_u32_u24 v10, 20480, v10
    v_and_b32 v11, 15, v8
    v_lshl_add_u32 v11, v4, 4, v11
    v_lshl_add_u32 v48, v11, 4, v10
    v_cmp_gt_u32 vcc, 2048, v8
    v_mov_b32 v9, s9
    s_nop 1
    v_cndmask_b32 v48, v9, v48, vcc
    s_lshr_b32 s12, s2, 3
    s_lshr_b32 s12, s12, 1
    s_mul_i32 s12, s12, 96
    v_add_u32 v8, 0, v0
    v_mul_u32_u24 v9, 683, v8
    v_lshrrev_b32 v9, 13, v9
    v_mul_u32_u24 v10, 12, v9
    v_sub_u32 v10, v8, v10
    v_and_b32 v39, 0xfffffff3, v9
    v_bfe_u32 v8, v9, 2, 1
    v_lshl_add_u32 v39, v8, 3, v39
    v_bfe_u32 v8, v9, 3, 1
    v_lshl_add_u32 v39, v8, 2, v39
    v_mul_u32_u24 v39, 3072, v39
    v_and_b32 v8, 7, v9
    v_lshrrev_b32 v8, 2, v8
    v_lshlrev_b32 v8, 1, v8
    v_xor_b32 v10, v10, v8
    v_lshl_add_u32 v39, v10, 4, v39
    v_lshl_add_u32 v39, s12, 1, v39
    v_add_u32 v8, 256, v0
    v_mul_u32_u24 v9, 683, v8
    v_lshrrev_b32 v9, 13, v9
    v_mul_u32_u24 v10, 12, v9
    v_sub_u32 v10, v8, v10
    v_and_b32 v40, 0xfffffff3, v9
    v_bfe_u32 v8, v9, 2, 1
    v_lshl_add_u32 v40, v8, 3, v40
    v_bfe_u32 v8, v9, 3, 1
    v_lshl_add_u32 v40, v8, 2, v40
    v_mul_u32_u24 v40, 3072, v40
    v_and_b32 v8, 7, v9
    v_lshrrev_b32 v8, 2, v8
    v_lshlrev_b32 v8, 1, v8
    v_xor_b32 v10, v10, v8
    v_lshl_add_u32 v40, v10, 4, v40
    v_lshl_add_u32 v40, s12, 1, v40
    v_add_u32 v8, 512, v0
    v_mul_u32_u24 v9, 683, v8
    v_lshrrev_b32 v9, 13, v9
    v_mul_u32_u24 v10, 12, v9
    v_sub_u32 v10, v8, v10
    v_and_b32 v41, 0xfffffff3, v9
    v_bfe_u32 v8, v9, 2, 1
    v_lshl_add_u32 v41, v8, 3, v41
    v_bfe_u32 v8, v9, 3, 1
    v_lshl_add_u32 v41, v8, 2, v41
    v_mul_u32_u24 v41, 3072, v41
    v_and_b32 v8, 7, v9
    v_lshrrev_b32 v8, 2, v8
    v_lshlrev_b32 v8, 1, v8
    v_xor_b32 v10, v10, v8
    v_lshl_add_u32 v41, v10, 4, v41
    v_lshl_add_u32 v41, s12, 1, v41
    v_bfe_u32 v8, v0, 2, 3
    v_bfe_u32 v9, v0, 5, 1
    v_lshl_add_u32 v9, v9, 4, v8
    v_mul_u32_u24 v9, 160, v9
    v_and_b32 v10, 3, v0
    v_lshl_add_u32 v9, v10, 3, v9
    v_mov_b32 v49, v9
    v_add_u32 v50, 65536, v49
    s_add_u32 s40, s36, 14680064
    s_addc_u32 s41, s37, 0
    s_and_b32 s41, s41, 0xffff
    s_mov_b32 s42, 2621440
    s_mov_b32 s43, 0x00020000
    s_mov_b32 s84, s28
    s_mov_b32 s85, s29
    s_and_b32 s85, s85, 0xffff
    s_mov_b32 s86, 1966080
    s_mov_b32 s87, 0x00020000
    s_mov_b32 s10, 491520
    s_add_u32 m0, s8, 61440
    s_nop 0
    buffer_load_dwordx4 v34, s[44:47], s10 offen lds
    s_mov_b32 s10, 491520
    s_add_u32 m0, s8, 65536
    s_nop 0
    buffer_load_dwordx4 v35, s[44:47], s10 offen lds
    s_mov_b32 s10, 491520
    s_add_u32 m0, s8, 69632
    s_nop 0
    buffer_load_dwordx4 v36, s[44:47], s10 offen lds
    s_mov_b32 s10, 491520
    s_add_u32 m0, s8, 73728
    s_nop 0
    buffer_load_dwordx4 v37, s[44:47], s10 offen lds
    s_mov_b32 s10, 491520
    s_add_u32 m0, s8, 77824
    s_nop 0
    buffer_load_dwordx4 v38, s[44:47], s10 offen lds
    s_mov_b32 s10, 655360
    s_add_u32 m0, s8, 81920
    s_nop 0
    buffer_load_dwordx4 v34, s[44:47], s10 offen lds
    s_mov_b32 s10, 655360
    s_add_u32 m0, s8, 86016
    s_nop 0
    buffer_load_dwordx4 v35, s[44:47], s10 offen lds
    s_mov_b32 s10, 655360
    s_add_u32 m0, s8, 90112
    s_nop 0
    buffer_load_dwordx4 v36, s[44:47], s10 offen lds
    s_mov_b32 s10, 655360
    s_add_u32 m0, s8, 94208
    s_nop 0
    buffer_load_dwordx4 v37, s[44:47], s10 offen lds
    s_mov_b32 s10, 655360
    s_add_u32 m0, s8, 98304
    s_nop 0
    buffer_load_dwordx4 v38, s[44:47], s10 offen lds
    s_barrier
    s_mov_b32 s10, 0
    buffer_load_dwordx4 v[72:75], v45, s[40:43], s10 offen offset:0 sc1
    s_mov_b32 s10, 0
    buffer_load_dwordx4 v[76:79], v45, s[40:43], s10 offen offset:1024 sc1
    s_mov_b32 s10, 0
    buffer_load_dwordx4 v[80:83], v45, s[40:43], s10 offen offset:2048 sc1
    s_mov_b32 s10, 0
    buffer_load_dwordx4 v[84:87], v45, s[40:43], s10 offen offset:3072 sc1
    s_add_u32 s60, s36, 28311552
    s_addc_u32 s61, s37, 0
    s_and_b32 s61, s61, 0xffff
    s_mov_b32 s62, 131072
    s_mov_b32 s63, 0x00020000
    v_lshlrev_b32 v8, 6, v44
    v_lshl_add_u32 v8, v4, 4, v8
    buffer_load_dwordx4 v[152:155], v8, s[60:63], 0 offen sc1
    s_add_u32 s48, s36, 17825792
    s_addc_u32 s49, s37, 0
    s_and_b32 s49, s49, 0xffff
    s_mov_b32 s50, 2621440
    s_mov_b32 s51, 0x00020000
    s_mul_i32 s9, s64, 20480
    s_lshl_b32 s14, s6, 5
    s_add_u32 s9, s9, s14
    v_lshrrev_b32 v8, 1, v4
    v_lshl_add_u32 v8, v8, 4, v3
    v_lshlrev_b32 v156, 4, v8
    v_and_b32 v8, 1, v4
    v_lshl_add_u32 v156, v8, 3, v156
    v_add_u32 v156, s9, v156
    s_mov_b32 s10, 4096
    buffer_load_dwordx4 v[88:91], v45, s[40:43], s10 offen offset:0 sc1
    s_mov_b32 s10, 4096
    buffer_load_dwordx4 v[92:95], v46, s[40:43], s10 offen offset:1024 sc1
    s_mov_b32 s10, 4096
    buffer_load_dwordx4 v[96:99], v46, s[40:43], s10 offen offset:2048 sc1
    s_mov_b32 s10, 4096
    buffer_load_dwordx4 v[100:103], v46, s[40:43], s10 offen offset:3072 sc1
    s_mov_b32 s10, 8192
    buffer_load_dwordx4 v[104:107], v46, s[40:43], s10 offen offset:0 sc1
    s_mov_b32 s10, 8192
    buffer_load_dwordx4 v[108:111], v46, s[40:43], s10 offen offset:1024 sc1
    s_mov_b32 s10, 8192
    buffer_load_dwordx4 v[112:115], v47, s[40:43], s10 offen offset:2048 sc1
    s_mov_b32 s10, 8192
    buffer_load_dwordx4 v[116:119], v47, s[40:43], s10 offen offset:3072 sc1
    s_mov_b32 s10, 12288
    buffer_load_dwordx4 v[120:123], v47, s[40:43], s10 offen offset:0 sc1
    s_mov_b32 s10, 12288
    buffer_load_dwordx4 v[124:127], v47, s[40:43], s10 offen offset:1024 sc1
    s_mov_b32 s10, 12288
    buffer_load_dwordx4 v[128:131], v47, s[40:43], s10 offen offset:2048 sc1
    s_mov_b32 s10, 12288
    buffer_load_dwordx4 v[132:135], v48, s[40:43], s10 offen offset:3072 sc1
    s_mov_b32 s10, 16384
    buffer_load_dwordx4 v[136:139], v48, s[40:43], s10 offen offset:0 sc1
    s_mov_b32 s10, 16384
    buffer_load_dwordx4 v[140:143], v48, s[40:43], s10 offen offset:1024 sc1
    s_mov_b32 s10, 16384
    buffer_load_dwordx4 v[144:147], v48, s[40:43], s10 offen offset:2048 sc1
    s_mov_b32 s10, 16384
    buffer_load_dwordx4 v[148:151], v48, s[40:43], s10 offen offset:3072 sc1
    v_mov_b32 v52, 0
    v_mov_b32 v53, 0
    v_mov_b32 v54, 0
    v_mov_b32 v55, 0
    v_mov_b32 v56, 0
    v_mov_b32 v57, 0
    v_mov_b32 v58, 0
    v_mov_b32 v59, 0
    v_mov_b32 v60, 0
    v_mov_b32 v61, 0
    v_mov_b32 v62, 0
    v_mov_b32 v63, 0
    v_mov_b32 v64, 0
    v_mov_b32 v65, 0
    v_mov_b32 v66, 0
    v_mov_b32 v67, 0
    v_mov_b32 v68, 0
    v_mov_b32 v69, 0
    v_mov_b32 v70, 0
    v_mov_b32 v71, 0
    s_waitcnt vmcnt(17)
    s_barrier
    ds_read_b64_tr_b16 v[160:161], v49 offset:0
    ds_read_b64_tr_b16 v[162:163], v49 offset:1280
    ds_read_b64_tr_b16 v[164:165], v49 offset:32
    ds_read_b64_tr_b16 v[166:167], v49 offset:1312
    ds_read_b64_tr_b16 v[168:169], v49 offset:64
    ds_read_b64_tr_b16 v[170:171], v49 offset:1344
    ds_read_b64_tr_b16 v[172:173], v49 offset:96
    ds_read_b64_tr_b16 v[174:175], v49 offset:1376
    ds_read_b64_tr_b16 v[176:177], v49 offset:128
    ds_read_b64_tr_b16 v[178:179], v49 offset:1408
    ds_read_b64_tr_b16 v[180:181], v49 offset:5120
    ds_read_b64_tr_b16 v[182:183], v49 offset:6400
    s_waitcnt lgkmcnt(10)
    v_mfma_f32_16x16x32_bf16 v[52:55], v[160:163], v[72:75], v[52:55]
    s_mov_b32 s96, s30
    s_and_b32 s97, s31, 0xffff
    s_mov_b32 s98, 983040
    s_mov_b32 s99, 0x00020000
    s_lshr_b32 s10, s2, 3
    s_mul_i32 s10, s10, 30720
    s_add_u32 s10, s10, 0
    buffer_load_dword v33, v32, s[96:99], s10 offen
    ds_read_b64_tr_b16 v[184:185], v49 offset:5152
    ds_read_b64_tr_b16 v[186:187], v49 offset:6432
    s_waitcnt lgkmcnt(10)
    v_mfma_f32_16x16x32_bf16 v[56:59], v[164:167], v[72:75], v[56:59]
    ds_read_b64_tr_b16 v[160:161], v49 offset:5184
    ds_read_b64_tr_b16 v[162:163], v49 offset:6464
    s_waitcnt lgkmcnt(10)
    v_mfma_f32_16x16x32_bf16 v[60:63], v[168:171], v[72:75], v[60:63]
    ds_read_b64_tr_b16 v[164:165], v49 offset:5216
    ds_read_b64_tr_b16 v[166:167], v49 offset:6496
    s_waitcnt lgkmcnt(10)
    v_mfma_f32_16x16x32_bf16 v[64:67], v[172:175], v[72:75], v[64:67]
    ds_read_b64_tr_b16 v[168:169], v49 offset:5248
    ds_read_b64_tr_b16 v[170:171], v49 offset:6528
    s_waitcnt lgkmcnt(10)
    v_mfma_f32_16x16x32_bf16 v[68:71], v[176:179], v[72:75], v[68:71]
    ds_read_b64_tr_b16 v[172:173], v49 offset:10240
    ds_read_b64_tr_b16 v[174:175], v49 offset:11520
    s_waitcnt lgkmcnt(10)
    v_mfma_f32_16x16x32_bf16 v[52:55], v[180:183], v[76:79], v[52:55]
    ds_read_b64_tr_b16 v[176:177], v49 offset:10272
    ds_read_b64_tr_b16 v[178:179], v49 offset:11552
    s_waitcnt lgkmcnt(10)
    v_mfma_f32_16x16x32_bf16 v[56:59], v[184:187], v[76:79], v[56:59]
    ds_read_b64_tr_b16 v[180:181], v49 offset:10304
    ds_read_b64_tr_b16 v[182:183], v49 offset:11584
    s_waitcnt lgkmcnt(10)
    v_mfma_f32_16x16x32_bf16 v[60:63], v[160:163], v[76:79], v[60:63]
    ds_read_b64_tr_b16 v[184:185], v49 offset:10336
    ds_read_b64_tr_b16 v[186:187], v49 offset:11616
    s_waitcnt lgkmcnt(10)
    v_mfma_f32_16x16x32_bf16 v[64:67], v[164:167], v[76:79], v[64:67]
    ds_read_b64_tr_b16 v[160:161], v49 offset:10368
    ds_read_b64_tr_b16 v[162:163], v49 offset:11648
    s_waitcnt lgkmcnt(10)
    v_mfma_f32_16x16x32_bf16 v[68:71], v[168:171], v[76:79], v[68:71]
    ds_read_b64_tr_b16 v[164:165], v49 offset:15360
    ds_read_b64_tr_b16 v[166:167], v49 offset:16640
    s_waitcnt lgkmcnt(10)
    v_mfma_f32_16x16x32_bf16 v[52:55], v[172:175], v[80:83], v[52:55]
    ds_read_b64_tr_b16 v[168:169], v49 offset:15392
    ds_read_b64_tr_b16 v[170:171], v49 offset:16672
    s_waitcnt lgkmcnt(10)
    v_mfma_f32_16x16x32_bf16 v[56:59], v[176:179], v[80:83], v[56:59]
    ds_read_b64_tr_b16 v[172:173], v49 offset:15424
    ds_read_b64_tr_b16 v[174:175], v49 offset:16704
    s_waitcnt lgkmcnt(10)
    v_mfma_f32_16x16x32_bf16 v[60:63], v[180:183], v[80:83], v[60:63]
    ds_read_b64_tr_b16 v[176:177], v49 offset:15456
    ds_read_b64_tr_b16 v[178:179], v49 offset:16736
    s_waitcnt lgkmcnt(10)
    v_mfma_f32_16x16x32_bf16 v[64:67], v[184:187], v[80:83], v[64:67]
    ds_read_b64_tr_b16 v[180:181], v49 offset:15488
    ds_read_b64_tr_b16 v[182:183], v49 offset:16768
    s_waitcnt lgkmcnt(10)
    v_mfma_f32_16x16x32_bf16 v[68:71], v[160:163], v[80:83], v[68:71]
    s_waitcnt vmcnt(13)
    s_barrier
    ds_read_b64_tr_b16 v[184:185], v49 offset:20480
    ds_read_b64_tr_b16 v[186:187], v49 offset:21760
    s_waitcnt lgkmcnt(10)
    v_mfma_f32_16x16x32_bf16 v[52:55], v[164:167], v[84:87], v[52:55]
    ds_read_b64_tr_b16 v[160:161], v49 offset:20512
    ds_read_b64_tr_b16 v[162:163], v49 offset:21792
    s_waitcnt lgkmcnt(10)
    v_mfma_f32_16x16x32_bf16 v[56:59], v[168:171], v[84:87], v[56:59]
    ds_read_b64_tr_b16 v[164:165], v49 offset:20544
    ds_read_b64_tr_b16 v[166:167], v49 offset:21824
    s_waitcnt lgkmcnt(10)
    v_mfma_f32_16x16x32_bf16 v[60:63], v[172:175], v[84:87], v[60:63]
    ds_read_b64_tr_b16 v[168:169], v49 offset:20576
    ds_read_b64_tr_b16 v[170:171], v49 offset:21856
    s_waitcnt lgkmcnt(10)
    v_mfma_f32_16x16x32_bf16 v[64:67], v[176:179], v[84:87], v[64:67]
    ds_read_b64_tr_b16 v[172:173], v49 offset:20608
    ds_read_b64_tr_b16 v[174:175], v49 offset:21888
    s_waitcnt lgkmcnt(10)
    v_mfma_f32_16x16x32_bf16 v[68:71], v[180:183], v[84:87], v[68:71]
    ds_read_b64_tr_b16 v[176:177], v49 offset:25600
    ds_read_b64_tr_b16 v[178:179], v49 offset:26880
    s_waitcnt lgkmcnt(10)
    v_mfma_f32_16x16x32_bf16 v[52:55], v[184:187], v[88:91], v[52:55]
    ds_read_b64_tr_b16 v[180:181], v49 offset:25632
    ds_read_b64_tr_b16 v[182:183], v49 offset:26912
    s_waitcnt lgkmcnt(10)
    v_mfma_f32_16x16x32_bf16 v[56:59], v[160:163], v[88:91], v[56:59]
    ds_read_b64_tr_b16 v[184:185], v49 offset:25664
    ds_read_b64_tr_b16 v[186:187], v49 offset:26944
    s_waitcnt lgkmcnt(10)
    v_mfma_f32_16x16x32_bf16 v[60:63], v[164:167], v[88:91], v[60:63]
    ds_read_b64_tr_b16 v[160:161], v49 offset:25696
    ds_read_b64_tr_b16 v[162:163], v49 offset:26976
    s_waitcnt lgkmcnt(10)
    v_mfma_f32_16x16x32_bf16 v[64:67], v[168:171], v[88:91], v[64:67]
    ds_read_b64_tr_b16 v[164:165], v49 offset:25728
    ds_read_b64_tr_b16 v[166:167], v49 offset:27008
    s_waitcnt lgkmcnt(10)
    v_mfma_f32_16x16x32_bf16 v[68:71], v[172:175], v[88:91], v[68:71]
    ds_read_b64_tr_b16 v[168:169], v49 offset:30720
    ds_read_b64_tr_b16 v[170:171], v49 offset:32000
    s_waitcnt lgkmcnt(10)
    v_mfma_f32_16x16x32_bf16 v[52:55], v[176:179], v[92:95], v[52:55]
    ds_read_b64_tr_b16 v[172:173], v49 offset:30752
    ds_read_b64_tr_b16 v[174:175], v49 offset:32032
    s_waitcnt lgkmcnt(10)
    v_mfma_f32_16x16x32_bf16 v[56:59], v[180:183], v[92:95], v[56:59]
    ds_read_b64_tr_b16 v[176:177], v49 offset:30784
    ds_read_b64_tr_b16 v[178:179], v49 offset:32064
    s_waitcnt lgkmcnt(10)
    v_mfma_f32_16x16x32_bf16 v[60:63], v[184:187], v[92:95], v[60:63]
    ds_read_b64_tr_b16 v[180:181], v49 offset:30816
    ds_read_b64_tr_b16 v[182:183], v49 offset:32096
    s_waitcnt lgkmcnt(10)
    v_mfma_f32_16x16x32_bf16 v[64:67], v[160:163], v[92:95], v[64:67]
    ds_read_b64_tr_b16 v[184:185], v49 offset:30848
    ds_read_b64_tr_b16 v[186:187], v49 offset:32128
    s_waitcnt lgkmcnt(10)
    v_mfma_f32_16x16x32_bf16 v[68:71], v[164:167], v[92:95], v[68:71]
    ds_read_b64_tr_b16 v[160:161], v49 offset:35840
    ds_read_b64_tr_b16 v[162:163], v49 offset:37120
    s_waitcnt lgkmcnt(10)
    v_mfma_f32_16x16x32_bf16 v[52:55], v[168:171], v[96:99], v[52:55]
    ds_read_b64_tr_b16 v[164:165], v49 offset:35872
    ds_read_b64_tr_b16 v[166:167], v49 offset:37152
    s_waitcnt lgkmcnt(10)
    v_mfma_f32_16x16x32_bf16 v[56:59], v[172:175], v[96:99], v[56:59]
    ds_read_b64_tr_b16 v[168:169], v49 offset:35904
    ds_read_b64_tr_b16 v[170:171], v49 offset:37184
    s_waitcnt lgkmcnt(10)
    v_mfma_f32_16x16x32_bf16 v[60:63], v[176:179], v[96:99], v[60:63]
    ds_read_b64_tr_b16 v[172:173], v49 offset:35936
    ds_read_b64_tr_b16 v[174:175], v49 offset:37216
    s_waitcnt lgkmcnt(10)
    v_mfma_f32_16x16x32_bf16 v[64:67], v[180:183], v[96:99], v[64:67]
    ds_read_b64_tr_b16 v[176:177], v49 offset:35968
    ds_read_b64_tr_b16 v[178:179], v49 offset:37248
    s_waitcnt lgkmcnt(10)
    v_mfma_f32_16x16x32_bf16 v[68:71], v[184:187], v[96:99], v[68:71]
    s_waitcnt vmcnt(9)
    s_barrier
    ds_read_b64_tr_b16 v[180:181], v49 offset:40960
    ds_read_b64_tr_b16 v[182:183], v49 offset:42240
    s_waitcnt lgkmcnt(10)
    v_mfma_f32_16x16x32_bf16 v[52:55], v[160:163], v[100:103], v[52:55]
    s_mov_b32 s10, 0
    s_add_u32 m0, s8, 0
    s_nop 0
    buffer_load_dwordx4 v39, s[84:87], s10 offen lds
    ds_read_b64_tr_b16 v[184:185], v49 offset:40992
    ds_read_b64_tr_b16 v[186:187], v49 offset:42272
    s_waitcnt lgkmcnt(10)
    v_mfma_f32_16x16x32_bf16 v[56:59], v[164:167], v[100:103], v[56:59]
    s_mov_b32 s10, 0
    s_add_u32 m0, s8, 4096
    s_nop 0
    buffer_load_dwordx4 v40, s[84:87], s10 offen lds
    ds_read_b64_tr_b16 v[160:161], v49 offset:41024
    ds_read_b64_tr_b16 v[162:163], v49 offset:42304
    s_waitcnt lgkmcnt(10)
    v_mfma_f32_16x16x32_bf16 v[60:63], v[168:171], v[100:103], v[60:63]
    s_mov_b32 s10, 0
    s_add_u32 m0, s8, 8192
    s_nop 0
    buffer_load_dwordx4 v41, s[84:87], s10 offen lds
    ds_read_b64_tr_b16 v[164:165], v49 offset:41056
    ds_read_b64_tr_b16 v[166:167], v49 offset:42336
    s_waitcnt lgkmcnt(10)
    v_mfma_f32_16x16x32_bf16 v[64:67], v[172:175], v[100:103], v[64:67]
    ds_read_b64_tr_b16 v[168:169], v49 offset:41088
    ds_read_b64_tr_b16 v[170:171], v49 offset:42368
    s_waitcnt lgkmcnt(10)
    v_mfma_f32_16x16x32_bf16 v[68:71], v[176:179], v[100:103], v[68:71]
    ds_read_b64_tr_b16 v[172:173], v49 offset:46080
    ds_read_b64_tr_b16 v[174:175], v49 offset:47360
    s_waitcnt lgkmcnt(10)
    v_mfma_f32_16x16x32_bf16 v[52:55], v[180:183], v[104:107], v[52:55]
    ds_read_b64_tr_b16 v[176:177], v49 offset:46112
    ds_read_b64_tr_b16 v[178:179], v49 offset:47392
    s_waitcnt lgkmcnt(10)
    v_mfma_f32_16x16x32_bf16 v[56:59], v[184:187], v[104:107], v[56:59]
    ds_read_b64_tr_b16 v[180:181], v49 offset:46144
    ds_read_b64_tr_b16 v[182:183], v49 offset:47424
    s_waitcnt lgkmcnt(10)
    v_mfma_f32_16x16x32_bf16 v[60:63], v[160:163], v[104:107], v[60:63]
    ds_read_b64_tr_b16 v[184:185], v49 offset:46176
    ds_read_b64_tr_b16 v[186:187], v49 offset:47456
    s_waitcnt lgkmcnt(10)
    v_mfma_f32_16x16x32_bf16 v[64:67], v[164:167], v[104:107], v[64:67]
    ds_read_b64_tr_b16 v[160:161], v49 offset:46208
    ds_read_b64_tr_b16 v[162:163], v49 offset:47488
    s_waitcnt lgkmcnt(10)
    v_mfma_f32_16x16x32_bf16 v[68:71], v[168:171], v[104:107], v[68:71]
    ds_read_b64_tr_b16 v[164:165], v49 offset:51200
    ds_read_b64_tr_b16 v[166:167], v49 offset:52480
    s_waitcnt lgkmcnt(10)
    v_mfma_f32_16x16x32_bf16 v[52:55], v[172:175], v[108:111], v[52:55]
    ds_read_b64_tr_b16 v[168:169], v49 offset:51232
    ds_read_b64_tr_b16 v[170:171], v49 offset:52512
    s_waitcnt lgkmcnt(10)
    v_mfma_f32_16x16x32_bf16 v[56:59], v[176:179], v[108:111], v[56:59]
    ds_read_b64_tr_b16 v[172:173], v49 offset:51264
    ds_read_b64_tr_b16 v[174:175], v49 offset:52544
    s_waitcnt lgkmcnt(10)
    v_mfma_f32_16x16x32_bf16 v[60:63], v[180:183], v[108:111], v[60:63]
    ds_read_b64_tr_b16 v[176:177], v49 offset:51296
    ds_read_b64_tr_b16 v[178:179], v49 offset:52576
    s_waitcnt lgkmcnt(10)
    v_mfma_f32_16x16x32_bf16 v[64:67], v[184:187], v[108:111], v[64:67]
    ds_read_b64_tr_b16 v[180:181], v49 offset:51328
    ds_read_b64_tr_b16 v[182:183], v49 offset:52608
    s_waitcnt lgkmcnt(10)
    v_mfma_f32_16x16x32_bf16 v[68:71], v[160:163], v[108:111], v[68:71]
    ds_read_b64_tr_b16 v[184:185], v49 offset:56320
    ds_read_b64_tr_b16 v[186:187], v49 offset:57600
    s_waitcnt lgkmcnt(10)
    v_mfma_f32_16x16x32_bf16 v[52:55], v[164:167], v[112:115], v[52:55]
    ds_read_b64_tr_b16 v[160:161], v49 offset:56352
    ds_read_b64_tr_b16 v[162:163], v49 offset:57632
    s_waitcnt lgkmcnt(10)
    v_mfma_f32_16x16x32_bf16 v[56:59], v[168:171], v[112:115], v[56:59]
    ds_read_b64_tr_b16 v[164:165], v49 offset:56384
    ds_read_b64_tr_b16 v[166:167], v49 offset:57664
    s_waitcnt lgkmcnt(10)
    v_mfma_f32_16x16x32_bf16 v[60:63], v[172:175], v[112:115], v[60:63]
    ds_read_b64_tr_b16 v[168:169], v49 offset:56416
    ds_read_b64_tr_b16 v[170:171], v49 offset:57696
    s_waitcnt lgkmcnt(10)
    v_mfma_f32_16x16x32_bf16 v[64:67], v[176:179], v[112:115], v[64:67]
    ds_read_b64_tr_b16 v[172:173], v49 offset:56448
    ds_read_b64_tr_b16 v[174:175], v49 offset:57728
    s_waitcnt lgkmcnt(10)
    v_mfma_f32_16x16x32_bf16 v[68:71], v[180:183], v[112:115], v[68:71]
    s_waitcnt vmcnt(8)
    s_barrier
    ds_read_b64_tr_b16 v[176:177], v49 offset:61440
    ds_read_b64_tr_b16 v[178:179], v49 offset:62720
    s_waitcnt lgkmcnt(10)
    v_mfma_f32_16x16x32_bf16 v[52:55], v[184:187], v[116:119], v[52:55]
    s_mov_b32 s10, 196608
    s_add_u32 m0, s8, 12288
    s_nop 0
    buffer_load_dwordx4 v39, s[84:87], s10 offen lds
    ds_read_b64_tr_b16 v[180:181], v49 offset:61472
    ds_read_b64_tr_b16 v[182:183], v49 offset:62752
    s_waitcnt lgkmcnt(10)
    v_mfma_f32_16x16x32_bf16 v[56:59], v[160:163], v[116:119], v[56:59]
    s_mov_b32 s10, 196608
    s_add_u32 m0, s8, 16384
    s_nop 0
    buffer_load_dwordx4 v40, s[84:87], s10 offen lds
    ds_read_b64_tr_b16 v[184:185], v49 offset:61504
    ds_read_b64_tr_b16 v[186:187], v49 offset:62784
    s_waitcnt lgkmcnt(10)
    v_mfma_f32_16x16x32_bf16 v[60:63], v[164:167], v[116:119], v[60:63]
    s_mov_b32 s10, 196608
    s_add_u32 m0, s8, 20480
    s_nop 0
    buffer_load_dwordx4 v41, s[84:87], s10 offen lds
    ds_read_b64_tr_b16 v[160:161], v49 offset:61536
    ds_read_b64_tr_b16 v[162:163], v49 offset:62816
    s_waitcnt lgkmcnt(10)
    v_mfma_f32_16x16x32_bf16 v[64:67], v[168:171], v[116:119], v[64:67]
    s_mov_b32 s10, 393216
    s_add_u32 m0, s8, 24576
    s_nop 0
    buffer_load_dwordx4 v39, s[84:87], s10 offen lds
    ds_read_b64_tr_b16 v[164:165], v49 offset:61568
    ds_read_b64_tr_b16 v[166:167], v49 offset:62848
    s_waitcnt lgkmcnt(10)
    v_mfma_f32_16x16x32_bf16 v[68:71], v[172:175], v[116:119], v[68:71]
    s_mov_b32 s10, 393216
    s_add_u32 m0, s8, 28672
    s_nop 0
    buffer_load_dwordx4 v40, s[84:87], s10 offen lds
    ds_read_b64_tr_b16 v[168:169], v50 offset:1024
    ds_read_b64_tr_b16 v[170:171], v50 offset:2304
    s_waitcnt lgkmcnt(10)
    v_mfma_f32_16x16x32_bf16 v[52:55], v[176:179], v[120:123], v[52:55]
    s_mov_b32 s10, 393216
    s_add_u32 m0, s8, 32768
    s_nop 0
    buffer_load_dwordx4 v41, s[84:87], s10 offen lds
    ds_read_b64_tr_b16 v[172:173], v50 offset:1056
    ds_read_b64_tr_b16 v[174:175], v50 offset:2336
    s_waitcnt lgkmcnt(10)
    v_mfma_f32_16x16x32_bf16 v[56:59], v[180:183], v[120:123], v[56:59]
    ds_read_b64_tr_b16 v[176:177], v50 offset:1088
    ds_read_b64_tr_b16 v[178:179], v50 offset:2368
    s_waitcnt lgkmcnt(10)
    v_mfma_f32_16x16x32_bf16 v[60:63], v[184:187], v[120:123], v[60:63]
    ds_read_b64_tr_b16 v[180:181], v50 offset:1120
    ds_read_b64_tr_b16 v[182:183], v50 offset:2400
    s_waitcnt lgkmcnt(10)
    v_mfma_f32_16x16x32_bf16 v[64:67], v[160:163], v[120:123], v[64:67]
    ds_read_b64_tr_b16 v[184:185], v50 offset:1152
    ds_read_b64_tr_b16 v[186:187], v50 offset:2432
    s_waitcnt lgkmcnt(10)
    v_mfma_f32_16x16x32_bf16 v[68:71], v[164:167], v[120:123], v[68:71]
    ds_read_b64_tr_b16 v[160:161], v50 offset:6144
    ds_read_b64_tr_b16 v[162:163], v50 offset:7424
    s_waitcnt lgkmcnt(10)
    v_mfma_f32_16x16x32_bf16 v[52:55], v[168:171], v[124:127], v[52:55]
    ds_read_b64_tr_b16 v[164:165], v50 offset:6176
    ds_read_b64_tr_b16 v[166:167], v50 offset:7456
    s_waitcnt lgkmcnt(10)
    v_mfma_f32_16x16x32_bf16 v[56:59], v[172:175], v[124:127], v[56:59]
    ds_read_b64_tr_b16 v[168:169], v50 offset:6208
    ds_read_b64_tr_b16 v[170:171], v50 offset:7488
    s_waitcnt lgkmcnt(10)
    v_mfma_f32_16x16x32_bf16 v[60:63], v[176:179], v[124:127], v[60:63]
    ds_read_b64_tr_b16 v[172:173], v50 offset:6240
    ds_read_b64_tr_b16 v[174:175], v50 offset:7520
    s_waitcnt lgkmcnt(10)
    v_mfma_f32_16x16x32_bf16 v[64:67], v[180:183], v[124:127], v[64:67]
    ds_read_b64_tr_b16 v[176:177], v50 offset:6272
    ds_read_b64_tr_b16 v[178:179], v50 offset:7552
    s_waitcnt lgkmcnt(10)
    v_mfma_f32_16x16x32_bf16 v[68:71], v[184:187], v[124:127], v[68:71]
    ds_read_b64_tr_b16 v[180:181], v50 offset:11264
    ds_read_b64_tr_b16 v[182:183], v50 offset:12544
    s_waitcnt lgkmcnt(10)
    v_mfma_f32_16x16x32_bf16 v[52:55], v[160:163], v[128:131], v[52:55]
    ds_read_b64_tr_b16 v[184:185], v50 offset:11296
    ds_read_b64_tr_b16 v[186:187], v50 offset:12576
    s_waitcnt lgkmcnt(10)
    v_mfma_f32_16x16x32_bf16 v[56:59], v[164:167], v[128:131], v[56:59]
    ds_read_b64_tr_b16 v[160:161], v50 offset:11328
    ds_read_b64_tr_b16 v[162:163], v50 offset:12608
    s_waitcnt lgkmcnt(10)
    v_mfma_f32_16x16x32_bf16 v[60:63], v[168:171], v[128:131], v[60:63]
    ds_read_b64_tr_b16 v[164:165], v50 offset:11360
    ds_read_b64_tr_b16 v[166:167], v50 offset:12640
    s_waitcnt lgkmcnt(10)
    v_mfma_f32_16x16x32_bf16 v[64:67], v[172:175], v[128:131], v[64:67]
    ds_read_b64_tr_b16 v[168:169], v50 offset:11392
    ds_read_b64_tr_b16 v[170:171], v50 offset:12672
    s_waitcnt lgkmcnt(10)
    v_mfma_f32_16x16x32_bf16 v[68:71], v[176:179], v[128:131], v[68:71]
    s_waitcnt vmcnt(10)
    s_barrier
    ds_read_b64_tr_b16 v[172:173], v50 offset:16384
    ds_read_b64_tr_b16 v[174:175], v50 offset:17664
    s_waitcnt lgkmcnt(10)
    v_mfma_f32_16x16x32_bf16 v[52:55], v[180:183], v[132:135], v[52:55]
    s_mov_b32 s10, 589824
    s_add_u32 m0, s8, 36864
    s_nop 0
    buffer_load_dwordx4 v39, s[84:87], s10 offen lds
    ds_read_b64_tr_b16 v[176:177], v50 offset:16416
    ds_read_b64_tr_b16 v[178:179], v50 offset:17696
    s_waitcnt lgkmcnt(10)
    v_mfma_f32_16x16x32_bf16 v[56:59], v[184:187], v[132:135], v[56:59]
    s_mov_b32 s10, 589824
    s_add_u32 m0, s8, 40960
    s_nop 0
    buffer_load_dwordx4 v40, s[84:87], s10 offen lds
    ds_read_b64_tr_b16 v[180:181], v50 offset:16448
    ds_read_b64_tr_b16 v[182:183], v50 offset:17728
    s_waitcnt lgkmcnt(10)
    v_mfma_f32_16x16x32_bf16 v[60:63], v[160:163], v[132:135], v[60:63]
    s_mov_b32 s10, 589824
    s_add_u32 m0, s8, 45056
    s_nop 0
    buffer_load_dwordx4 v41, s[84:87], s10 offen lds
    ds_read_b64_tr_b16 v[184:185], v50 offset:16480
    ds_read_b64_tr_b16 v[186:187], v50 offset:17760
    s_waitcnt lgkmcnt(10)
    v_mfma_f32_16x16x32_bf16 v[64:67], v[164:167], v[132:135], v[64:67]
    s_mov_b32 s10, 786432
    s_add_u32 m0, s8, 49152
    s_nop 0
    buffer_load_dwordx4 v39, s[84:87], s10 offen lds
    ds_read_b64_tr_b16 v[160:161], v50 offset:16512
    ds_read_b64_tr_b16 v[162:163], v50 offset:17792
    s_waitcnt lgkmcnt(10)
    v_mfma_f32_16x16x32_bf16 v[68:71], v[168:171], v[132:135], v[68:71]
    s_mov_b32 s10, 786432
    s_add_u32 m0, s8, 53248
    s_nop 0
    buffer_load_dwordx4 v40, s[84:87], s10 offen lds
    ds_read_b64_tr_b16 v[164:165], v50 offset:21504
    ds_read_b64_tr_b16 v[166:167], v50 offset:22784
    s_waitcnt lgkmcnt(10)
    v_mfma_f32_16x16x32_bf16 v[52:55], v[172:175], v[136:139], v[52:55]
    s_mov_b32 s10, 786432
    s_add_u32 m0, s8, 57344
    s_nop 0
    buffer_load_dwordx4 v41, s[84:87], s10 offen lds
    ds_read_b64_tr_b16 v[168:169], v50 offset:21536
    ds_read_b64_tr_b16 v[170:171], v50 offset:22816
    s_waitcnt lgkmcnt(10)
    v_mfma_f32_16x16x32_bf16 v[56:59], v[176:179], v[136:139], v[56:59]
    ds_read_b64_tr_b16 v[172:173], v50 offset:21568
    ds_read_b64_tr_b16 v[174:175], v50 offset:22848
    s_waitcnt lgkmcnt(10)
    v_mfma_f32_16x16x32_bf16 v[60:63], v[180:183], v[136:139], v[60:63]
    ds_read_b64_tr_b16 v[176:177], v50 offset:21600
    ds_read_b64_tr_b16 v[178:179], v50 offset:22880
    s_waitcnt lgkmcnt(10)
    v_mfma_f32_16x16x32_bf16 v[64:67], v[184:187], v[136:139], v[64:67]
    ds_read_b64_tr_b16 v[180:181], v50 offset:21632
    ds_read_b64_tr_b16 v[182:183], v50 offset:22912
    s_waitcnt lgkmcnt(10)
    v_mfma_f32_16x16x32_bf16 v[68:71], v[160:163], v[136:139], v[68:71]
    ds_read_b64_tr_b16 v[184:185], v50 offset:26624
    ds_read_b64_tr_b16 v[186:187], v50 offset:27904
    s_waitcnt lgkmcnt(10)
    v_mfma_f32_16x16x32_bf16 v[52:55], v[164:167], v[140:143], v[52:55]
    ds_read_b64_tr_b16 v[160:161], v50 offset:26656
    ds_read_b64_tr_b16 v[162:163], v50 offset:27936
    s_waitcnt lgkmcnt(10)
    v_mfma_f32_16x16x32_bf16 v[56:59], v[168:171], v[140:143], v[56:59]
    ds_read_b64_tr_b16 v[164:165], v50 offset:26688
    ds_read_b64_tr_b16 v[166:167], v50 offset:27968
    s_waitcnt lgkmcnt(10)
    v_mfma_f32_16x16x32_bf16 v[60:63], v[172:175], v[140:143], v[60:63]
    ds_read_b64_tr_b16 v[168:169], v50 offset:26720
    ds_read_b64_tr_b16 v[170:171], v50 offset:28000
    s_waitcnt lgkmcnt(10)
    v_mfma_f32_16x16x32_bf16 v[64:67], v[176:179], v[140:143], v[64:67]
    ds_read_b64_tr_b16 v[172:173], v50 offset:26752
    ds_read_b64_tr_b16 v[174:175], v50 offset:28032
    s_waitcnt lgkmcnt(10)
    v_mfma_f32_16x16x32_bf16 v[68:71], v[180:183], v[140:143], v[68:71]
    ds_read_b64_tr_b16 v[176:177], v50 offset:31744
    ds_read_b64_tr_b16 v[178:179], v50 offset:33024
    s_waitcnt lgkmcnt(10)
    v_mfma_f32_16x16x32_bf16 v[52:55], v[184:187], v[144:147], v[52:55]
    ds_read_b64_tr_b16 v[180:181], v50 offset:31776
    ds_read_b64_tr_b16 v[182:183], v50 offset:33056
    s_waitcnt lgkmcnt(10)
    v_mfma_f32_16x16x32_bf16 v[56:59], v[160:163], v[144:147], v[56:59]
    ds_read_b64_tr_b16 v[184:185], v50 offset:31808
    ds_read_b64_tr_b16 v[186:187], v50 offset:33088
    s_waitcnt lgkmcnt(10)
    v_mfma_f32_16x16x32_bf16 v[60:63], v[164:167], v[144:147], v[60:63]
    ds_read_b64_tr_b16 v[160:161], v50 offset:31840
    ds_read_b64_tr_b16 v[162:163], v50 offset:33120
    s_waitcnt lgkmcnt(10)
    v_mfma_f32_16x16x32_bf16 v[64:67], v[168:171], v[144:147], v[64:67]
    ds_read_b64_tr_b16 v[164:165], v50 offset:31872
    ds_read_b64_tr_b16 v[166:167], v50 offset:33152
    s_waitcnt lgkmcnt(10)
    v_mfma_f32_16x16x32_bf16 v[68:71], v[172:175], v[144:147], v[68:71]
    s_waitcnt lgkmcnt(8)
    v_mfma_f32_16x16x32_bf16 v[52:55], v[176:179], v[148:151], v[52:55]
    s_waitcnt lgkmcnt(6)
    v_mfma_f32_16x16x32_bf16 v[56:59], v[180:183], v[148:151], v[56:59]
    s_waitcnt lgkmcnt(4)
    v_mfma_f32_16x16x32_bf16 v[60:63], v[184:187], v[148:151], v[60:63]
    s_waitcnt lgkmcnt(2)
    v_mfma_f32_16x16x32_bf16 v[64:67], v[160:163], v[148:151], v[64:67]
    s_waitcnt lgkmcnt(0)
    v_mfma_f32_16x16x32_bf16 v[68:71], v[164:167], v[148:151], v[68:71]
    s_nop 7
    s_nop 1
    s_barrier
    v_add_f32 v152, v152, v154
    v_add_f32 v153, v153, v155
    v_mov_b32 v8, v152
    s_nop 1
    v_permlane16_swap_b32 v152, v8
    s_nop 1
    v_add_f32 v152, v152, v8
    v_mov_b32 v8, v152
    s_nop 1
    v_permlane32_swap_b32 v152, v8
    s_nop 1
    v_add_f32 v152, v152, v8
    v_mov_b32 v8, v153
    s_nop 1
    v_permlane16_swap_b32 v153, v8
    s_nop 1
    v_add_f32 v153, v153, v8
    v_mov_b32 v8, v153
    s_nop 1
    v_permlane32_swap_b32 v153, v8
    s_nop 1
    v_add_f32 v153, v153, v8
    s_mov_b32 s9, 0x3acccccd
    v_mul_f32 v152, s9, v152
    v_mul_f32 v153, s9, v153
    v_fma_f32 v153, -v152, v152, v153
    v_max_f32 v153, 0, v153
    s_mov_b32 s9, 0x3727c5ac
    v_cvt_pk_bf16_f32 v152, v152, v152
    v_lshlrev_b32 v152, 16, v152
    v_cvt_pk_bf16_f32 v153, v153, v153
    v_lshlrev_b32 v153, 16, v153
    v_add_f32 v153, s9, v153
    v_cvt_pk_bf16_f32 v153, v153, v153
    v_lshlrev_b32 v153, 16, v153
    v_sqrt_f32 v153, v153
    s_nop 0
    v_cvt_pk_bf16_f32 v153, v153, v153
    v_lshlrev_b32 v153, 16, v153
    v_rcp_f32 v153, v153
    v_mov_b32 v188, 0
    v_mov_b32 v189, 0
    v_lshlrev_b32 v8, 16, v12
    v_and_b32 v9, 0xffff0000, v12
    v_sub_f32 v8, v8, v152
    v_sub_f32 v9, v9, v152
    v_cvt_pk_bf16_f32 v8, v8, v9
    v_and_b32 v9, 0xffff0000, v8
    v_lshlrev_b32 v8, 16, v8
    v_mul_f32 v8, v8, v153
    v_mul_f32 v9, v9, v153
    v_cvt_pk_bf16_f32 v8, v8, v9
    v_and_b32 v9, 0xffff0000, v8
    v_lshlrev_b32 v8, 16, v8
    v_cvt_pk_bf16_f32 v10, v52, v53
    v_and_b32 v11, 0xffff0000, v10
    v_lshlrev_b32 v10, 16, v10
    v_add_f32 v8, v8, v10
    v_add_f32 v9, v9, v11
    v_cvt_pk_bf16_f32 v22, v8, v9
    v_lshlrev_b32 v8, 16, v22
    v_and_b32 v9, 0xffff0000, v22
    v_add_f32 v188, v188, v8
    v_fmac_f32 v189, v8, v8
    v_add_f32 v188, v188, v9
    v_fmac_f32 v189, v9, v9
    v_lshlrev_b32 v8, 16, v13
    v_and_b32 v9, 0xffff0000, v13
    v_sub_f32 v8, v8, v152
    v_sub_f32 v9, v9, v152
    v_cvt_pk_bf16_f32 v8, v8, v9
    v_and_b32 v9, 0xffff0000, v8
    v_lshlrev_b32 v8, 16, v8
    v_mul_f32 v8, v8, v153
    v_mul_f32 v9, v9, v153
    v_cvt_pk_bf16_f32 v8, v8, v9
    v_and_b32 v9, 0xffff0000, v8
    v_lshlrev_b32 v8, 16, v8
    v_cvt_pk_bf16_f32 v10, v54, v55
    v_and_b32 v11, 0xffff0000, v10
    v_lshlrev_b32 v10, 16, v10
    v_add_f32 v8, v8, v10
    v_add_f32 v9, v9, v11
    v_cvt_pk_bf16_f32 v23, v8, v9
    v_lshlrev_b32 v8, 16, v23
    v_and_b32 v9, 0xffff0000, v23
    v_add_f32 v188, v188, v8
    v_fmac_f32 v189, v8, v8
    v_add_f32 v188, v188, v9
    v_fmac_f32 v189, v9, v9
    buffer_store_dwordx2 v[22:23], v156, s[48:51], 0 offen offset:0 sc1
    v_lshlrev_b32 v8, 16, v14
    v_and_b32 v9, 0xffff0000, v14
    v_sub_f32 v8, v8, v152
    v_sub_f32 v9, v9, v152
    v_cvt_pk_bf16_f32 v8, v8, v9
    v_and_b32 v9, 0xffff0000, v8
    v_lshlrev_b32 v8, 16, v8
    v_mul_f32 v8, v8, v153
    v_mul_f32 v9, v9, v153
    v_cvt_pk_bf16_f32 v8, v8, v9
    v_and_b32 v9, 0xffff0000, v8
    v_lshlrev_b32 v8, 16, v8
    v_cvt_pk_bf16_f32 v10, v56, v57
    v_and_b32 v11, 0xffff0000, v10
    v_lshlrev_b32 v10, 16, v10
    v_add_f32 v8, v8, v10
    v_add_f32 v9, v9, v11
    v_cvt_pk_bf16_f32 v24, v8, v9
    v_lshlrev_b32 v8, 16, v24
    v_and_b32 v9, 0xffff0000, v24
    v_add_f32 v188, v188, v8
    v_fmac_f32 v189, v8, v8
    v_add_f32 v188, v188, v9
    v_fmac_f32 v189, v9, v9
    v_lshlrev_b32 v8, 16, v15
    v_and_b32 v9, 0xffff0000, v15
    v_sub_f32 v8, v8, v152
    v_sub_f32 v9, v9, v152
    v_cvt_pk_bf16_f32 v8, v8, v9
    v_and_b32 v9, 0xffff0000, v8
    v_lshlrev_b32 v8, 16, v8
    v_mul_f32 v8, v8, v153
    v_mul_f32 v9, v9, v153
    v_cvt_pk_bf16_f32 v8, v8, v9
    v_and_b32 v9, 0xffff0000, v8
    v_lshlrev_b32 v8, 16, v8
    v_cvt_pk_bf16_f32 v10, v58, v59
    v_and_b32 v11, 0xffff0000, v10
    v_lshlrev_b32 v10, 16, v10
    v_add_f32 v8, v8, v10
    v_add_f32 v9, v9, v11
    v_cvt_pk_bf16_f32 v25, v8, v9
    v_lshlrev_b32 v8, 16, v25
    v_and_b32 v9, 0xffff0000, v25
    v_add_f32 v188, v188, v8
    v_fmac_f32 v189, v8, v8
    v_add_f32 v188, v188, v9
    v_fmac_f32 v189, v9, v9
    buffer_store_dwordx2 v[24:25], v156, s[48:51], 0 offen offset:512 sc1
    v_lshlrev_b32 v8, 16, v16
    v_and_b32 v9, 0xffff0000, v16
    v_sub_f32 v8, v8, v152
    v_sub_f32 v9, v9, v152
    v_cvt_pk_bf16_f32 v8, v8, v9
    v_and_b32 v9, 0xffff0000, v8
    v_lshlrev_b32 v8, 16, v8
    v_mul_f32 v8, v8, v153
    v_mul_f32 v9, v9, v153
    v_cvt_pk_bf16_f32 v8, v8, v9
    v_and_b32 v9, 0xffff0000, v8
    v_lshlrev_b32 v8, 16, v8
    v_cvt_pk_bf16_f32 v10, v60, v61
    v_and_b32 v11, 0xffff0000, v10
    v_lshlrev_b32 v10, 16, v10
    v_add_f32 v8, v8, v10
    v_add_f32 v9, v9, v11
    v_cvt_pk_bf16_f32 v26, v8, v9
    v_lshlrev_b32 v8, 16, v26
    v_and_b32 v9, 0xffff0000, v26
    v_add_f32 v188, v188, v8
    v_fmac_f32 v189, v8, v8
    v_add_f32 v188, v188, v9
    v_fmac_f32 v189, v9, v9
    v_lshlrev_b32 v8, 16, v17
    v_and_b32 v9, 0xffff0000, v17
    v_sub_f32 v8, v8, v152
    v_sub_f32 v9, v9, v152
    v_cvt_pk_bf16_f32 v8, v8, v9
    v_and_b32 v9, 0xffff0000, v8
    v_lshlrev_b32 v8, 16, v8
    v_mul_f32 v8, v8, v153
    v_mul_f32 v9, v9, v153
    v_cvt_pk_bf16_f32 v8, v8, v9
    v_and_b32 v9, 0xffff0000, v8
    v_lshlrev_b32 v8, 16, v8
    v_cvt_pk_bf16_f32 v10, v62, v63
    v_and_b32 v11, 0xffff0000, v10
    v_lshlrev_b32 v10, 16, v10
    v_add_f32 v8, v8, v10
    v_add_f32 v9, v9, v11
    v_cvt_pk_bf16_f32 v27, v8, v9
    v_lshlrev_b32 v8, 16, v27
    v_and_b32 v9, 0xffff0000, v27
    v_add_f32 v188, v188, v8
    v_fmac_f32 v189, v8, v8
    v_add_f32 v188, v188, v9
    v_fmac_f32 v189, v9, v9
    buffer_store_dwordx2 v[26:27], v156, s[48:51], 0 offen offset:1024 sc1
    v_lshlrev_b32 v8, 16, v18
    v_and_b32 v9, 0xffff0000, v18
    v_sub_f32 v8, v8, v152
    v_sub_f32 v9, v9, v152
    v_cvt_pk_bf16_f32 v8, v8, v9
    v_and_b32 v9, 0xffff0000, v8
    v_lshlrev_b32 v8, 16, v8
    v_mul_f32 v8, v8, v153
    v_mul_f32 v9, v9, v153
    v_cvt_pk_bf16_f32 v8, v8, v9
    v_and_b32 v9, 0xffff0000, v8
    v_lshlrev_b32 v8, 16, v8
    v_cvt_pk_bf16_f32 v10, v64, v65
    v_and_b32 v11, 0xffff0000, v10
    v_lshlrev_b32 v10, 16, v10
    v_add_f32 v8, v8, v10
    v_add_f32 v9, v9, v11
    v_cvt_pk_bf16_f32 v28, v8, v9
    v_lshlrev_b32 v8, 16, v28
    v_and_b32 v9, 0xffff0000, v28
    v_add_f32 v188, v188, v8
    v_fmac_f32 v189, v8, v8
    v_add_f32 v188, v188, v9
    v_fmac_f32 v189, v9, v9
    v_lshlrev_b32 v8, 16, v19
    v_and_b32 v9, 0xffff0000, v19
    v_sub_f32 v8, v8, v152
    v_sub_f32 v9, v9, v152
    v_cvt_pk_bf16_f32 v8, v8, v9
    v_and_b32 v9, 0xffff0000, v8
    v_lshlrev_b32 v8, 16, v8
    v_mul_f32 v8, v8, v153
    v_mul_f32 v9, v9, v153
    v_cvt_pk_bf16_f32 v8, v8, v9
    v_and_b32 v9, 0xffff0000, v8
    v_lshlrev_b32 v8, 16, v8
    v_cvt_pk_bf16_f32 v10, v66, v67
    v_and_b32 v11, 0xffff0000, v10
    v_lshlrev_b32 v10, 16, v10
    v_add_f32 v8, v8, v10
    v_add_f32 v9, v9, v11
    v_cvt_pk_bf16_f32 v29, v8, v9
    v_lshlrev_b32 v8, 16, v29
    v_and_b32 v9, 0xffff0000, v29
    v_add_f32 v188, v188, v8
    v_fmac_f32 v189, v8, v8
    v_add_f32 v188, v188, v9
    v_fmac_f32 v189, v9, v9
    buffer_store_dwordx2 v[28:29], v156, s[48:51], 0 offen offset:1536 sc1
    v_lshlrev_b32 v8, 16, v20
    v_and_b32 v9, 0xffff0000, v20
    v_sub_f32 v8, v8, v152
    v_sub_f32 v9, v9, v152
    v_cvt_pk_bf16_f32 v8, v8, v9
    v_and_b32 v9, 0xffff0000, v8
    v_lshlrev_b32 v8, 16, v8
    v_mul_f32 v8, v8, v153
    v_mul_f32 v9, v9, v153
    v_cvt_pk_bf16_f32 v8, v8, v9
    v_and_b32 v9, 0xffff0000, v8
    v_lshlrev_b32 v8, 16, v8
    v_cvt_pk_bf16_f32 v10, v68, v69
    v_and_b32 v11, 0xffff0000, v10
    v_lshlrev_b32 v10, 16, v10
    v_add_f32 v8, v8, v10
    v_add_f32 v9, v9, v11
    v_cvt_pk_bf16_f32 v30, v8, v9
    v_lshlrev_b32 v8, 16, v30
    v_and_b32 v9, 0xffff0000, v30
    v_add_f32 v188, v188, v8
    v_fmac_f32 v189, v8, v8
    v_add_f32 v188, v188, v9
    v_fmac_f32 v189, v9, v9
    v_lshlrev_b32 v8, 16, v21
    v_and_b32 v9, 0xffff0000, v21
    v_sub_f32 v8, v8, v152
    v_sub_f32 v9, v9, v152
    v_cvt_pk_bf16_f32 v8, v8, v9
    v_and_b32 v9, 0xffff0000, v8
    v_lshlrev_b32 v8, 16, v8
    v_mul_f32 v8, v8, v153
    v_mul_f32 v9, v9, v153
    v_cvt_pk_bf16_f32 v8, v8, v9
    v_and_b32 v9, 0xffff0000, v8
    v_lshlrev_b32 v8, 16, v8
    v_cvt_pk_bf16_f32 v10, v70, v71
    v_and_b32 v11, 0xffff0000, v10
    v_lshlrev_b32 v10, 16, v10
    v_add_f32 v8, v8, v10
    v_add_f32 v9, v9, v11
    v_cvt_pk_bf16_f32 v31, v8, v9
    v_lshlrev_b32 v8, 16, v31
    v_and_b32 v9, 0xffff0000, v31
    v_add_f32 v188, v188, v8
    v_fmac_f32 v189, v8, v8
    v_add_f32 v188, v188, v9
    v_fmac_f32 v189, v9, v9
    buffer_store_dwordx2 v[30:31], v156, s[48:51], 0 offen offset:2048 sc1
    v_mov_b32 v8, v188
    s_nop 1
    v_permlane16_swap_b32 v188, v8
    s_nop 1
    v_add_f32 v188, v188, v8
    v_mov_b32 v8, v188
    s_nop 1
    v_permlane32_swap_b32 v188, v8
    s_nop 1
    v_add_f32 v188, v188, v8
    v_mov_b32 v8, v189
    s_nop 1
    v_permlane16_swap_b32 v189, v8
    s_nop 1
    v_add_f32 v189, v189, v8
    v_mov_b32 v8, v189
    s_nop 1
    v_permlane32_swap_b32 v189, v8
    s_nop 1
    v_add_f32 v189, v189, v8
    s_add_u32 s60, s36, 28573696
    s_addc_u32 s61, s37, 0
    s_and_b32 s61, s61, 0xffff
    s_mov_b32 s62, 131072
    s_mov_b32 s63, 0x00020000
    v_lshlrev_b32 v8, 6, v44
    s_lshl_b32 s9, s4, 3
    v_add_u32 v8, s9, v8
    s_mov_b32 s9, 0x80000000
    v_mov_b32 v9, s9
    v_cmp_eq_u32 vcc, 0, v4
    s_nop 1
    v_cndmask_b32 v8, v9, v8, vcc
    buffer_store_dwordx2 v[188:189], v8, s[60:63], 0 offen sc1
    s_waitcnt vmcnt(0)
    s_barrier
    s_and_b32 s3, s2, 7
    s_lshr_b32 s4, s2, 3
    s_lshl_b32 s3, s3, 1
    s_and_b32 s5, s4, 1
    s_add_u32 s3, s3, s5
    s_lshr_b32 s4, s4, 1
    s_mul_i32 s5, s3, 128
    s_mul_i32 s6, s4, 96
    s_lshr_b32 s9, s5, 4
    s_mul_i32 s64, s7, 2
    s_add_u32 s64, s64, s9
    v_lshl_add_u32 v44, s64, 4, v3
    s_add_u32 s65, s64, 1
    v_lshl_add_u32 v45, s65, 4, v3
    v_lshlrev_b32 v8, 4, v2
    s_mul_i32 s9, s64, 20480
    v_add_u32 v46, s9, v8
    s_mul_i32 s9, s65, 20480
    v_add_u32 v47, s9, v8
    s_lshr_b32 s12, s2, 3
    s_lshr_b32 s12, s12, 2
    s_mul_i32 s12, s12, 80
    v_add_u32 v8, 0, v0
    v_mul_u32_u24 v9, 1639, v8
    v_lshrrev_b32 v9, 14, v9
    v_mul_u32_u24 v10, 10, v9
    v_sub_u32 v10, v8, v10
    v_and_b32 v34, 0xfffffff3, v9
    v_bfe_u32 v8, v9, 2, 1
    v_lshl_add_u32 v34, v8, 3, v34
    v_bfe_u32 v8, v9, 3, 1
    v_lshl_add_u32 v34, v8, 2, v34
    v_mul_u32_u24 v34, 1280, v34
    v_lshl_add_u32 v34, v10, 4, v34
    v_lshl_add_u32 v34, s12, 1, v34
    v_add_u32 v8, 256, v0
    v_mul_u32_u24 v9, 1639, v8
    v_lshrrev_b32 v9, 14, v9
    v_mul_u32_u24 v10, 10, v9
    v_sub_u32 v10, v8, v10
    v_and_b32 v35, 0xfffffff3, v9
    v_bfe_u32 v8, v9, 2, 1
    v_lshl_add_u32 v35, v8, 3, v35
    v_bfe_u32 v8, v9, 3, 1
    v_lshl_add_u32 v35, v8, 2, v35
    v_mul_u32_u24 v35, 1280, v35
    v_lshl_add_u32 v35, v10, 4, v35
    v_lshl_add_u32 v35, s12, 1, v35
    v_add_u32 v8, 512, v0
    v_mul_u32_u24 v9, 1639, v8
    v_lshrrev_b32 v9, 14, v9
    v_mul_u32_u24 v10, 10, v9
    v_sub_u32 v10, v8, v10
    v_and_b32 v36, 0xfffffff3, v9
    v_bfe_u32 v8, v9, 2, 1
    v_lshl_add_u32 v36, v8, 3, v36
    v_bfe_u32 v8, v9, 3, 1
    v_lshl_add_u32 v36, v8, 2, v36
    v_mul_u32_u24 v36, 1280, v36
    v_lshl_add_u32 v36, v10, 4, v36
    v_lshl_add_u32 v36, s12, 1, v36
    v_add_u32 v8, 768, v0
    v_mul_u32_u24 v9, 1639, v8
    v_lshrrev_b32 v9, 14, v9
    v_mul_u32_u24 v10, 10, v9
    v_sub_u32 v10, v8, v10
    v_and_b32 v37, 0xfffffff3, v9
    v_bfe_u32 v8, v9, 2, 1
    v_lshl_add_u32 v37, v8, 3, v37
    v_bfe_u32 v8, v9, 3, 1
    v_lshl_add_u32 v37, v8, 2, v37
    v_mul_u32_u24 v37, 1280, v37
    v_lshl_add_u32 v37, v10, 4, v37
    v_lshl_add_u32 v37, s12, 1, v37
    v_add_u32 v8, 1024, v0
    v_mul_u32_u24 v9, 1639, v8
    v_lshrrev_b32 v9, 14, v9
    v_mul_u32_u24 v10, 10, v9
    v_sub_u32 v10, v8, v10
    v_and_b32 v38, 0xfffffff3, v9
    v_bfe_u32 v8, v9, 2, 1
    v_lshl_add_u32 v38, v8, 3, v38
    v_bfe_u32 v8, v9, 3, 1
    v_lshl_add_u32 v38, v8, 2, v38
    v_mul_u32_u24 v38, 1280, v38
    v_lshl_add_u32 v38, v10, 4, v38
    v_lshl_add_u32 v38, s12, 1, v38
    v_bfe_u32 v8, v0, 2, 3
    v_bfe_u32 v9, v0, 5, 1
    v_lshl_add_u32 v9, v9, 4, v8
    v_mul_u32_u24 v9, 192, v9
    v_and_b32 v10, 3, v0
    v_lshl_add_u32 v9, v10, 3, v9
    v_lshrrev_b32 v8, 2, v8
    v_xor_b32 v10, 0, v8
    v_lshl_add_u32 v48, v10, 5, v9
    v_add_u32 v49, 65536, v48
    v_xor_b32 v10, 1, v8
    v_lshl_add_u32 v50, v10, 5, v9
    v_add_u32 v51, 65536, v50
    s_add_u32 s9, s7, 0
    s_min_u32 s9, s9, 5
    v_xor_b32 v10, s9, v8
    v_lshl_add_u32 v52, v10, 5, v9
    v_add_u32 v53, 65536, v52
    s_add_u32 s9, s7, 4
    s_min_u32 s9, s9, 5
    v_xor_b32 v10, s9, v8
    v_lshl_add_u32 v54, v10, 5, v9
    v_add_u32 v55, 65536, v54
    v_mov_b32 v56, 0x3f803f80
    v_mov_b32 v57, 0x3f803f80
    v_mov_b32 v58, 0x3f803f80
    v_mov_b32 v59, 0x3f803f80
    s_add_u32 s40, s36, 17825792
    s_addc_u32 s41, s37, 0
    s_and_b32 s41, s41, 0xffff
    s_mov_b32 s42, 2621440
    s_mov_b32 s43, 0x00020000
    s_mov_b32 s44, s30
    s_mov_b32 s45, s31
    s_and_b32 s45, s45, 0xffff
    s_mov_b32 s46, 1966080
    s_mov_b32 s47, 0x00020000
    s_mov_b32 s10, 983040
    s_add_u32 m0, s8, 61440
    s_nop 0
    buffer_load_dwordx4 v39, s[84:87], s10 offen lds
    s_mov_b32 s10, 983040
    s_add_u32 m0, s8, 65536
    s_nop 0
    buffer_load_dwordx4 v40, s[84:87], s10 offen lds
    s_mov_b32 s10, 983040
    s_add_u32 m0, s8, 69632
    s_nop 0
    buffer_load_dwordx4 v41, s[84:87], s10 offen lds
    s_mov_b32 s10, 1179648
    s_add_u32 m0, s8, 73728
    s_nop 0
    buffer_load_dwordx4 v39, s[84:87], s10 offen lds
    s_mov_b32 s10, 1179648
    s_add_u32 m0, s8, 77824
    s_nop 0
    buffer_load_dwordx4 v40, s[84:87], s10 offen lds
    s_mov_b32 s10, 1179648
    s_add_u32 m0, s8, 81920
    s_nop 0
    buffer_load_dwordx4 v41, s[84:87], s10 offen lds
    s_mov_b32 s10, 1376256
    s_add_u32 m0, s8, 86016
    s_nop 0
    buffer_load_dwordx4 v39, s[84:87], s10 offen lds
    s_mov_b32 s10, 1376256
    s_add_u32 m0, s8, 90112
    s_nop 0
    buffer_load_dwordx4 v40, s[84:87], s10 offen lds
    s_mov_b32 s10, 1376256
    s_add_u32 m0, s8, 94208
    s_nop 0
    buffer_load_dwordx4 v41, s[84:87], s10 offen lds
    s_mov_b32 s10, 1572864
    s_add_u32 m0, s8, 98304
    s_nop 0
    buffer_load_dwordx4 v39, s[84:87], s10 offen lds
    s_mov_b32 s10, 1572864
    s_add_u32 m0, s8, 102400
    s_nop 0
    buffer_load_dwordx4 v40, s[84:87], s10 offen lds
    s_mov_b32 s10, 1572864
    s_add_u32 m0, s8, 106496
    s_nop 0
    buffer_load_dwordx4 v41, s[84:87], s10 offen lds
    s_mov_b32 s10, 1769472
    s_add_u32 m0, s8, 110592
    s_nop 0
    buffer_load_dwordx4 v39, s[84:87], s10 offen lds
    s_mov_b32 s10, 1769472
    s_add_u32 m0, s8, 114688
    s_nop 0
    buffer_load_dwordx4 v40, s[84:87], s10 offen lds
    s_mov_b32 s10, 1769472
    s_add_u32 m0, s8, 118784
    s_nop 0
    buffer_load_dwordx4 v41, s[84:87], s10 offen lds
    s_barrier
    s_mov_b32 s10, 0
    buffer_load_dwordx4 v[120:123], v46, s[40:43], s10 offen offset:0 sc1
    s_mov_b32 s10, 0
    buffer_load_dwordx4 v[124:127], v47, s[40:43], s10 offen offset:0 sc1
    s_mov_b32 s10, 0
    buffer_load_dwordx4 v[128:131], v46, s[40:43], s10 offen offset:1024 sc1
    s_mov_b32 s10, 0
    buffer_load_dwordx4 v[132:135], v47, s[40:43], s10 offen offset:1024 sc1
    s_add_u32 s60, s36, 28573696
    s_addc_u32 s61, s37, 0
    s_and_b32 s61, s61, 0xffff
    s_mov_b32 s62, 131072
    s_mov_b32 s63, 0x00020000
    v_lshlrev_b32 v8, 6, v44
    v_lshl_add_u32 v8, v4, 4, v8
    buffer_load_dwordx4 v[184:187], v8, s[60:63], 0 offen sc1
    s_add_u32 s48, s36, 20971520
    s_addc_u32 s49, s37, 0
    s_and_b32 s49, s49, 0xffff
    s_mov_b32 s50, 6291456
    s_mov_b32 s51, 0x00020000
    s_mul_i32 s9, s64, 49152
    s_lshl_b32 s14, s6, 5
    s_add_u32 s9, s9, s14
    v_lshrrev_b32 v8, 1, v4
    v_lshl_add_u32 v8, v8, 4, v3
    v_lshlrev_b32 v188, 4, v8
    v_and_b32 v8, 1, v4
    v_lshl_add_u32 v188, v8, 3, v188
    v_add_u32 v188, s9, v188
    v_mov_b32 v190, 0xc0135761
    v_mov_b32 v191, 0xc0135761
    v_mov_b32 v192, 0xbdd2d3e8
    v_mov_b32 v193, 0xbdd2d3e8
    v_mov_b32 v194, 0x3f800000
    v_mov_b32 v195, 0x3f800000
    s_add_u32 s60, s36, 28573696
    s_addc_u32 s61, s37, 0
    s_and_b32 s61, s61, 0xffff
    s_mov_b32 s62, 131072
    s_mov_b32 s63, 0x00020000
    v_lshlrev_b32 v8, 6, v45
    v_lshl_add_u32 v8, v4, 4, v8
    buffer_load_dwordx4 v[196:199], v8, s[60:63], 0 offen sc1
    s_add_u32 s48, s36, 20971520
    s_addc_u32 s49, s37, 0
    s_and_b32 s49, s49, 0xffff
    s_mov_b32 s50, 6291456
    s_mov_b32 s51, 0x00020000
    s_mul_i32 s9, s65, 49152
    s_lshl_b32 s14, s6, 5
    s_add_u32 s9, s9, s14
    v_lshrrev_b32 v8, 1, v4
    v_lshl_add_u32 v8, v8, 4, v3
    v_lshlrev_b32 v200, 4, v8
    v_and_b32 v8, 1, v4
    v_lshl_add_u32 v200, v8, 3, v200
    v_add_u32 v200, s9, v200
    v_mov_b32 v202, 0xc0135761
    v_mov_b32 v203, 0xc0135761
    v_mov_b32 v204, 0xbdd2d3e8
    v_mov_b32 v205, 0xbdd2d3e8
    v_mov_b32 v206, 0x3f800000
    v_mov_b32 v207, 0x3f800000
    s_mov_b32 s10, 2048
    buffer_load_dwordx4 v[136:139], v46, s[40:43], s10 offen offset:0 sc1
    s_mov_b32 s10, 2048
    buffer_load_dwordx4 v[140:143], v47, s[40:43], s10 offen offset:0 sc1
    s_mov_b32 s10, 2048
    buffer_load_dwordx4 v[144:147], v46, s[40:43], s10 offen offset:1024 sc1
    s_mov_b32 s10, 2048
    buffer_load_dwordx4 v[148:151], v47, s[40:43], s10 offen offset:1024 sc1
    v_mov_b32 v72, 0
    v_mov_b32 v73, 0
    v_mov_b32 v74, 0
    v_mov_b32 v75, 0
    v_mov_b32 v76, 0
    v_mov_b32 v77, 0
    v_mov_b32 v78, 0
    v_mov_b32 v79, 0
    v_mov_b32 v80, 0
    v_mov_b32 v81, 0
    v_mov_b32 v82, 0
    v_mov_b32 v83, 0
    v_mov_b32 v84, 0
    v_mov_b32 v85, 0
    v_mov_b32 v86, 0
    v_mov_b32 v87, 0
    v_mov_b32 v88, 0
    v_mov_b32 v89, 0
    v_mov_b32 v90, 0
    v_mov_b32 v91, 0
    v_mov_b32 v92, 0
    v_mov_b32 v93, 0
    v_mov_b32 v94, 0
    v_mov_b32 v95, 0
    v_mov_b32 v96, 0
    v_mov_b32 v97, 0
    v_mov_b32 v98, 0
    v_mov_b32 v99, 0
    v_mov_b32 v100, 0
    v_mov_b32 v101, 0
    v_mov_b32 v102, 0
    v_mov_b32 v103, 0
    v_mov_b32 v104, 0
    v_mov_b32 v105, 0
    v_mov_b32 v106, 0
    v_mov_b32 v107, 0
    v_mov_b32 v108, 0
    v_mov_b32 v109, 0
    v_mov_b32 v110, 0
    v_mov_b32 v111, 0
    v_mov_b32 v112, 0
    v_mov_b32 v113, 0
    v_mov_b32 v114, 0
    v_mov_b32 v115, 0
    v_mov_b32 v116, 0
    v_mov_b32 v117, 0
    v_mov_b32 v118, 0
    v_mov_b32 v119, 0
    v_mov_b32 v64, 0
    v_mov_b32 v65, 0
    v_mov_b32 v66, 0
    v_mov_b32 v67, 0
    v_mov_b32 v68, 0
    v_mov_b32 v69, 0
    v_mov_b32 v70, 0
    v_mov_b32 v71, 0
    s_waitcnt vmcnt(6)
    s_barrier
    ds_read_b64_tr_b16 v[208:209], v48 offset:0
    ds_read_b64_tr_b16 v[210:211], v48 offset:1536
    ds_read_b64_tr_b16 v[212:213], v50 offset:0
    ds_read_b64_tr_b16 v[214:215], v50 offset:1536
    ds_read_b64_tr_b16 v[216:217], v48 offset:64
    ds_read_b64_tr_b16 v[218:219], v48 offset:1600
    ds_read_b64_tr_b16 v[220:221], v50 offset:64
    ds_read_b64_tr_b16 v[222:223], v50 offset:1600
    ds_read_b64_tr_b16 v[224:225], v48 offset:128
    ds_read_b64_tr_b16 v[226:227], v48 offset:1664
    ds_read_b64_tr_b16 v[228:229], v50 offset:128
    ds_read_b64_tr_b16 v[230:231], v50 offset:1664
    s_waitcnt lgkmcnt(10)
    v_mfma_f32_16x16x32_bf16 v[72:75], v[208:211], v[120:123], v[72:75]
    v_mfma_f32_16x16x32_bf16 v[96:99], v[208:211], v[124:127], v[96:99]
    s_mov_b32 s10, 4096
    buffer_load_dwordx4 v[152:155], v46, s[40:43], s10 offen offset:0 sc1
    ds_read_b64_tr_b16 v[232:233], v52 offset:0
    ds_read_b64_tr_b16 v[234:235], v52 offset:1536
    s_waitcnt lgkmcnt(10)
    v_mfma_f32_16x16x32_bf16 v[76:79], v[212:215], v[120:123], v[76:79]
    v_mfma_f32_16x16x32_bf16 v[100:103], v[212:215], v[124:127], v[100:103]
    s_mov_b32 s10, 4096
    buffer_load_dwordx4 v[156:159], v47, s[40:43], s10 offen offset:0 sc1
    ds_read_b64_tr_b16 v[208:209], v54 offset:0
    ds_read_b64_tr_b16 v[210:211], v54 offset:1536
    s_waitcnt lgkmcnt(10)
    v_mfma_f32_16x16x32_bf16 v[80:83], v[216:219], v[120:123], v[80:83]
    v_mfma_f32_16x16x32_bf16 v[104:107], v[216:219], v[124:127], v[104:107]
    s_mov_b32 s10, 4096
    buffer_load_dwordx4 v[160:163], v46, s[40:43], s10 offen offset:1024 sc1
    ds_read_b64_tr_b16 v[212:213], v48 offset:6144
    ds_read_b64_tr_b16 v[214:215], v48 offset:7680
    s_waitcnt lgkmcnt(10)
    v_mfma_f32_16x16x32_bf16 v[84:87], v[220:223], v[120:123], v[84:87]
    v_mfma_f32_16x16x32_bf16 v[108:111], v[220:223], v[124:127], v[108:111]
    s_mov_b32 s10, 4096
    buffer_load_dwordx4 v[164:167], v47, s[40:43], s10 offen offset:1024 sc1
    ds_read_b64_tr_b16 v[216:217], v50 offset:6144
    ds_read_b64_tr_b16 v[218:219], v50 offset:7680
    s_waitcnt lgkmcnt(10)
    v_mfma_f32_16x16x32_bf16 v[88:91], v[224:227], v[120:123], v[88:91]
    v_mfma_f32_16x16x32_bf16 v[112:115], v[224:227], v[124:127], v[112:115]
    ds_read_b64_tr_b16 v[220:221], v48 offset:6208
    ds_read_b64_tr_b16 v[222:223], v48 offset:7744
    s_waitcnt lgkmcnt(10)
    v_mfma_f32_16x16x32_bf16 v[92:95], v[228:231], v[120:123], v[92:95]
    v_mfma_f32_16x16x32_bf16 v[116:119], v[228:231], v[124:127], v[116:119]
    ds_read_b64_tr_b16 v[224:225], v50 offset:6208
    ds_read_b64_tr_b16 v[226:227], v50 offset:7744
    s_waitcnt lgkmcnt(10)
    v_mfma_f32_16x16x32_bf16 v[64:67], v[232:235], v[56:59], v[64:67]
    ds_read_b64_tr_b16 v[228:229], v48 offset:6272
    ds_read_b64_tr_b16 v[230:231], v48 offset:7808
    s_waitcnt lgkmcnt(10)
    v_mfma_f32_16x16x32_bf16 v[68:71], v[208:211], v[56:59], v[68:71]
    ds_read_b64_tr_b16 v[232:233], v50 offset:6272
    ds_read_b64_tr_b16 v[234:235], v50 offset:7808
    s_waitcnt lgkmcnt(10)
    v_mfma_f32_16x16x32_bf16 v[72:75], v[212:215], v[128:131], v[72:75]
    v_mfma_f32_16x16x32_bf16 v[96:99], v[212:215], v[132:135], v[96:99]
    ds_read_b64_tr_b16 v[208:209], v52 offset:6144
    ds_read_b64_tr_b16 v[210:211], v52 offset:7680
    s_waitcnt lgkmcnt(10)
    v_mfma_f32_16x16x32_bf16 v[76:79], v[216:219], v[128:131], v[76:79]
    v_mfma_f32_16x16x32_bf16 v[100:103], v[216:219], v[132:135], v[100:103]
    ds_read_b64_tr_b16 v[212:213], v54 offset:6144
    ds_read_b64_tr_b16 v[214:215], v54 offset:7680
    s_waitcnt lgkmcnt(10)
    v_mfma_f32_16x16x32_bf16 v[80:83], v[220:223], v[128:131], v[80:83]
    v_mfma_f32_16x16x32_bf16 v[104:107], v[220:223], v[132:135], v[104:107]
    s_waitcnt vmcnt(4)
    s_barrier
    ds_read_b64_tr_b16 v[216:217], v48 offset:12288
    ds_read_b64_tr_b16 v[218:219], v48 offset:13824
    s_waitcnt lgkmcnt(10)
    v_mfma_f32_16x16x32_bf16 v[84:87], v[224:227], v[128:131], v[84:87]
    v_mfma_f32_16x16x32_bf16 v[108:111], v[224:227], v[132:135], v[108:111]
    s_mov_b32 s10, 6144
    buffer_load_dwordx4 v[168:171], v46, s[40:43], s10 offen offset:0 sc1
    ds_read_b64_tr_b16 v[220:221], v50 offset:12288
    ds_read_b64_tr_b16 v[222:223], v50 offset:13824
    s_waitcnt lgkmcnt(10)
    v_mfma_f32_16x16x32_bf16 v[88:91], v[228:231], v[128:131], v[88:91]
    v_mfma_f32_16x16x32_bf16 v[112:115], v[228:231], v[132:135], v[112:115]
    s_mov_b32 s10, 6144
    buffer_load_dwordx4 v[172:175], v47, s[40:43], s10 offen offset:0 sc1
    ds_read_b64_tr_b16 v[224:225], v48 offset:12352
    ds_read_b64_tr_b16 v[226:227], v48 offset:13888
    s_waitcnt lgkmcnt(10)
    v_mfma_f32_16x16x32_bf16 v[92:95], v[232:235], v[128:131], v[92:95]
    v_mfma_f32_16x16x32_bf16 v[116:119], v[232:235], v[132:135], v[116:119]
    s_mov_b32 s10, 6144
    buffer_load_dwordx4 v[176:179], v46, s[40:43], s10 offen offset:1024 sc1
    ds_read_b64_tr_b16 v[228:229], v50 offset:12352
    ds_read_b64_tr_b16 v[230:231], v50 offset:13888
    s_waitcnt lgkmcnt(10)
    v_mfma_f32_16x16x32_bf16 v[64:67], v[208:211], v[56:59], v[64:67]
    s_mov_b32 s10, 6144
    buffer_load_dwordx4 v[180:183], v47, s[40:43], s10 offen offset:1024 sc1
    ds_read_b64_tr_b16 v[232:233], v48 offset:12416
    ds_read_b64_tr_b16 v[234:235], v48 offset:13952
    s_waitcnt lgkmcnt(10)
    v_mfma_f32_16x16x32_bf16 v[68:71], v[212:215], v[56:59], v[68:71]
    ds_read_b64_tr_b16 v[208:209], v50 offset:12416
    ds_read_b64_tr_b16 v[210:211], v50 offset:13952
    s_waitcnt lgkmcnt(10)
    v_mfma_f32_16x16x32_bf16 v[72:75], v[216:219], v[136:139], v[72:75]
    v_mfma_f32_16x16x32_bf16 v[96:99], v[216:219], v[140:143], v[96:99]
    ds_read_b64_tr_b16 v[212:213], v52 offset:12288
    ds_read_b64_tr_b16 v[214:215], v52 offset:13824
    s_waitcnt lgkmcnt(10)
    v_mfma_f32_16x16x32_bf16 v[76:79], v[220:223], v[136:139], v[76:79]
    v_mfma_f32_16x16x32_bf16 v[100:103], v[220:223], v[140:143], v[100:103]
    ds_read_b64_tr_b16 v[216:217], v54 offset:12288
    ds_read_b64_tr_b16 v[218:219], v54 offset:13824
    s_waitcnt lgkmcnt(10)
    v_mfma_f32_16x16x32_bf16 v[80:83], v[224:227], v[136:139], v[80:83]
    v_mfma_f32_16x16x32_bf16 v[104:107], v[224:227], v[140:143], v[104:107]
    ds_read_b64_tr_b16 v[220:221], v48 offset:18432
    ds_read_b64_tr_b16 v[222:223], v48 offset:19968
    s_waitcnt lgkmcnt(10)
    v_mfma_f32_16x16x32_bf16 v[84:87], v[228:231], v[136:139], v[84:87]
    v_mfma_f32_16x16x32_bf16 v[108:111], v[228:231], v[140:143], v[108:111]
    ds_read_b64_tr_b16 v[224:225], v50 offset:18432
    ds_read_b64_tr_b16 v[226:227], v50 offset:19968
    s_waitcnt lgkmcnt(10)
    v_mfma_f32_16x16x32_bf16 v[88:91], v[232:235], v[136:139], v[88:91]
    v_mfma_f32_16x16x32_bf16 v[112:115], v[232:235], v[140:143], v[112:115]
    ds_read_b64_tr_b16 v[228:229], v48 offset:18496
    ds_read_b64_tr_b16 v[230:231], v48 offset:20032
    s_waitcnt lgkmcnt(10)
    v_mfma_f32_16x16x32_bf16 v[92:95], v[208:211], v[136:139], v[92:95]
    v_mfma_f32_16x16x32_bf16 v[116:119], v[208:211], v[140:143], v[116:119]
    ds_read_b64_tr_b16 v[232:233], v50 offset:18496
    ds_read_b64_tr_b16 v[234:235], v50 offset:20032
    s_waitcnt lgkmcnt(10)
    v_mfma_f32_16x16x32_bf16 v[64:67], v[212:215], v[56:59], v[64:67]
    ds_read_b64_tr_b16 v[208:209], v48 offset:18560
    ds_read_b64_tr_b16 v[210:211], v48 offset:20096
    s_waitcnt lgkmcnt(10)
    v_mfma_f32_16x16x32_bf16 v[68:71], v[216:219], v[56:59], v[68:71]
    ds_read_b64_tr_b16 v[212:213], v50 offset:18560
    ds_read_b64_tr_b16 v[214:215], v50 offset:20096
    s_waitcnt lgkmcnt(10)
    v_mfma_f32_16x16x32_bf16 v[72:75], v[220:223], v[144:147], v[72:75]
    v_mfma_f32_16x16x32_bf16 v[96:99], v[220:223], v[148:151], v[96:99]
    ds_read_b64_tr_b16 v[216:217], v52 offset:18432
    ds_read_b64_tr_b16 v[218:219], v52 offset:19968
    s_waitcnt lgkmcnt(10)
    v_mfma_f32_16x16x32_bf16 v[76:79], v[224:227], v[144:147], v[76:79]
    v_mfma_f32_16x16x32_bf16 v[100:103], v[224:227], v[148:151], v[100:103]
    ds_read_b64_tr_b16 v[220:221], v54 offset:18432
    ds_read_b64_tr_b16 v[222:223], v54 offset:19968
    s_waitcnt lgkmcnt(10)
    v_mfma_f32_16x16x32_bf16 v[80:83], v[228:231], v[144:147], v[80:83]
    v_mfma_f32_16x16x32_bf16 v[104:107], v[228:231], v[148:151], v[104:107]
    s_waitcnt vmcnt(4)
    s_barrier
    ds_read_b64_tr_b16 v[224:225], v48 offset:24576
    ds_read_b64_tr_b16 v[226:227], v48 offset:26112
    s_waitcnt lgkmcnt(10)
    v_mfma_f32_16x16x32_bf16 v[84:87], v[232:235], v[144:147], v[84:87]
    v_mfma_f32_16x16x32_bf16 v[108:111], v[232:235], v[148:151], v[108:111]
    s_mov_b32 s10, 8192
    buffer_load_dwordx4 v[120:123], v46, s[40:43], s10 offen offset:0 sc1
    ds_read_b64_tr_b16 v[228:229], v50 offset:24576
    ds_read_b64_tr_b16 v[230:231], v50 offset:26112
    s_waitcnt lgkmcnt(10)
    v_mfma_f32_16x16x32_bf16 v[88:91], v[208:211], v[144:147], v[88:91]
    v_mfma_f32_16x16x32_bf16 v[112:115], v[208:211], v[148:151], v[112:115]
    s_mov_b32 s10, 8192
    buffer_load_dwordx4 v[124:127], v47, s[40:43], s10 offen offset:0 sc1
    ds_read_b64_tr_b16 v[232:233], v48 offset:24640
    ds_read_b64_tr_b16 v[234:235], v48 offset:26176
    s_waitcnt lgkmcnt(10)
    v_mfma_f32_16x16x32_bf16 v[92:95], v[212:215], v[144:147], v[92:95]
    v_mfma_f32_16x16x32_bf16 v[116:119], v[212:215], v[148:151], v[116:119]
    s_mov_b32 s10, 8192
    buffer_load_dwordx4 v[128:131], v46, s[40:43], s10 offen offset:1024 sc1
    ds_read_b64_tr_b16 v[208:209], v50 offset:24640
    ds_read_b64_tr_b16 v[210:211], v50 offset:26176
    s_waitcnt lgkmcnt(10)
    v_mfma_f32_16x16x32_bf16 v[64:67], v[216:219], v[56:59], v[64:67]
    s_mov_b32 s10, 8192
    buffer_load_dwordx4 v[132:135], v47, s[40:43], s10 offen offset:1024 sc1
    ds_read_b64_tr_b16 v[212:213], v48 offset:24704
    ds_read_b64_tr_b16 v[214:215], v48 offset:26240
    s_waitcnt lgkmcnt(10)
    v_mfma_f32_16x16x32_bf16 v[68:71], v[220:223], v[56:59], v[68:71]
    ds_read_b64_tr_b16 v[216:217], v50 offset:24704
    ds_read_b64_tr_b16 v[218:219], v50 offset:26240
    s_waitcnt lgkmcnt(10)
    v_mfma_f32_16x16x32_bf16 v[72:75], v[224:227], v[152:155], v[72:75]
    v_mfma_f32_16x16x32_bf16 v[96:99], v[224:227], v[156:159], v[96:99]
    ds_read_b64_tr_b16 v[220:221], v52 offset:24576
    ds_read_b64_tr_b16 v[222:223], v52 offset:26112
    s_waitcnt lgkmcnt(10)
    v_mfma_f32_16x16x32_bf16 v[76:79], v[228:231], v[152:155], v[76:79]
    v_mfma_f32_16x16x32_bf16 v[100:103], v[228:231], v[156:159], v[100:103]
    ds_read_b64_tr_b16 v[224:225], v54 offset:24576
    ds_read_b64_tr_b16 v[226:227], v54 offset:26112
    s_waitcnt lgkmcnt(10)
    v_mfma_f32_16x16x32_bf16 v[80:83], v[232:235], v[152:155], v[80:83]
    v_mfma_f32_16x16x32_bf16 v[104:107], v[232:235], v[156:159], v[104:107]
    ds_read_b64_tr_b16 v[228:229], v48 offset:30720
    ds_read_b64_tr_b16 v[230:231], v48 offset:32256
    s_waitcnt lgkmcnt(10)
    v_mfma_f32_16x16x32_bf16 v[84:87], v[208:211], v[152:155], v[84:87]
    v_mfma_f32_16x16x32_bf16 v[108:111], v[208:211], v[156:159], v[108:111]
    ds_read_b64_tr_b16 v[232:233], v50 offset:30720
    ds_read_b64_tr_b16 v[234:235], v50 offset:32256
    s_waitcnt lgkmcnt(10)
    v_mfma_f32_16x16x32_bf16 v[88:91], v[212:215], v[152:155], v[88:91]
    v_mfma_f32_16x16x32_bf16 v[112:115], v[212:215], v[156:159], v[112:115]
    ds_read_b64_tr_b16 v[208:209], v48 offset:30784
    ds_read_b64_tr_b16 v[210:211], v48 offset:32320
    s_waitcnt lgkmcnt(10)
    v_mfma_f32_16x16x32_bf16 v[92:95], v[216:219], v[152:155], v[92:95]
    v_mfma_f32_16x16x32_bf16 v[116:119], v[216:219], v[156:159], v[116:119]
    ds_read_b64_tr_b16 v[212:213], v50 offset:30784
    ds_read_b64_tr_b16 v[214:215], v50 offset:32320
    s_waitcnt lgkmcnt(10)
    v_mfma_f32_16x16x32_bf16 v[64:67], v[220:223], v[56:59], v[64:67]
    ds_read_b64_tr_b16 v[216:217], v48 offset:30848
    ds_read_b64_tr_b16 v[218:219], v48 offset:32384
    s_waitcnt lgkmcnt(10)
    v_mfma_f32_16x16x32_bf16 v[68:71], v[224:227], v[56:59], v[68:71]
    ds_read_b64_tr_b16 v[220:221], v50 offset:30848
    ds_read_b64_tr_b16 v[222:223], v50 offset:32384
    s_waitcnt lgkmcnt(10)
    v_mfma_f32_16x16x32_bf16 v[72:75], v[228:231], v[160:163], v[72:75]
    v_mfma_f32_16x16x32_bf16 v[96:99], v[228:231], v[164:167], v[96:99]
    ds_read_b64_tr_b16 v[224:225], v52 offset:30720
    ds_read_b64_tr_b16 v[226:227], v52 offset:32256
    s_waitcnt lgkmcnt(10)
    v_mfma_f32_16x16x32_bf16 v[76:79], v[232:235], v[160:163], v[76:79]
    v_mfma_f32_16x16x32_bf16 v[100:103], v[232:235], v[164:167], v[100:103]
    ds_read_b64_tr_b16 v[228:229], v54 offset:30720
    ds_read_b64_tr_b16 v[230:231], v54 offset:32256
    s_waitcnt lgkmcnt(10)
    v_mfma_f32_16x16x32_bf16 v[80:83], v[208:211], v[160:163], v[80:83]
    v_mfma_f32_16x16x32_bf16 v[104:107], v[208:211], v[164:167], v[104:107]
    s_waitcnt vmcnt(4)
    s_barrier
    ds_read_b64_tr_b16 v[232:233], v48 offset:36864
    ds_read_b64_tr_b16 v[234:235], v48 offset:38400
    s_waitcnt lgkmcnt(10)
    v_mfma_f32_16x16x32_bf16 v[84:87], v[212:215], v[160:163], v[84:87]
    v_mfma_f32_16x16x32_bf16 v[108:111], v[212:215], v[164:167], v[108:111]
    s_mov_b32 s10, 0
    s_add_u32 m0, s8, 0
    s_nop 0
    buffer_load_dwordx4 v34, s[44:47], s10 offen lds
    ds_read_b64_tr_b16 v[208:209], v50 offset:36864
    ds_read_b64_tr_b16 v[210:211], v50 offset:38400
    s_waitcnt lgkmcnt(10)
    v_mfma_f32_16x16x32_bf16 v[88:91], v[216:219], v[160:163], v[88:91]
    v_mfma_f32_16x16x32_bf16 v[112:115], v[216:219], v[164:167], v[112:115]
    s_mov_b32 s10, 0
    s_add_u32 m0, s8, 4096
    s_nop 0
    buffer_load_dwordx4 v35, s[44:47], s10 offen lds
    ds_read_b64_tr_b16 v[212:213], v48 offset:36928
    ds_read_b64_tr_b16 v[214:215], v48 offset:38464
    s_waitcnt lgkmcnt(10)
    v_mfma_f32_16x16x32_bf16 v[92:95], v[220:223], v[160:163], v[92:95]
    v_mfma_f32_16x16x32_bf16 v[116:119], v[220:223], v[164:167], v[116:119]
    s_mov_b32 s10, 0
    s_add_u32 m0, s8, 8192
    s_nop 0
    buffer_load_dwordx4 v36, s[44:47], s10 offen lds
    ds_read_b64_tr_b16 v[216:217], v50 offset:36928
    ds_read_b64_tr_b16 v[218:219], v50 offset:38464
    s_waitcnt lgkmcnt(10)
    v_mfma_f32_16x16x32_bf16 v[64:67], v[224:227], v[56:59], v[64:67]
    s_mov_b32 s10, 0
    s_add_u32 m0, s8, 12288
    s_nop 0
    buffer_load_dwordx4 v37, s[44:47], s10 offen lds
    ds_read_b64_tr_b16 v[220:221], v48 offset:36992
    ds_read_b64_tr_b16 v[222:223], v48 offset:38528
    s_waitcnt lgkmcnt(10)
    v_mfma_f32_16x16x32_bf16 v[68:71], v[228:231], v[56:59], v[68:71]
    s_mov_b32 s10, 0
    s_add_u32 m0, s8, 16384
    s_nop 0
    buffer_load_dwordx4 v38, s[44:47], s10 offen lds
    ds_read_b64_tr_b16 v[224:225], v50 offset:36992
    ds_read_b64_tr_b16 v[226:227], v50 offset:38528
    s_waitcnt lgkmcnt(10)
    v_mfma_f32_16x16x32_bf16 v[72:75], v[232:235], v[168:171], v[72:75]
    v_mfma_f32_16x16x32_bf16 v[96:99], v[232:235], v[172:175], v[96:99]
    s_mov_b32 s10, 10240
    buffer_load_dwordx4 v[136:139], v46, s[40:43], s10 offen offset:0 sc1
    ds_read_b64_tr_b16 v[228:229], v52 offset:36864
    ds_read_b64_tr_b16 v[230:231], v52 offset:38400
    s_waitcnt lgkmcnt(10)
    v_mfma_f32_16x16x32_bf16 v[76:79], v[208:211], v[168:171], v[76:79]
    v_mfma_f32_16x16x32_bf16 v[100:103], v[208:211], v[172:175], v[100:103]
    s_mov_b32 s10, 10240
    buffer_load_dwordx4 v[140:143], v47, s[40:43], s10 offen offset:0 sc1
    ds_read_b64_tr_b16 v[232:233], v54 offset:36864
    ds_read_b64_tr_b16 v[234:235], v54 offset:38400
    s_waitcnt lgkmcnt(10)
    v_mfma_f32_16x16x32_bf16 v[80:83], v[212:215], v[168:171], v[80:83]
    v_mfma_f32_16x16x32_bf16 v[104:107], v[212:215], v[172:175], v[104:107]
    s_mov_b32 s10, 10240
    buffer_load_dwordx4 v[144:147], v46, s[40:43], s10 offen offset:1024 sc1
    ds_read_b64_tr_b16 v[208:209], v48 offset:43008
    ds_read_b64_tr_b16 v[210:211], v48 offset:44544
    s_waitcnt lgkmcnt(10)
    v_mfma_f32_16x16x32_bf16 v[84:87], v[216:219], v[168:171], v[84:87]
    v_mfma_f32_16x16x32_bf16 v[108:111], v[216:219], v[172:175], v[108:111]
    s_mov_b32 s10, 10240
    buffer_load_dwordx4 v[148:151], v47, s[40:43], s10 offen offset:1024 sc1
    ds_read_b64_tr_b16 v[212:213], v50 offset:43008
    ds_read_b64_tr_b16 v[214:215], v50 offset:44544
    s_waitcnt lgkmcnt(10)
    v_mfma_f32_16x16x32_bf16 v[88:91], v[220:223], v[168:171], v[88:91]
    v_mfma_f32_16x16x32_bf16 v[112:115], v[220:223], v[172:175], v[112:115]
    ds_read_b64_tr_b16 v[216:217], v48 offset:43072
    ds_read_b64_tr_b16 v[218:219], v48 offset:44608
    s_waitcnt lgkmcnt(10)
    v_mfma_f32_16x16x32_bf16 v[92:95], v[224:227], v[168:171], v[92:95]
    v_mfma_f32_16x16x32_bf16 v[116:119], v[224:227], v[172:175], v[116:119]
    ds_read_b64_tr_b16 v[220:221], v50 offset:43072
    ds_read_b64_tr_b16 v[222:223], v50 offset:44608
    s_waitcnt lgkmcnt(10)
    v_mfma_f32_16x16x32_bf16 v[64:67], v[228:231], v[56:59], v[64:67]
    ds_read_b64_tr_b16 v[224:225], v48 offset:43136
    ds_read_b64_tr_b16 v[226:227], v48 offset:44672
    s_waitcnt lgkmcnt(10)
    v_mfma_f32_16x16x32_bf16 v[68:71], v[232:235], v[56:59], v[68:71]
    ds_read_b64_tr_b16 v[228:229], v50 offset:43136
    ds_read_b64_tr_b16 v[230:231], v50 offset:44672
    s_waitcnt lgkmcnt(10)
    v_mfma_f32_16x16x32_bf16 v[72:75], v[208:211], v[176:179], v[72:75]
    v_mfma_f32_16x16x32_bf16 v[96:99], v[208:211], v[180:183], v[96:99]
    ds_read_b64_tr_b16 v[232:233], v52 offset:43008
    ds_read_b64_tr_b16 v[234:235], v52 offset:44544
    s_waitcnt lgkmcnt(10)
    v_mfma_f32_16x16x32_bf16 v[76:79], v[212:215], v[176:179], v[76:79]
    v_mfma_f32_16x16x32_bf16 v[100:103], v[212:215], v[180:183], v[100:103]
    ds_read_b64_tr_b16 v[208:209], v54 offset:43008
    ds_read_b64_tr_b16 v[210:211], v54 offset:44544
    s_waitcnt lgkmcnt(10)
    v_mfma_f32_16x16x32_bf16 v[80:83], v[216:219], v[176:179], v[80:83]
    v_mfma_f32_16x16x32_bf16 v[104:107], v[216:219], v[180:183], v[104:107]
    s_waitcnt vmcnt(9)
    s_barrier
    ds_read_b64_tr_b16 v[212:213], v48 offset:49152
    ds_read_b64_tr_b16 v[214:215], v48 offset:50688
    s_waitcnt lgkmcnt(10)
    v_mfma_f32_16x16x32_bf16 v[84:87], v[220:223], v[176:179], v[84:87]
    v_mfma_f32_16x16x32_bf16 v[108:111], v[220:223], v[180:183], v[108:111]
    s_mov_b32 s10, 12288
    buffer_load_dwordx4 v[152:155], v46, s[40:43], s10 offen offset:0 sc1
    ds_read_b64_tr_b16 v[216:217], v50 offset:49152
    ds_read_b64_tr_b16 v[218:219], v50 offset:50688
    s_waitcnt lgkmcnt(10)
    v_mfma_f32_16x16x32_bf16 v[88:91], v[224:227], v[176:179], v[88:91]
    v_mfma_f32_16x16x32_bf16 v[112:115], v[224:227], v[180:183], v[112:115]
    s_mov_b32 s10, 12288
    buffer_load_dwordx4 v[156:159], v47, s[40:43], s10 offen offset:0 sc1
    ds_read_b64_tr_b16 v[220:221], v48 offset:49216
    ds_read_b64_tr_b16 v[222:223], v48 offset:50752
    s_waitcnt lgkmcnt(10)
    v_mfma_f32_16x16x32_bf16 v[92:95], v[228:231], v[176:179], v[92:95]
    v_mfma_f32_16x16x32_bf16 v[116:119], v[228:231], v[180:183], v[116:119]
    s_mov_b32 s10, 12288
    buffer_load_dwordx4 v[160:163], v46, s[40:43], s10 offen offset:1024 sc1
    ds_read_b64_tr_b16 v[224:225], v50 offset:49216
    ds_read_b64_tr_b16 v[226:227], v50 offset:50752
    s_waitcnt lgkmcnt(10)
    v_mfma_f32_16x16x32_bf16 v[64:67], v[232:235], v[56:59], v[64:67]
    s_mov_b32 s10, 12288
    buffer_load_dwordx4 v[164:167], v47, s[40:43], s10 offen offset:1024 sc1
    ds_read_b64_tr_b16 v[228:229], v48 offset:49280
    ds_read_b64_tr_b16 v[230:231], v48 offset:50816
    s_waitcnt lgkmcnt(10)
    v_mfma_f32_16x16x32_bf16 v[68:71], v[208:211], v[56:59], v[68:71]
    ds_read_b64_tr_b16 v[232:233], v50 offset:49280
    ds_read_b64_tr_b16 v[234:235], v50 offset:50816
    s_waitcnt lgkmcnt(10)
    v_mfma_f32_16x16x32_bf16 v[72:75], v[212:215], v[120:123], v[72:75]
    v_mfma_f32_16x16x32_bf16 v[96:99], v[212:215], v[124:127], v[96:99]
    ds_read_b64_tr_b16 v[208:209], v52 offset:49152
    ds_read_b64_tr_b16 v[210:211], v52 offset:50688
    s_waitcnt lgkmcnt(10)
    v_mfma_f32_16x16x32_bf16 v[76:79], v[216:219], v[120:123], v[76:79]
    v_mfma_f32_16x16x32_bf16 v[100:103], v[216:219], v[124:127], v[100:103]
    ds_read_b64_tr_b16 v[212:213], v54 offset:49152
    ds_read_b64_tr_b16 v[214:215], v54 offset:50688
    s_waitcnt lgkmcnt(10)
    v_mfma_f32_16x16x32_bf16 v[80:83], v[220:223], v[120:123], v[80:83]
    v_mfma_f32_16x16x32_bf16 v[104:107], v[220:223], v[124:127], v[104:107]
    ds_read_b64_tr_b16 v[216:217], v48 offset:55296
    ds_read_b64_tr_b16 v[218:219], v48 offset:56832
    s_waitcnt lgkmcnt(10)
    v_mfma_f32_16x16x32_bf16 v[84:87], v[224:227], v[120:123], v[84:87]
    v_mfma_f32_16x16x32_bf16 v[108:111], v[224:227], v[124:127], v[108:111]
    ds_read_b64_tr_b16 v[220:221], v50 offset:55296
    ds_read_b64_tr_b16 v[222:223], v50 offset:56832
    s_waitcnt lgkmcnt(10)
    v_mfma_f32_16x16x32_bf16 v[88:91], v[228:231], v[120:123], v[88:91]
    v_mfma_f32_16x16x32_bf16 v[112:115], v[228:231], v[124:127], v[112:115]
    ds_read_b64_tr_b16 v[224:225], v48 offset:55360
    ds_read_b64_tr_b16 v[226:227], v48 offset:56896
    s_waitcnt lgkmcnt(10)
    v_mfma_f32_16x16x32_bf16 v[92:95], v[232:235], v[120:123], v[92:95]
    v_mfma_f32_16x16x32_bf16 v[116:119], v[232:235], v[124:127], v[116:119]
    ds_read_b64_tr_b16 v[228:229], v50 offset:55360
    ds_read_b64_tr_b16 v[230:231], v50 offset:56896
    s_waitcnt lgkmcnt(10)
    v_mfma_f32_16x16x32_bf16 v[64:67], v[208:211], v[56:59], v[64:67]
    ds_read_b64_tr_b16 v[232:233], v48 offset:55424
    ds_read_b64_tr_b16 v[234:235], v48 offset:56960
    s_waitcnt lgkmcnt(10)
    v_mfma_f32_16x16x32_bf16 v[68:71], v[212:215], v[56:59], v[68:71]
    ds_read_b64_tr_b16 v[208:209], v50 offset:55424
    ds_read_b64_tr_b16 v[210:211], v50 offset:56960
    s_waitcnt lgkmcnt(10)
    v_mfma_f32_16x16x32_bf16 v[72:75], v[216:219], v[128:131], v[72:75]
    v_mfma_f32_16x16x32_bf16 v[96:99], v[216:219], v[132:135], v[96:99]
    ds_read_b64_tr_b16 v[212:213], v52 offset:55296
    ds_read_b64_tr_b16 v[214:215], v52 offset:56832
    s_waitcnt lgkmcnt(10)
    v_mfma_f32_16x16x32_bf16 v[76:79], v[220:223], v[128:131], v[76:79]
    v_mfma_f32_16x16x32_bf16 v[100:103], v[220:223], v[132:135], v[100:103]
    ds_read_b64_tr_b16 v[216:217], v54 offset:55296
    ds_read_b64_tr_b16 v[218:219], v54 offset:56832
    s_waitcnt lgkmcnt(10)
    v_mfma_f32_16x16x32_bf16 v[80:83], v[224:227], v[128:131], v[80:83]
    v_mfma_f32_16x16x32_bf16 v[104:107], v[224:227], v[132:135], v[104:107]
    s_waitcnt vmcnt(4)
    s_barrier
    ds_read_b64_tr_b16 v[220:221], v48 offset:61440
    ds_read_b64_tr_b16 v[222:223], v48 offset:62976
    s_waitcnt lgkmcnt(10)
    v_mfma_f32_16x16x32_bf16 v[84:87], v[228:231], v[128:131], v[84:87]
    v_mfma_f32_16x16x32_bf16 v[108:111], v[228:231], v[132:135], v[108:111]
    s_mov_b32 s10, 163840
    s_add_u32 m0, s8, 20480
    s_nop 0
    buffer_load_dwordx4 v34, s[44:47], s10 offen lds
    ds_read_b64_tr_b16 v[224:225], v50 offset:61440
    ds_read_b64_tr_b16 v[226:227], v50 offset:62976
    s_waitcnt lgkmcnt(10)
    v_mfma_f32_16x16x32_bf16 v[88:91], v[232:235], v[128:131], v[88:91]
    v_mfma_f32_16x16x32_bf16 v[112:115], v[232:235], v[132:135], v[112:115]
    s_mov_b32 s10, 163840
    s_add_u32 m0, s8, 24576
    s_nop 0
    buffer_load_dwordx4 v35, s[44:47], s10 offen lds
    ds_read_b64_tr_b16 v[228:229], v48 offset:61504
    ds_read_b64_tr_b16 v[230:231], v48 offset:63040
    s_waitcnt lgkmcnt(10)
    v_mfma_f32_16x16x32_bf16 v[92:95], v[208:211], v[128:131], v[92:95]
    v_mfma_f32_16x16x32_bf16 v[116:119], v[208:211], v[132:135], v[116:119]
    s_mov_b32 s10, 163840
    s_add_u32 m0, s8, 28672
    s_nop 0
    buffer_load_dwordx4 v36, s[44:47], s10 offen lds
    ds_read_b64_tr_b16 v[232:233], v50 offset:61504
    ds_read_b64_tr_b16 v[234:235], v50 offset:63040
    s_waitcnt lgkmcnt(10)
    v_mfma_f32_16x16x32_bf16 v[64:67], v[212:215], v[56:59], v[64:67]
    s_mov_b32 s10, 163840
    s_add_u32 m0, s8, 32768
    s_nop 0
    buffer_load_dwordx4 v37, s[44:47], s10 offen lds
    ds_read_b64_tr_b16 v[208:209], v48 offset:61568
    ds_read_b64_tr_b16 v[210:211], v48 offset:63104
    s_waitcnt lgkmcnt(10)
    v_mfma_f32_16x16x32_bf16 v[68:71], v[216:219], v[56:59], v[68:71]
    s_mov_b32 s10, 163840
    s_add_u32 m0, s8, 36864
    s_nop 0
    buffer_load_dwordx4 v38, s[44:47], s10 offen lds
    ds_read_b64_tr_b16 v[212:213], v50 offset:61568
    ds_read_b64_tr_b16 v[214:215], v50 offset:63104
    s_waitcnt lgkmcnt(10)
    v_mfma_f32_16x16x32_bf16 v[72:75], v[220:223], v[136:139], v[72:75]
    v_mfma_f32_16x16x32_bf16 v[96:99], v[220:223], v[140:143], v[96:99]
    s_mov_b32 s10, 14336
    buffer_load_dwordx4 v[168:171], v46, s[40:43], s10 offen offset:0 sc1
    ds_read_b64_tr_b16 v[216:217], v52 offset:61440
    ds_read_b64_tr_b16 v[218:219], v52 offset:62976
    s_waitcnt lgkmcnt(10)
    v_mfma_f32_16x16x32_bf16 v[76:79], v[224:227], v[136:139], v[76:79]
    v_mfma_f32_16x16x32_bf16 v[100:103], v[224:227], v[140:143], v[100:103]
    s_mov_b32 s10, 14336
    buffer_load_dwordx4 v[172:175], v47, s[40:43], s10 offen offset:0 sc1
    ds_read_b64_tr_b16 v[220:221], v54 offset:61440
    ds_read_b64_tr_b16 v[222:223], v54 offset:62976
    s_waitcnt lgkmcnt(10)
    v_mfma_f32_16x16x32_bf16 v[80:83], v[228:231], v[136:139], v[80:83]
    v_mfma_f32_16x16x32_bf16 v[104:107], v[228:231], v[140:143], v[104:107]
    s_mov_b32 s10, 14336
    buffer_load_dwordx4 v[176:179], v46, s[40:43], s10 offen offset:1024 sc1
    ds_read_b64_tr_b16 v[224:225], v49 offset:2048
    ds_read_b64_tr_b16 v[226:227], v49 offset:3584
    s_waitcnt lgkmcnt(10)
    v_mfma_f32_16x16x32_bf16 v[84:87], v[232:235], v[136:139], v[84:87]
    v_mfma_f32_16x16x32_bf16 v[108:111], v[232:235], v[140:143], v[108:111]
    s_mov_b32 s10, 14336
    buffer_load_dwordx4 v[180:183], v47, s[40:43], s10 offen offset:1024 sc1
    ds_read_b64_tr_b16 v[228:229], v51 offset:2048
    ds_read_b64_tr_b16 v[230:231], v51 offset:3584
    s_waitcnt lgkmcnt(10)
    v_mfma_f32_16x16x32_bf16 v[88:91], v[208:211], v[136:139], v[88:91]
    v_mfma_f32_16x16x32_bf16 v[112:115], v[208:211], v[140:143], v[112:115]
    ds_read_b64_tr_b16 v[232:233], v49 offset:2112
    ds_read_b64_tr_b16 v[234:235], v49 offset:3648
    s_waitcnt lgkmcnt(10)
    v_mfma_f32_16x16x32_bf16 v[92:95], v[212:215], v[136:139], v[92:95]
    v_mfma_f32_16x16x32_bf16 v[116:119], v[212:215], v[140:143], v[116:119]
    ds_read_b64_tr_b16 v[208:209], v51 offset:2112
    ds_read_b64_tr_b16 v[210:211], v51 offset:3648
    s_waitcnt lgkmcnt(10)
    v_mfma_f32_16x16x32_bf16 v[64:67], v[216:219], v[56:59], v[64:67]
    ds_read_b64_tr_b16 v[212:213], v49 offset:2176
    ds_read_b64_tr_b16 v[214:215], v49 offset:3712
    s_waitcnt lgkmcnt(10)
    v_mfma_f32_16x16x32_bf16 v[68:71], v[220:223], v[56:59], v[68:71]
    ds_read_b64_tr_b16 v[216:217], v51 offset:2176
    ds_read_b64_tr_b16 v[218:219], v51 offset:3712
    s_waitcnt lgkmcnt(10)
    v_mfma_f32_16x16x32_bf16 v[72:75], v[224:227], v[144:147], v[72:75]
    v_mfma_f32_16x16x32_bf16 v[96:99], v[224:227], v[148:151], v[96:99]
    ds_read_b64_tr_b16 v[220:221], v53 offset:2048
    ds_read_b64_tr_b16 v[222:223], v53 offset:3584
    s_waitcnt lgkmcnt(10)
    v_mfma_f32_16x16x32_bf16 v[76:79], v[228:231], v[144:147], v[76:79]
    v_mfma_f32_16x16x32_bf16 v[100:103], v[228:231], v[148:151], v[100:103]
    ds_read_b64_tr_b16 v[224:225], v55 offset:2048
    ds_read_b64_tr_b16 v[226:227], v55 offset:3584
    s_waitcnt lgkmcnt(10)
    v_mfma_f32_16x16x32_bf16 v[80:83], v[232:235], v[144:147], v[80:83]
    v_mfma_f32_16x16x32_bf16 v[104:107], v[232:235], v[148:151], v[104:107]
    s_waitcnt vmcnt(9)
    s_barrier
    ds_read_b64_tr_b16 v[228:229], v49 offset:8192
    ds_read_b64_tr_b16 v[230:231], v49 offset:9728
    s_waitcnt lgkmcnt(10)
    v_mfma_f32_16x16x32_bf16 v[84:87], v[208:211], v[144:147], v[84:87]
    v_mfma_f32_16x16x32_bf16 v[108:111], v[208:211], v[148:151], v[108:111]
    s_mov_b32 s10, 327680
    s_add_u32 m0, s8, 40960
    s_nop 0
    buffer_load_dwordx4 v34, s[44:47], s10 offen lds
    ds_read_b64_tr_b16 v[232:233], v51 offset:8192
    ds_read_b64_tr_b16 v[234:235], v51 offset:9728
    s_waitcnt lgkmcnt(10)
    v_mfma_f32_16x16x32_bf16 v[88:91], v[212:215], v[144:147], v[88:91]
    v_mfma_f32_16x16x32_bf16 v[112:115], v[212:215], v[148:151], v[112:115]
    s_mov_b32 s10, 327680
    s_add_u32 m0, s8, 45056
    s_nop 0
    buffer_load_dwordx4 v35, s[44:47], s10 offen lds
    ds_read_b64_tr_b16 v[208:209], v49 offset:8256
    ds_read_b64_tr_b16 v[210:211], v49 offset:9792
    s_waitcnt lgkmcnt(10)
    v_mfma_f32_16x16x32_bf16 v[92:95], v[216:219], v[144:147], v[92:95]
    v_mfma_f32_16x16x32_bf16 v[116:119], v[216:219], v[148:151], v[116:119]
    s_mov_b32 s10, 327680
    s_add_u32 m0, s8, 49152
    s_nop 0
    buffer_load_dwordx4 v36, s[44:47], s10 offen lds
    ds_read_b64_tr_b16 v[212:213], v51 offset:8256
    ds_read_b64_tr_b16 v[214:215], v51 offset:9792
    s_waitcnt lgkmcnt(10)
    v_mfma_f32_16x16x32_bf16 v[64:67], v[220:223], v[56:59], v[64:67]
    s_mov_b32 s10, 327680
    s_add_u32 m0, s8, 53248
    s_nop 0
    buffer_load_dwordx4 v37, s[44:47], s10 offen lds
    ds_read_b64_tr_b16 v[216:217], v49 offset:8320
    ds_read_b64_tr_b16 v[218:219], v49 offset:9856
    s_waitcnt lgkmcnt(10)
    v_mfma_f32_16x16x32_bf16 v[68:71], v[224:227], v[56:59], v[68:71]
    s_mov_b32 s10, 327680
    s_add_u32 m0, s8, 57344
    s_nop 0
    buffer_load_dwordx4 v38, s[44:47], s10 offen lds
    ds_read_b64_tr_b16 v[220:221], v51 offset:8320
    ds_read_b64_tr_b16 v[222:223], v51 offset:9856
    s_waitcnt lgkmcnt(10)
    v_mfma_f32_16x16x32_bf16 v[72:75], v[228:231], v[152:155], v[72:75]
    v_mfma_f32_16x16x32_bf16 v[96:99], v[228:231], v[156:159], v[96:99]
    s_mov_b32 s10, 16384
    buffer_load_dwordx4 v[120:123], v46, s[40:43], s10 offen offset:0 sc1
    ds_read_b64_tr_b16 v[224:225], v53 offset:8192
    ds_read_b64_tr_b16 v[226:227], v53 offset:9728
    s_waitcnt lgkmcnt(10)
    v_mfma_f32_16x16x32_bf16 v[76:79], v[232:235], v[152:155], v[76:79]
    v_mfma_f32_16x16x32_bf16 v[100:103], v[232:235], v[156:159], v[100:103]
    s_mov_b32 s10, 16384
    buffer_load_dwordx4 v[124:127], v47, s[40:43], s10 offen offset:0 sc1
    ds_read_b64_tr_b16 v[228:229], v55 offset:8192
    ds_read_b64_tr_b16 v[230:231], v55 offset:9728
    s_waitcnt lgkmcnt(10)
    v_mfma_f32_16x16x32_bf16 v[80:83], v[208:211], v[152:155], v[80:83]
    v_mfma_f32_16x16x32_bf16 v[104:107], v[208:211], v[156:159], v[104:107]
    s_mov_b32 s10, 16384
    buffer_load_dwordx4 v[128:131], v46, s[40:43], s10 offen offset:1024 sc1
    ds_read_b64_tr_b16 v[232:233], v49 offset:14336
    ds_read_b64_tr_b16 v[234:235], v49 offset:15872
    s_waitcnt lgkmcnt(10)
    v_mfma_f32_16x16x32_bf16 v[84:87], v[212:215], v[152:155], v[84:87]
    v_mfma_f32_16x16x32_bf16 v[108:111], v[212:215], v[156:159], v[108:111]
    s_mov_b32 s10, 16384
    buffer_load_dwordx4 v[132:135], v47, s[40:43], s10 offen offset:1024 sc1
    ds_read_b64_tr_b16 v[208:209], v51 offset:14336
    ds_read_b64_tr_b16 v[210:211], v51 offset:15872
    s_waitcnt lgkmcnt(10)
    v_mfma_f32_16x16x32_bf16 v[88:91], v[216:219], v[152:155], v[88:91]
    v_mfma_f32_16x16x32_bf16 v[112:115], v[216:219], v[156:159], v[112:115]
    ds_read_b64_tr_b16 v[212:213], v49 offset:14400
    ds_read_b64_tr_b16 v[214:215], v49 offset:15936
    s_waitcnt lgkmcnt(10)
    v_mfma_f32_16x16x32_bf16 v[92:95], v[220:223], v[152:155], v[92:95]
    v_mfma_f32_16x16x32_bf16 v[116:119], v[220:223], v[156:159], v[116:119]
    ds_read_b64_tr_b16 v[216:217], v51 offset:14400
    ds_read_b64_tr_b16 v[218:219], v51 offset:15936
    s_waitcnt lgkmcnt(10)
    v_mfma_f32_16x16x32_bf16 v[64:67], v[224:227], v[56:59], v[64:67]
    ds_read_b64_tr_b16 v[220:221], v49 offset:14464
    ds_read_b64_tr_b16 v[222:223], v49 offset:16000
    s_waitcnt lgkmcnt(10)
    v_mfma_f32_16x16x32_bf16 v[68:71], v[228:231], v[56:59], v[68:71]
    ds_read_b64_tr_b16 v[224:225], v51 offset:14464
    ds_read_b64_tr_b16 v[226:227], v51 offset:16000
    s_waitcnt lgkmcnt(10)
    v_mfma_f32_16x16x32_bf16 v[72:75], v[232:235], v[160:163], v[72:75]
    v_mfma_f32_16x16x32_bf16 v[96:99], v[232:235], v[164:167], v[96:99]
    ds_read_b64_tr_b16 v[228:229], v53 offset:14336
    ds_read_b64_tr_b16 v[230:231], v53 offset:15872
    s_waitcnt lgkmcnt(10)
    v_mfma_f32_16x16x32_bf16 v[76:79], v[208:211], v[160:163], v[76:79]
    v_mfma_f32_16x16x32_bf16 v[100:103], v[208:211], v[164:167], v[100:103]
    ds_read_b64_tr_b16 v[232:233], v55 offset:14336
    ds_read_b64_tr_b16 v[234:235], v55 offset:15872
    s_waitcnt lgkmcnt(10)
    v_mfma_f32_16x16x32_bf16 v[80:83], v[212:215], v[160:163], v[80:83]
    v_mfma_f32_16x16x32_bf16 v[104:107], v[212:215], v[164:167], v[104:107]
    s_waitcnt vmcnt(9)
    s_barrier
    ds_read_b64_tr_b16 v[208:209], v49 offset:20480
    ds_read_b64_tr_b16 v[210:211], v49 offset:22016
    s_waitcnt lgkmcnt(10)
    v_mfma_f32_16x16x32_bf16 v[84:87], v[216:219], v[160:163], v[84:87]
    v_mfma_f32_16x16x32_bf16 v[108:111], v[216:219], v[164:167], v[108:111]
    s_mov_b32 s10, 18432
    buffer_load_dwordx4 v[136:139], v46, s[40:43], s10 offen offset:0 sc1
    ds_read_b64_tr_b16 v[212:213], v51 offset:20480
    ds_read_b64_tr_b16 v[214:215], v51 offset:22016
    s_waitcnt lgkmcnt(10)
    v_mfma_f32_16x16x32_bf16 v[88:91], v[220:223], v[160:163], v[88:91]
    v_mfma_f32_16x16x32_bf16 v[112:115], v[220:223], v[164:167], v[112:115]
    s_mov_b32 s10, 18432
    buffer_load_dwordx4 v[140:143], v47, s[40:43], s10 offen offset:0 sc1
    ds_read_b64_tr_b16 v[216:217], v49 offset:20544
    ds_read_b64_tr_b16 v[218:219], v49 offset:22080
    s_waitcnt lgkmcnt(10)
    v_mfma_f32_16x16x32_bf16 v[92:95], v[224:227], v[160:163], v[92:95]
    v_mfma_f32_16x16x32_bf16 v[116:119], v[224:227], v[164:167], v[116:119]
    s_mov_b32 s10, 18432
    buffer_load_dwordx4 v[144:147], v46, s[40:43], s10 offen offset:1024 sc1
    ds_read_b64_tr_b16 v[220:221], v51 offset:20544
    ds_read_b64_tr_b16 v[222:223], v51 offset:22080
    s_waitcnt lgkmcnt(10)
    v_mfma_f32_16x16x32_bf16 v[64:67], v[228:231], v[56:59], v[64:67]
    s_mov_b32 s10, 18432
    buffer_load_dwordx4 v[148:151], v47, s[40:43], s10 offen offset:1024 sc1
    ds_read_b64_tr_b16 v[224:225], v49 offset:20608
    ds_read_b64_tr_b16 v[226:227], v49 offset:22144
    s_waitcnt lgkmcnt(10)
    v_mfma_f32_16x16x32_bf16 v[68:71], v[232:235], v[56:59], v[68:71]
    ds_read_b64_tr_b16 v[228:229], v51 offset:20608
    ds_read_b64_tr_b16 v[230:231], v51 offset:22144
    s_waitcnt lgkmcnt(10)
    v_mfma_f32_16x16x32_bf16 v[72:75], v[208:211], v[168:171], v[72:75]
    v_mfma_f32_16x16x32_bf16 v[96:99], v[208:211], v[172:175], v[96:99]
    ds_read_b64_tr_b16 v[232:233], v53 offset:20480
    ds_read_b64_tr_b16 v[234:235], v53 offset:22016
    s_waitcnt lgkmcnt(10)
    v_mfma_f32_16x16x32_bf16 v[76:79], v[212:215], v[168:171], v[76:79]
    v_mfma_f32_16x16x32_bf16 v[100:103], v[212:215], v[172:175], v[100:103]
    ds_read_b64_tr_b16 v[208:209], v55 offset:20480
    ds_read_b64_tr_b16 v[210:211], v55 offset:22016
    s_waitcnt lgkmcnt(10)
    v_mfma_f32_16x16x32_bf16 v[80:83], v[216:219], v[168:171], v[80:83]
    v_mfma_f32_16x16x32_bf16 v[104:107], v[216:219], v[172:175], v[104:107]
    ds_read_b64_tr_b16 v[212:213], v49 offset:26624
    ds_read_b64_tr_b16 v[214:215], v49 offset:28160
    s_waitcnt lgkmcnt(10)
    v_mfma_f32_16x16x32_bf16 v[84:87], v[220:223], v[168:171], v[84:87]
    v_mfma_f32_16x16x32_bf16 v[108:111], v[220:223], v[172:175], v[108:111]
    ds_read_b64_tr_b16 v[216:217], v51 offset:26624
    ds_read_b64_tr_b16 v[218:219], v51 offset:28160
    s_waitcnt lgkmcnt(10)
    v_mfma_f32_16x16x32_bf16 v[88:91], v[224:227], v[168:171], v[88:91]
    v_mfma_f32_16x16x32_bf16 v[112:115], v[224:227], v[172:175], v[112:115]
    ds_read_b64_tr_b16 v[220:221], v49 offset:26688
    ds_read_b64_tr_b16 v[222:223], v49 offset:28224
    s_waitcnt lgkmcnt(10)
    v_mfma_f32_16x16x32_bf16 v[92:95], v[228:231], v[168:171], v[92:95]
    v_mfma_f32_16x16x32_bf16 v[116:119], v[228:231], v[172:175], v[116:119]
    ds_read_b64_tr_b16 v[224:225], v51 offset:26688
    ds_read_b64_tr_b16 v[226:227], v51 offset:28224
    s_waitcnt lgkmcnt(10)
    v_mfma_f32_16x16x32_bf16 v[64:67], v[232:235], v[56:59], v[64:67]
    ds_read_b64_tr_b16 v[228:229], v49 offset:26752
    ds_read_b64_tr_b16 v[230:231], v49 offset:28288
    s_waitcnt lgkmcnt(10)
    v_mfma_f32_16x16x32_bf16 v[68:71], v[208:211], v[56:59], v[68:71]
    ds_read_b64_tr_b16 v[232:233], v51 offset:26752
    ds_read_b64_tr_b16 v[234:235], v51 offset:28288
    s_waitcnt lgkmcnt(10)
    v_mfma_f32_16x16x32_bf16 v[72:75], v[212:215], v[176:179], v[72:75]
    v_mfma_f32_16x16x32_bf16 v[96:99], v[212:215], v[180:183], v[96:99]
    ds_read_b64_tr_b16 v[208:209], v53 offset:26624
    ds_read_b64_tr_b16 v[210:211], v53 offset:28160
    s_waitcnt lgkmcnt(10)
    v_mfma_f32_16x16x32_bf16 v[76:79], v[216:219], v[176:179], v[76:79]
    v_mfma_f32_16x16x32_bf16 v[100:103], v[216:219], v[180:183], v[100:103]
    ds_read_b64_tr_b16 v[212:213], v55 offset:26624
    ds_read_b64_tr_b16 v[214:215], v55 offset:28160
    s_waitcnt lgkmcnt(10)
    v_mfma_f32_16x16x32_bf16 v[80:83], v[220:223], v[176:179], v[80:83]
    v_mfma_f32_16x16x32_bf16 v[104:107], v[220:223], v[180:183], v[104:107]
    s_waitcnt vmcnt(4)
    s_barrier
    ds_read_b64_tr_b16 v[216:217], v49 offset:32768
    ds_read_b64_tr_b16 v[218:219], v49 offset:34304
    s_waitcnt lgkmcnt(10)
    v_mfma_f32_16x16x32_bf16 v[84:87], v[224:227], v[176:179], v[84:87]
    v_mfma_f32_16x16x32_bf16 v[108:111], v[224:227], v[180:183], v[108:111]
    s_mov_b32 s10, 491520
    s_add_u32 m0, s8, 61440
    s_nop 0
    buffer_load_dwordx4 v34, s[44:47], s10 offen lds
    ds_read_b64_tr_b16 v[220:221], v51 offset:32768
    ds_read_b64_tr_b16 v[222:223], v51 offset:34304
    s_waitcnt lgkmcnt(10)
    v_mfma_f32_16x16x32_bf16 v[88:91], v[228:231], v[176:179], v[88:91]
    v_mfma_f32_16x16x32_bf16 v[112:115], v[228:231], v[180:183], v[112:115]
    s_mov_b32 s10, 491520
    s_add_u32 m0, s8, 65536
    s_nop 0
    buffer_load_dwordx4 v35, s[44:47], s10 offen lds
    ds_read_b64_tr_b16 v[224:225], v49 offset:32832
    ds_read_b64_tr_b16 v[226:227], v49 offset:34368
    s_waitcnt lgkmcnt(10)
    v_mfma_f32_16x16x32_bf16 v[92:95], v[232:235], v[176:179], v[92:95]
    v_mfma_f32_16x16x32_bf16 v[116:119], v[232:235], v[180:183], v[116:119]
    s_mov_b32 s10, 491520
    s_add_u32 m0, s8, 69632
    s_nop 0
    buffer_load_dwordx4 v36, s[44:47], s10 offen lds
    ds_read_b64_tr_b16 v[228:229], v51 offset:32832
    ds_read_b64_tr_b16 v[230:231], v51 offset:34368
    s_waitcnt lgkmcnt(10)
    v_mfma_f32_16x16x32_bf16 v[64:67], v[208:211], v[56:59], v[64:67]
    s_mov_b32 s10, 491520
    s_add_u32 m0, s8, 73728
    s_nop 0
    buffer_load_dwordx4 v37, s[44:47], s10 offen lds
    ds_read_b64_tr_b16 v[232:233], v49 offset:32896
    ds_read_b64_tr_b16 v[234:235], v49 offset:34432
    s_waitcnt lgkmcnt(10)
    v_mfma_f32_16x16x32_bf16 v[68:71], v[212:215], v[56:59], v[68:71]
    s_mov_b32 s10, 491520
    s_add_u32 m0, s8, 77824
    s_nop 0
    buffer_load_dwordx4 v38, s[44:47], s10 offen lds
    ds_read_b64_tr_b16 v[208:209], v51 offset:32896
    ds_read_b64_tr_b16 v[210:211], v51 offset:34432
    s_waitcnt lgkmcnt(10)
    v_mfma_f32_16x16x32_bf16 v[72:75], v[216:219], v[120:123], v[72:75]
    v_mfma_f32_16x16x32_bf16 v[96:99], v[216:219], v[124:127], v[96:99]
    s_mov_b32 s96, s30
    s_and_b32 s97, s31, 0xffff
    s_mov_b32 s98, 1966080
    s_mov_b32 s99, 0x00020000
    s_lshr_b32 s10, s2, 3
    s_mul_i32 s10, s10, 30720
    s_add_u32 s10, s10, 983040
    buffer_load_dword v33, v32, s[96:99], s10 offen
    ds_read_b64_tr_b16 v[212:213], v53 offset:32768
    ds_read_b64_tr_b16 v[214:215], v53 offset:34304
    s_waitcnt lgkmcnt(10)
    v_mfma_f32_16x16x32_bf16 v[76:79], v[220:223], v[120:123], v[76:79]
    v_mfma_f32_16x16x32_bf16 v[100:103], v[220:223], v[124:127], v[100:103]
    ds_read_b64_tr_b16 v[216:217], v55 offset:32768
    ds_read_b64_tr_b16 v[218:219], v55 offset:34304
    s_waitcnt lgkmcnt(10)
    v_mfma_f32_16x16x32_bf16 v[80:83], v[224:227], v[120:123], v[80:83]
    v_mfma_f32_16x16x32_bf16 v[104:107], v[224:227], v[124:127], v[104:107]
    ds_read_b64_tr_b16 v[220:221], v49 offset:38912
    ds_read_b64_tr_b16 v[222:223], v49 offset:40448
    s_waitcnt lgkmcnt(10)
    v_mfma_f32_16x16x32_bf16 v[84:87], v[228:231], v[120:123], v[84:87]
    v_mfma_f32_16x16x32_bf16 v[108:111], v[228:231], v[124:127], v[108:111]
    ds_read_b64_tr_b16 v[224:225], v51 offset:38912
    ds_read_b64_tr_b16 v[226:227], v51 offset:40448
    s_waitcnt lgkmcnt(10)
    v_mfma_f32_16x16x32_bf16 v[88:91], v[232:235], v[120:123], v[88:91]
    v_mfma_f32_16x16x32_bf16 v[112:115], v[232:235], v[124:127], v[112:115]
    ds_read_b64_tr_b16 v[228:229], v49 offset:38976
    ds_read_b64_tr_b16 v[230:231], v49 offset:40512
    s_waitcnt lgkmcnt(10)
    v_mfma_f32_16x16x32_bf16 v[92:95], v[208:211], v[120:123], v[92:95]
    v_mfma_f32_16x16x32_bf16 v[116:119], v[208:211], v[124:127], v[116:119]
    ds_read_b64_tr_b16 v[232:233], v51 offset:38976
    ds_read_b64_tr_b16 v[234:235], v51 offset:40512
    s_waitcnt lgkmcnt(10)
    v_mfma_f32_16x16x32_bf16 v[64:67], v[212:215], v[56:59], v[64:67]
    ds_read_b64_tr_b16 v[208:209], v49 offset:39040
    ds_read_b64_tr_b16 v[210:211], v49 offset:40576
    s_waitcnt lgkmcnt(10)
    v_mfma_f32_16x16x32_bf16 v[68:71], v[216:219], v[56:59], v[68:71]
    ds_read_b64_tr_b16 v[212:213], v51 offset:39040
    ds_read_b64_tr_b16 v[214:215], v51 offset:40576
    s_waitcnt lgkmcnt(10)
    v_mfma_f32_16x16x32_bf16 v[72:75], v[220:223], v[128:131], v[72:75]
    v_mfma_f32_16x16x32_bf16 v[96:99], v[220:223], v[132:135], v[96:99]
    ds_read_b64_tr_b16 v[216:217], v53 offset:38912
    ds_read_b64_tr_b16 v[218:219], v53 offset:40448
    s_waitcnt lgkmcnt(10)
    v_mfma_f32_16x16x32_bf16 v[76:79], v[224:227], v[128:131], v[76:79]
    v_mfma_f32_16x16x32_bf16 v[100:103], v[224:227], v[132:135], v[100:103]
    ds_read_b64_tr_b16 v[220:221], v55 offset:38912
    ds_read_b64_tr_b16 v[222:223], v55 offset:40448
    s_waitcnt lgkmcnt(10)
    v_mfma_f32_16x16x32_bf16 v[80:83], v[228:231], v[128:131], v[80:83]
    v_mfma_f32_16x16x32_bf16 v[104:107], v[228:231], v[132:135], v[104:107]
    s_waitcnt vmcnt(6)
    s_barrier
    ds_read_b64_tr_b16 v[224:225], v49 offset:45056
    ds_read_b64_tr_b16 v[226:227], v49 offset:46592
    s_waitcnt lgkmcnt(10)
    v_mfma_f32_16x16x32_bf16 v[84:87], v[232:235], v[128:131], v[84:87]
    v_mfma_f32_16x16x32_bf16 v[108:111], v[232:235], v[132:135], v[108:111]
    ds_read_b64_tr_b16 v[228:229], v51 offset:45056
    ds_read_b64_tr_b16 v[230:231], v51 offset:46592
    s_waitcnt lgkmcnt(10)
    v_mfma_f32_16x16x32_bf16 v[88:91], v[208:211], v[128:131], v[88:91]
    v_mfma_f32_16x16x32_bf16 v[112:115], v[208:211], v[132:135], v[112:115]
    ds_read_b64_tr_b16 v[232:233], v49 offset:45120
    ds_read_b64_tr_b16 v[234:235], v49 offset:46656
    s_waitcnt lgkmcnt(10)
    v_mfma_f32_16x16x32_bf16 v[92:95], v[212:215], v[128:131], v[92:95]
    v_mfma_f32_16x16x32_bf16 v[116:119], v[212:215], v[132:135], v[116:119]
    ds_read_b64_tr_b16 v[208:209], v51 offset:45120
    ds_read_b64_tr_b16 v[210:211], v51 offset:46656
    s_waitcnt lgkmcnt(10)
    v_mfma_f32_16x16x32_bf16 v[64:67], v[216:219], v[56:59], v[64:67]
    ds_read_b64_tr_b16 v[212:213], v49 offset:45184
    ds_read_b64_tr_b16 v[214:215], v49 offset:46720
    s_waitcnt lgkmcnt(10)
    v_mfma_f32_16x16x32_bf16 v[68:71], v[220:223], v[56:59], v[68:71]
    ds_read_b64_tr_b16 v[216:217], v51 offset:45184
    ds_read_b64_tr_b16 v[218:219], v51 offset:46720
    s_waitcnt lgkmcnt(10)
    v_mfma_f32_16x16x32_bf16 v[72:75], v[224:227], v[136:139], v[72:75]
    v_mfma_f32_16x16x32_bf16 v[96:99], v[224:227], v[140:143], v[96:99]
    ds_read_b64_tr_b16 v[220:221], v53 offset:45056
    ds_read_b64_tr_b16 v[222:223], v53 offset:46592
    s_waitcnt lgkmcnt(10)
    v_mfma_f32_16x16x32_bf16 v[76:79], v[228:231], v[136:139], v[76:79]
    v_mfma_f32_16x16x32_bf16 v[100:103], v[228:231], v[140:143], v[100:103]
    ds_read_b64_tr_b16 v[224:225], v55 offset:45056
    ds_read_b64_tr_b16 v[226:227], v55 offset:46592
    s_waitcnt lgkmcnt(10)
    v_mfma_f32_16x16x32_bf16 v[80:83], v[232:235], v[136:139], v[80:83]
    v_mfma_f32_16x16x32_bf16 v[104:107], v[232:235], v[140:143], v[104:107]
    ds_read_b64_tr_b16 v[228:229], v49 offset:51200
    ds_read_b64_tr_b16 v[230:231], v49 offset:52736
    s_waitcnt lgkmcnt(10)
    v_mfma_f32_16x16x32_bf16 v[84:87], v[208:211], v[136:139], v[84:87]
    v_mfma_f32_16x16x32_bf16 v[108:111], v[208:211], v[140:143], v[108:111]
    ds_read_b64_tr_b16 v[232:233], v51 offset:51200
    ds_read_b64_tr_b16 v[234:235], v51 offset:52736
    s_waitcnt lgkmcnt(10)
    v_mfma_f32_16x16x32_bf16 v[88:91], v[212:215], v[136:139], v[88:91]
    v_mfma_f32_16x16x32_bf16 v[112:115], v[212:215], v[140:143], v[112:115]
    ds_read_b64_tr_b16 v[208:209], v49 offset:51264
    ds_read_b64_tr_b16 v[210:211], v49 offset:52800
    s_waitcnt lgkmcnt(10)
    v_mfma_f32_16x16x32_bf16 v[92:95], v[216:219], v[136:139], v[92:95]
    v_mfma_f32_16x16x32_bf16 v[116:119], v[216:219], v[140:143], v[116:119]
    ds_read_b64_tr_b16 v[212:213], v51 offset:51264
    ds_read_b64_tr_b16 v[214:215], v51 offset:52800
    s_waitcnt lgkmcnt(10)
    v_mfma_f32_16x16x32_bf16 v[64:67], v[220:223], v[56:59], v[64:67]
    ds_read_b64_tr_b16 v[216:217], v49 offset:51328
    ds_read_b64_tr_b16 v[218:219], v49 offset:52864
    s_waitcnt lgkmcnt(10)
    v_mfma_f32_16x16x32_bf16 v[68:71], v[224:227], v[56:59], v[68:71]
    ds_read_b64_tr_b16 v[220:221], v51 offset:51328
    ds_read_b64_tr_b16 v[222:223], v51 offset:52864
    s_waitcnt lgkmcnt(10)
    v_mfma_f32_16x16x32_bf16 v[72:75], v[228:231], v[144:147], v[72:75]
    v_mfma_f32_16x16x32_bf16 v[96:99], v[228:231], v[148:151], v[96:99]
    ds_read_b64_tr_b16 v[224:225], v53 offset:51200
    ds_read_b64_tr_b16 v[226:227], v53 offset:52736
    s_waitcnt lgkmcnt(10)
    v_mfma_f32_16x16x32_bf16 v[76:79], v[232:235], v[144:147], v[76:79]
    v_mfma_f32_16x16x32_bf16 v[100:103], v[232:235], v[148:151], v[100:103]
    ds_read_b64_tr_b16 v[228:229], v55 offset:51200
    ds_read_b64_tr_b16 v[230:231], v55 offset:52736
    s_waitcnt lgkmcnt(10)
    v_mfma_f32_16x16x32_bf16 v[80:83], v[208:211], v[144:147], v[80:83]
    v_mfma_f32_16x16x32_bf16 v[104:107], v[208:211], v[148:151], v[104:107]
    s_waitcnt lgkmcnt(8)
    v_mfma_f32_16x16x32_bf16 v[84:87], v[212:215], v[144:147], v[84:87]
    v_mfma_f32_16x16x32_bf16 v[108:111], v[212:215], v[148:151], v[108:111]
    s_waitcnt lgkmcnt(6)
    v_mfma_f32_16x16x32_bf16 v[88:91], v[216:219], v[144:147], v[88:91]
    v_mfma_f32_16x16x32_bf16 v[112:115], v[216:219], v[148:151], v[112:115]
    s_waitcnt lgkmcnt(4)
    v_mfma_f32_16x16x32_bf16 v[92:95], v[220:223], v[144:147], v[92:95]
    v_mfma_f32_16x16x32_bf16 v[116:119], v[220:223], v[148:151], v[116:119]
    s_waitcnt lgkmcnt(2)
    v_mfma_f32_16x16x32_bf16 v[64:67], v[224:227], v[56:59], v[64:67]
    s_waitcnt lgkmcnt(0)
    v_mfma_f32_16x16x32_bf16 v[68:71], v[228:231], v[56:59], v[68:71]
    s_nop 7
    s_nop 1
    s_barrier
    v_lshlrev_b32 v8, 4, v4
    v_add_u32 v8, 147456, v8
    s_add_u32 s9, s7, 0
    s_min_u32 s9, s9, 5
    s_lshl_b32 s9, s9, 6
    v_add_u32 v9, s9, v8
    ds_write_b128 v9, v[64:67]
    s_add_u32 s9, s7, 4
    s_min_u32 s9, s9, 5
    s_lshl_b32 s9, s9, 6
    v_add_u32 v9, s9, v8
    ds_write_b128 v9, v[68:71]
    v_add_f32 v60, v184, v186
    v_add_f32 v62, v185, v187
    v_mov_b32 v10, v60
    s_nop 1
    v_permlane16_swap_b32 v60, v10
    s_nop 1
    v_add_f32 v60, v60, v10
    v_mov_b32 v10, v60
    s_nop 1
    v_permlane32_swap_b32 v60, v10
    s_nop 1
    v_add_f32 v60, v60, v10
    v_mov_b32 v10, v62
    s_nop 1
    v_permlane16_swap_b32 v62, v10
    s_nop 1
    v_add_f32 v62, v62, v10
    v_mov_b32 v10, v62
    s_nop 1
    v_permlane32_swap_b32 v62, v10
    s_nop 1
    v_add_f32 v62, v62, v10
    v_add_f32 v61, v196, v198
    v_add_f32 v63, v197, v199
    v_mov_b32 v10, v61
    s_nop 1
    v_permlane16_swap_b32 v61, v10
    s_nop 1
    v_add_f32 v61, v61, v10
    v_mov_b32 v10, v61
    s_nop 1
    v_permlane32_swap_b32 v61, v10
    s_nop 1
    v_add_f32 v61, v61, v10
    v_mov_b32 v10, v63
    s_nop 1
    v_permlane16_swap_b32 v63, v10
    s_nop 1
    v_add_f32 v63, v63, v10
    v_mov_b32 v10, v63
    s_nop 1
    v_permlane32_swap_b32 v63, v10
    s_nop 1
    v_add_f32 v63, v63, v10
    s_waitcnt lgkmcnt(0)
    s_barrier
    ds_read_b128 v[208:211], v8 offset:0
    ds_read_b128 v[212:215], v8 offset:64
    ds_read_b128 v[216:219], v8 offset:128
    ds_read_b128 v[220:223], v8 offset:192
    ds_read_b128 v[224:227], v8 offset:256
    ds_read_b128 v[228:231], v8 offset:320
    s_mov_b32 s9, 0x3acccccd
    v_mul_f32 v60, s9, v60
    v_mul_f32 v62, s9, v62
    v_fma_f32 v62, -v60, v60, v62
    v_max_f32 v62, 0, v62
    s_mov_b32 s9, 0x3727c5ac
    v_cvt_pk_bf16_f32 v236, v60, v60
    v_lshlrev_b32 v236, 16, v236
    v_cvt_pk_bf16_f32 v237, v62, v62
    v_lshlrev_b32 v237, 16, v237
    v_add_f32 v237, s9, v237
    v_cvt_pk_bf16_f32 v237, v237, v237
    v_lshlrev_b32 v237, 16, v237
    v_sqrt_f32 v237, v237
    s_nop 0
    v_cvt_pk_bf16_f32 v237, v237, v237
    v_lshlrev_b32 v237, 16, v237
    v_rcp_f32 v238, v237
    s_nop 0
    v_mul_f32 v239, v236, v238
    v_sub_f32 v239, 0, v239
    s_mov_b32 s9, 0x3acccccd
    v_mul_f32 v61, s9, v61
    v_mul_f32 v63, s9, v63
    v_fma_f32 v63, -v61, v61, v63
    v_max_f32 v63, 0, v63
    s_mov_b32 s9, 0x3727c5ac
    v_cvt_pk_bf16_f32 v240, v61, v61
    v_lshlrev_b32 v240, 16, v240
    v_cvt_pk_bf16_f32 v241, v63, v63
    v_lshlrev_b32 v241, 16, v241
    v_add_f32 v241, s9, v241
    v_cvt_pk_bf16_f32 v241, v241, v241
    v_lshlrev_b32 v241, 16, v241
    v_sqrt_f32 v241, v241
    s_nop 0
    v_cvt_pk_bf16_f32 v241, v241, v241
    v_lshlrev_b32 v241, 16, v241
    v_rcp_f32 v242, v241
    s_nop 0
    v_mul_f32 v243, v240, v242
    v_sub_f32 v243, 0, v243
    s_waitcnt lgkmcnt(0)
    v_mov_b32 v8, v238
    v_mov_b32 v9, v238
    v_mov_b32 v10, v239
    v_mov_b32 v11, v239
    v_pk_mul_f32 v[72:73], v[72:73], v[8:9]
    v_pk_fma_f32 v[72:73], v[208:209], v[10:11], v[72:73]
    v_pk_mul_f32 v[74:75], v[74:75], v[8:9]
    v_pk_fma_f32 v[74:75], v[210:211], v[10:11], v[74:75]
    v_pk_mul_f32 v[76:77], v[76:77], v[8:9]
    v_pk_fma_f32 v[76:77], v[212:213], v[10:11], v[76:77]
    v_pk_mul_f32 v[78:79], v[78:79], v[8:9]
    v_pk_fma_f32 v[78:79], v[214:215], v[10:11], v[78:79]
    v_pk_mul_f32 v[80:81], v[80:81], v[8:9]
    v_pk_fma_f32 v[80:81], v[216:217], v[10:11], v[80:81]
    v_pk_mul_f32 v[82:83], v[82:83], v[8:9]
    v_pk_fma_f32 v[82:83], v[218:219], v[10:11], v[82:83]
    v_pk_mul_f32 v[84:85], v[84:85], v[8:9]
    v_pk_fma_f32 v[84:85], v[220:221], v[10:11], v[84:85]
    v_pk_mul_f32 v[86:87], v[86:87], v[8:9]
    v_pk_fma_f32 v[86:87], v[222:223], v[10:11], v[86:87]
    v_pk_mul_f32 v[88:89], v[88:89], v[8:9]
    v_pk_fma_f32 v[88:89], v[224:225], v[10:11], v[88:89]
    v_pk_mul_f32 v[90:91], v[90:91], v[8:9]
    v_pk_fma_f32 v[90:91], v[226:227], v[10:11], v[90:91]
    v_pk_mul_f32 v[92:93], v[92:93], v[8:9]
    v_pk_fma_f32 v[92:93], v[228:229], v[10:11], v[92:93]
    v_pk_mul_f32 v[94:95], v[94:95], v[8:9]
    v_pk_fma_f32 v[94:95], v[230:231], v[10:11], v[94:95]
    v_mov_b32 v8, v242
    v_mov_b32 v9, v242
    v_mov_b32 v10, v243
    v_mov_b32 v11, v243
    v_pk_mul_f32 v[96:97], v[96:97], v[8:9]
    v_pk_fma_f32 v[96:97], v[208:209], v[10:11], v[96:97]
    v_pk_mul_f32 v[98:99], v[98:99], v[8:9]
    v_pk_fma_f32 v[98:99], v[210:211], v[10:11], v[98:99]
    v_pk_mul_f32 v[100:101], v[100:101], v[8:9]
    v_pk_fma_f32 v[100:101], v[212:213], v[10:11], v[100:101]
    v_pk_mul_f32 v[102:103], v[102:103], v[8:9]
    v_pk_fma_f32 v[102:103], v[214:215], v[10:11], v[102:103]
    v_pk_mul_f32 v[104:105], v[104:105], v[8:9]
    v_pk_fma_f32 v[104:105], v[216:217], v[10:11], v[104:105]
    v_pk_mul_f32 v[106:107], v[106:107], v[8:9]
    v_pk_fma_f32 v[106:107], v[218:219], v[10:11], v[106:107]
    v_pk_mul_f32 v[108:109], v[108:109], v[8:9]
    v_pk_fma_f32 v[108:109], v[220:221], v[10:11], v[108:109]
    v_pk_mul_f32 v[110:111], v[110:111], v[8:9]
    v_pk_fma_f32 v[110:111], v[222:223], v[10:11], v[110:111]
    v_pk_mul_f32 v[112:113], v[112:113], v[8:9]
    v_pk_fma_f32 v[112:113], v[224:225], v[10:11], v[112:113]
    v_pk_mul_f32 v[114:115], v[114:115], v[8:9]
    v_pk_fma_f32 v[114:115], v[226:227], v[10:11], v[114:115]
    v_pk_mul_f32 v[116:117], v[116:117], v[8:9]
    v_pk_fma_f32 v[116:117], v[228:229], v[10:11], v[116:117]
    v_pk_mul_f32 v[118:119], v[118:119], v[8:9]
    v_pk_fma_f32 v[118:119], v[230:231], v[10:11], v[118:119]
    v_cvt_pk_bf16_f32 v8, v72, v73
    v_cvt_pk_bf16_f32 v9, v74, v75
    v_lshlrev_b32 v72, 16, v8
    v_and_b32 v73, 0xffff0000, v8
    v_lshlrev_b32 v74, 16, v9
    v_and_b32 v75, 0xffff0000, v9
    v_pk_mul_f32 v[8:9], v[72:73], v[72:73]
    v_pk_mul_f32 v[10:11], v[74:75], v[74:75]
    v_pk_fma_f32 v[8:9], v[8:9], v[192:193], v[190:191]
    v_pk_fma_f32 v[10:11], v[10:11], v[192:193], v[190:191]
    v_pk_mul_f32 v[8:9], v[8:9], v[72:73]
    v_pk_mul_f32 v[10:11], v[10:11], v[74:75]
    v_exp_f32 v8, v8
    v_exp_f32 v9, v9
    v_exp_f32 v10, v10
    v_exp_f32 v11, v11
    s_nop 0
    v_pk_add_f32 v[8:9], v[8:9], v[194:195]
    v_pk_add_f32 v[10:11], v[10:11], v[194:195]
    v_rcp_f32 v8, v8
    v_rcp_f32 v9, v9
    v_rcp_f32 v10, v10
    v_rcp_f32 v11, v11
    s_nop 0
    v_pk_mul_f32 v[72:73], v[72:73], v[8:9]
    v_pk_mul_f32 v[74:75], v[74:75], v[10:11]
    v_cvt_pk_bf16_f32 v72, v72, v73
    v_cvt_pk_bf16_f32 v73, v74, v75
    buffer_store_dwordx2 v[72:73], v188, s[48:51], 0 offen offset:0 sc1
    v_cvt_pk_bf16_f32 v8, v76, v77
    v_cvt_pk_bf16_f32 v9, v78, v79
    v_lshlrev_b32 v76, 16, v8
    v_and_b32 v77, 0xffff0000, v8
    v_lshlrev_b32 v78, 16, v9
    v_and_b32 v79, 0xffff0000, v9
    v_pk_mul_f32 v[8:9], v[76:77], v[76:77]
    v_pk_mul_f32 v[10:11], v[78:79], v[78:79]
    v_pk_fma_f32 v[8:9], v[8:9], v[192:193], v[190:191]
    v_pk_fma_f32 v[10:11], v[10:11], v[192:193], v[190:191]
    v_pk_mul_f32 v[8:9], v[8:9], v[76:77]
    v_pk_mul_f32 v[10:11], v[10:11], v[78:79]
    v_exp_f32 v8, v8
    v_exp_f32 v9, v9
    v_exp_f32 v10, v10
    v_exp_f32 v11, v11
    s_nop 0
    v_pk_add_f32 v[8:9], v[8:9], v[194:195]
    v_pk_add_f32 v[10:11], v[10:11], v[194:195]
    v_rcp_f32 v8, v8
    v_rcp_f32 v9, v9
    v_rcp_f32 v10, v10
    v_rcp_f32 v11, v11
    s_nop 0
    v_pk_mul_f32 v[76:77], v[76:77], v[8:9]
    v_pk_mul_f32 v[78:79], v[78:79], v[10:11]
    v_cvt_pk_bf16_f32 v76, v76, v77
    v_cvt_pk_bf16_f32 v77, v78, v79
    buffer_store_dwordx2 v[76:77], v188, s[48:51], 0 offen offset:512 sc1
    v_cvt_pk_bf16_f32 v8, v80, v81
    v_cvt_pk_bf16_f32 v9, v82, v83
    v_lshlrev_b32 v80, 16, v8
    v_and_b32 v81, 0xffff0000, v8
    v_lshlrev_b32 v82, 16, v9
    v_and_b32 v83, 0xffff0000, v9
    v_pk_mul_f32 v[8:9], v[80:81], v[80:81]
    v_pk_mul_f32 v[10:11], v[82:83], v[82:83]
    v_pk_fma_f32 v[8:9], v[8:9], v[192:193], v[190:191]
    v_pk_fma_f32 v[10:11], v[10:11], v[192:193], v[190:191]
    v_pk_mul_f32 v[8:9], v[8:9], v[80:81]
    v_pk_mul_f32 v[10:11], v[10:11], v[82:83]
    v_exp_f32 v8, v8
    v_exp_f32 v9, v9
    v_exp_f32 v10, v10
    v_exp_f32 v11, v11
    s_nop 0
    v_pk_add_f32 v[8:9], v[8:9], v[194:195]
    v_pk_add_f32 v[10:11], v[10:11], v[194:195]
    v_rcp_f32 v8, v8
    v_rcp_f32 v9, v9
    v_rcp_f32 v10, v10
    v_rcp_f32 v11, v11
    s_nop 0
    v_pk_mul_f32 v[80:81], v[80:81], v[8:9]
    v_pk_mul_f32 v[82:83], v[82:83], v[10:11]
    v_cvt_pk_bf16_f32 v80, v80, v81
    v_cvt_pk_bf16_f32 v81, v82, v83
    buffer_store_dwordx2 v[80:81], v188, s[48:51], 0 offen offset:1024 sc1
    v_cvt_pk_bf16_f32 v8, v84, v85
    v_cvt_pk_bf16_f32 v9, v86, v87
    v_lshlrev_b32 v84, 16, v8
    v_and_b32 v85, 0xffff0000, v8
    v_lshlrev_b32 v86, 16, v9
    v_and_b32 v87, 0xffff0000, v9
    v_pk_mul_f32 v[8:9], v[84:85], v[84:85]
    v_pk_mul_f32 v[10:11], v[86:87], v[86:87]
    v_pk_fma_f32 v[8:9], v[8:9], v[192:193], v[190:191]
    v_pk_fma_f32 v[10:11], v[10:11], v[192:193], v[190:191]
    v_pk_mul_f32 v[8:9], v[8:9], v[84:85]
    v_pk_mul_f32 v[10:11], v[10:11], v[86:87]
    v_exp_f32 v8, v8
    v_exp_f32 v9, v9
    v_exp_f32 v10, v10
    v_exp_f32 v11, v11
    s_nop 0
    v_pk_add_f32 v[8:9], v[8:9], v[194:195]
    v_pk_add_f32 v[10:11], v[10:11], v[194:195]
    v_rcp_f32 v8, v8
    v_rcp_f32 v9, v9
    v_rcp_f32 v10, v10
    v_rcp_f32 v11, v11
    s_nop 0
    v_pk_mul_f32 v[84:85], v[84:85], v[8:9]
    v_pk_mul_f32 v[86:87], v[86:87], v[10:11]
    v_cvt_pk_bf16_f32 v84, v84, v85
    v_cvt_pk_bf16_f32 v85, v86, v87
    buffer_store_dwordx2 v[84:85], v188, s[48:51], 0 offen offset:1536 sc1
    v_cvt_pk_bf16_f32 v8, v88, v89
    v_cvt_pk_bf16_f32 v9, v90, v91
    v_lshlrev_b32 v88, 16, v8
    v_and_b32 v89, 0xffff0000, v8
    v_lshlrev_b32 v90, 16, v9
    v_and_b32 v91, 0xffff0000, v9
    v_pk_mul_f32 v[8:9], v[88:89], v[88:89]
    v_pk_mul_f32 v[10:11], v[90:91], v[90:91]
    v_pk_fma_f32 v[8:9], v[8:9], v[192:193], v[190:191]
    v_pk_fma_f32 v[10:11], v[10:11], v[192:193], v[190:191]
    v_pk_mul_f32 v[8:9], v[8:9], v[88:89]
    v_pk_mul_f32 v[10:11], v[10:11], v[90:91]
    v_exp_f32 v8, v8
    v_exp_f32 v9, v9
    v_exp_f32 v10, v10
    v_exp_f32 v11, v11
    s_nop 0
    v_pk_add_f32 v[8:9], v[8:9], v[194:195]
    v_pk_add_f32 v[10:11], v[10:11], v[194:195]
    v_rcp_f32 v8, v8
    v_rcp_f32 v9, v9
    v_rcp_f32 v10, v10
    v_rcp_f32 v11, v11
    s_nop 0
    v_pk_mul_f32 v[88:89], v[88:89], v[8:9]
    v_pk_mul_f32 v[90:91], v[90:91], v[10:11]
    v_cvt_pk_bf16_f32 v88, v88, v89
    v_cvt_pk_bf16_f32 v89, v90, v91
    buffer_store_dwordx2 v[88:89], v188, s[48:51], 0 offen offset:2048 sc1
    v_cvt_pk_bf16_f32 v8, v92, v93
    v_cvt_pk_bf16_f32 v9, v94, v95
    v_lshlrev_b32 v92, 16, v8
    v_and_b32 v93, 0xffff0000, v8
    v_lshlrev_b32 v94, 16, v9
    v_and_b32 v95, 0xffff0000, v9
    v_pk_mul_f32 v[8:9], v[92:93], v[92:93]
    v_pk_mul_f32 v[10:11], v[94:95], v[94:95]
    v_pk_fma_f32 v[8:9], v[8:9], v[192:193], v[190:191]
    v_pk_fma_f32 v[10:11], v[10:11], v[192:193], v[190:191]
    v_pk_mul_f32 v[8:9], v[8:9], v[92:93]
    v_pk_mul_f32 v[10:11], v[10:11], v[94:95]
    v_exp_f32 v8, v8
    v_exp_f32 v9, v9
    v_exp_f32 v10, v10
    v_exp_f32 v11, v11
    s_nop 0
    v_pk_add_f32 v[8:9], v[8:9], v[194:195]
    v_pk_add_f32 v[10:11], v[10:11], v[194:195]
    v_rcp_f32 v8, v8
    v_rcp_f32 v9, v9
    v_rcp_f32 v10, v10
    v_rcp_f32 v11, v11
    s_nop 0
    v_pk_mul_f32 v[92:93], v[92:93], v[8:9]
    v_pk_mul_f32 v[94:95], v[94:95], v[10:11]
    v_cvt_pk_bf16_f32 v92, v92, v93
    v_cvt_pk_bf16_f32 v93, v94, v95
    buffer_store_dwordx2 v[92:93], v188, s[48:51], 0 offen offset:2560 sc1
    v_cvt_pk_bf16_f32 v8, v96, v97
    v_cvt_pk_bf16_f32 v9, v98, v99
    v_lshlrev_b32 v96, 16, v8
    v_and_b32 v97, 0xffff0000, v8
    v_lshlrev_b32 v98, 16, v9
    v_and_b32 v99, 0xffff0000, v9
    v_pk_mul_f32 v[8:9], v[96:97], v[96:97]
    v_pk_mul_f32 v[10:11], v[98:99], v[98:99]
    v_pk_fma_f32 v[8:9], v[8:9], v[204:205], v[202:203]
    v_pk_fma_f32 v[10:11], v[10:11], v[204:205], v[202:203]
    v_pk_mul_f32 v[8:9], v[8:9], v[96:97]
    v_pk_mul_f32 v[10:11], v[10:11], v[98:99]
    v_exp_f32 v8, v8
    v_exp_f32 v9, v9
    v_exp_f32 v10, v10
    v_exp_f32 v11, v11
    s_nop 0
    v_pk_add_f32 v[8:9], v[8:9], v[206:207]
    v_pk_add_f32 v[10:11], v[10:11], v[206:207]
    v_rcp_f32 v8, v8
    v_rcp_f32 v9, v9
    v_rcp_f32 v10, v10
    v_rcp_f32 v11, v11
    s_nop 0
    v_pk_mul_f32 v[96:97], v[96:97], v[8:9]
    v_pk_mul_f32 v[98:99], v[98:99], v[10:11]
    v_cvt_pk_bf16_f32 v96, v96, v97
    v_cvt_pk_bf16_f32 v97, v98, v99
    buffer_store_dwordx2 v[96:97], v200, s[48:51], 0 offen offset:0 sc1
    v_cvt_pk_bf16_f32 v8, v100, v101
    v_cvt_pk_bf16_f32 v9, v102, v103
    v_lshlrev_b32 v100, 16, v8
    v_and_b32 v101, 0xffff0000, v8
    v_lshlrev_b32 v102, 16, v9
    v_and_b32 v103, 0xffff0000, v9
    v_pk_mul_f32 v[8:9], v[100:101], v[100:101]
    v_pk_mul_f32 v[10:11], v[102:103], v[102:103]
    v_pk_fma_f32 v[8:9], v[8:9], v[204:205], v[202:203]
    v_pk_fma_f32 v[10:11], v[10:11], v[204:205], v[202:203]
    v_pk_mul_f32 v[8:9], v[8:9], v[100:101]
    v_pk_mul_f32 v[10:11], v[10:11], v[102:103]
    v_exp_f32 v8, v8
    v_exp_f32 v9, v9
    v_exp_f32 v10, v10
    v_exp_f32 v11, v11
    s_nop 0
    v_pk_add_f32 v[8:9], v[8:9], v[206:207]
    v_pk_add_f32 v[10:11], v[10:11], v[206:207]
    v_rcp_f32 v8, v8
    v_rcp_f32 v9, v9
    v_rcp_f32 v10, v10
    v_rcp_f32 v11, v11
    s_nop 0
    v_pk_mul_f32 v[100:101], v[100:101], v[8:9]
    v_pk_mul_f32 v[102:103], v[102:103], v[10:11]
    v_cvt_pk_bf16_f32 v100, v100, v101
    v_cvt_pk_bf16_f32 v101, v102, v103
    buffer_store_dwordx2 v[100:101], v200, s[48:51], 0 offen offset:512 sc1
    v_cvt_pk_bf16_f32 v8, v104, v105
    v_cvt_pk_bf16_f32 v9, v106, v107
    v_lshlrev_b32 v104, 16, v8
    v_and_b32 v105, 0xffff0000, v8
    v_lshlrev_b32 v106, 16, v9
    v_and_b32 v107, 0xffff0000, v9
    v_pk_mul_f32 v[8:9], v[104:105], v[104:105]
    v_pk_mul_f32 v[10:11], v[106:107], v[106:107]
    v_pk_fma_f32 v[8:9], v[8:9], v[204:205], v[202:203]
    v_pk_fma_f32 v[10:11], v[10:11], v[204:205], v[202:203]
    v_pk_mul_f32 v[8:9], v[8:9], v[104:105]
    v_pk_mul_f32 v[10:11], v[10:11], v[106:107]
    v_exp_f32 v8, v8
    v_exp_f32 v9, v9
    v_exp_f32 v10, v10
    v_exp_f32 v11, v11
    s_nop 0
    v_pk_add_f32 v[8:9], v[8:9], v[206:207]
    v_pk_add_f32 v[10:11], v[10:11], v[206:207]
    v_rcp_f32 v8, v8
    v_rcp_f32 v9, v9
    v_rcp_f32 v10, v10
    v_rcp_f32 v11, v11
    s_nop 0
    v_pk_mul_f32 v[104:105], v[104:105], v[8:9]
    v_pk_mul_f32 v[106:107], v[106:107], v[10:11]
    v_cvt_pk_bf16_f32 v104, v104, v105
    v_cvt_pk_bf16_f32 v105, v106, v107
    buffer_store_dwordx2 v[104:105], v200, s[48:51], 0 offen offset:1024 sc1
    v_cvt_pk_bf16_f32 v8, v108, v109
    v_cvt_pk_bf16_f32 v9, v110, v111
    v_lshlrev_b32 v108, 16, v8
    v_and_b32 v109, 0xffff0000, v8
    v_lshlrev_b32 v110, 16, v9
    v_and_b32 v111, 0xffff0000, v9
    v_pk_mul_f32 v[8:9], v[108:109], v[108:109]
    v_pk_mul_f32 v[10:11], v[110:111], v[110:111]
    v_pk_fma_f32 v[8:9], v[8:9], v[204:205], v[202:203]
    v_pk_fma_f32 v[10:11], v[10:11], v[204:205], v[202:203]
    v_pk_mul_f32 v[8:9], v[8:9], v[108:109]
    v_pk_mul_f32 v[10:11], v[10:11], v[110:111]
    v_exp_f32 v8, v8
    v_exp_f32 v9, v9
    v_exp_f32 v10, v10
    v_exp_f32 v11, v11
    s_nop 0
    v_pk_add_f32 v[8:9], v[8:9], v[206:207]
    v_pk_add_f32 v[10:11], v[10:11], v[206:207]
    v_rcp_f32 v8, v8
    v_rcp_f32 v9, v9
    v_rcp_f32 v10, v10
    v_rcp_f32 v11, v11
    s_nop 0
    v_pk_mul_f32 v[108:109], v[108:109], v[8:9]
    v_pk_mul_f32 v[110:111], v[110:111], v[10:11]
    v_cvt_pk_bf16_f32 v108, v108, v109
    v_cvt_pk_bf16_f32 v109, v110, v111
    buffer_store_dwordx2 v[108:109], v200, s[48:51], 0 offen offset:1536 sc1
    v_cvt_pk_bf16_f32 v8, v112, v113
    v_cvt_pk_bf16_f32 v9, v114, v115
    v_lshlrev_b32 v112, 16, v8
    v_and_b32 v113, 0xffff0000, v8
    v_lshlrev_b32 v114, 16, v9
    v_and_b32 v115, 0xffff0000, v9
    v_pk_mul_f32 v[8:9], v[112:113], v[112:113]
    v_pk_mul_f32 v[10:11], v[114:115], v[114:115]
    v_pk_fma_f32 v[8:9], v[8:9], v[204:205], v[202:203]
    v_pk_fma_f32 v[10:11], v[10:11], v[204:205], v[202:203]
    v_pk_mul_f32 v[8:9], v[8:9], v[112:113]
    v_pk_mul_f32 v[10:11], v[10:11], v[114:115]
    v_exp_f32 v8, v8
    v_exp_f32 v9, v9
    v_exp_f32 v10, v10
    v_exp_f32 v11, v11
    s_nop 0
    v_pk_add_f32 v[8:9], v[8:9], v[206:207]
    v_pk_add_f32 v[10:11], v[10:11], v[206:207]
    v_rcp_f32 v8, v8
    v_rcp_f32 v9, v9
    v_rcp_f32 v10, v10
    v_rcp_f32 v11, v11
    s_nop 0
    v_pk_mul_f32 v[112:113], v[112:113], v[8:9]
    v_pk_mul_f32 v[114:115], v[114:115], v[10:11]
    v_cvt_pk_bf16_f32 v112, v112, v113
    v_cvt_pk_bf16_f32 v113, v114, v115
    buffer_store_dwordx2 v[112:113], v200, s[48:51], 0 offen offset:2048 sc1
    v_cvt_pk_bf16_f32 v8, v116, v117
    v_cvt_pk_bf16_f32 v9, v118, v119
    v_lshlrev_b32 v116, 16, v8
    v_and_b32 v117, 0xffff0000, v8
    v_lshlrev_b32 v118, 16, v9
    v_and_b32 v119, 0xffff0000, v9
    v_pk_mul_f32 v[8:9], v[116:117], v[116:117]
    v_pk_mul_f32 v[10:11], v[118:119], v[118:119]
    v_pk_fma_f32 v[8:9], v[8:9], v[204:205], v[202:203]
    v_pk_fma_f32 v[10:11], v[10:11], v[204:205], v[202:203]
    v_pk_mul_f32 v[8:9], v[8:9], v[116:117]
    v_pk_mul_f32 v[10:11], v[10:11], v[118:119]
    v_exp_f32 v8, v8
    v_exp_f32 v9, v9
    v_exp_f32 v10, v10
    v_exp_f32 v11, v11
    s_nop 0
    v_pk_add_f32 v[8:9], v[8:9], v[206:207]
    v_pk_add_f32 v[10:11], v[10:11], v[206:207]
    v_rcp_f32 v8, v8
    v_rcp_f32 v9, v9
    v_rcp_f32 v10, v10
    v_rcp_f32 v11, v11
    s_nop 0
    v_pk_mul_f32 v[116:117], v[116:117], v[8:9]
    v_pk_mul_f32 v[118:119], v[118:119], v[10:11]
    v_cvt_pk_bf16_f32 v116, v116, v117
    v_cvt_pk_bf16_f32 v117, v118, v119
    buffer_store_dwordx2 v[116:117], v200, s[48:51], 0 offen offset:2560 sc1
    s_waitcnt vmcnt(0)
    s_barrier
    s_and_b32 s3, s2, 7
    s_lshr_b32 s4, s2, 3
    s_lshl_b32 s3, s3, 2
    s_and_b32 s5, s4, 3
    s_add_u32 s3, s3, s5
    s_lshr_b32 s4, s4, 2
    s_mul_i32 s5, s3, 64
    s_mul_i32 s6, s4, 80
    s_lshr_b32 s9, s5, 4
    s_mul_i32 s64, s7, 1
    s_add_u32 s64, s64, s9
    v_lshl_add_u32 v44, s64, 4, v3
    v_lshlrev_b32 v8, 4, v2
    s_mul_i32 s9, s64, 49152
    v_add_u32 v45, s9, v8
    v_bfe_u32 v8, v0, 2, 3
    v_bfe_u32 v9, v0, 5, 1
    v_lshl_add_u32 v9, v9, 4, v8
    v_mul_u32_u24 v9, 160, v9
    v_and_b32 v10, 3, v0
    v_lshl_add_u32 v9, v10, 3, v9
    v_mov_b32 v46, v9
    v_add_u32 v47, 65536, v46
    v_add_u32 v48, 131072, v46
    s_add_u32 s40, s36, 20971520
    s_addc_u32 s41, s37, 0
    s_and_b32 s41, s41, 0xffff
    s_mov_b32 s42, 6291456
    s_mov_b32 s43, 0x00020000
    s_mov_b32 s10, 655360
    s_add_u32 m0, s8, 81920
    s_nop 0
    buffer_load_dwordx4 v34, s[44:47], s10 offen lds
    s_mov_b32 s10, 655360
    s_add_u32 m0, s8, 86016
    s_nop 0
    buffer_load_dwordx4 v35, s[44:47], s10 offen lds
    s_mov_b32 s10, 655360
    s_add_u32 m0, s8, 90112
    s_nop 0
    buffer_load_dwordx4 v36, s[44:47], s10 offen lds
    s_mov_b32 s10, 655360
    s_add_u32 m0, s8, 94208
    s_nop 0
    buffer_load_dwordx4 v37, s[44:47], s10 offen lds
    s_mov_b32 s10, 655360
    s_add_u32 m0, s8, 98304
    s_nop 0
    buffer_load_dwordx4 v38, s[44:47], s10 offen lds
    s_mov_b32 s10, 819200
    s_add_u32 m0, s8, 102400
    s_nop 0
    buffer_load_dwordx4 v34, s[44:47], s10 offen lds
    s_mov_b32 s10, 819200
    s_add_u32 m0, s8, 106496
    s_nop 0
    buffer_load_dwordx4 v35, s[44:47], s10 offen lds
    s_mov_b32 s10, 819200
    s_add_u32 m0, s8, 110592
    s_nop 0
    buffer_load_dwordx4 v36, s[44:47], s10 offen lds
    s_mov_b32 s10, 819200
    s_add_u32 m0, s8, 114688
    s_nop 0
    buffer_load_dwordx4 v37, s[44:47], s10 offen lds
    s_mov_b32 s10, 819200
    s_add_u32 m0, s8, 118784
    s_nop 0
    buffer_load_dwordx4 v38, s[44:47], s10 offen lds
    s_mov_b32 s10, 983040
    s_add_u32 m0, s8, 122880
    s_nop 0
    buffer_load_dwordx4 v34, s[44:47], s10 offen lds
    s_mov_b32 s10, 983040
    s_add_u32 m0, s8, 126976
    s_nop 0
    buffer_load_dwordx4 v35, s[44:47], s10 offen lds
    s_mov_b32 s10, 983040
    s_add_u32 m0, s8, 131072
    s_nop 0
    buffer_load_dwordx4 v36, s[44:47], s10 offen lds
    s_mov_b32 s10, 983040
    s_add_u32 m0, s8, 135168
    s_nop 0
    buffer_load_dwordx4 v37, s[44:47], s10 offen lds
    s_mov_b32 s10, 983040
    s_add_u32 m0, s8, 139264
    s_nop 0
    buffer_load_dwordx4 v38, s[44:47], s10 offen lds
    s_barrier
    s_mov_b32 s10, 0
    buffer_load_dwordx4 v[72:75], v45, s[40:43], s10 offen offset:0 sc1
    s_mov_b32 s10, 0
    buffer_load_dwordx4 v[76:79], v45, s[40:43], s10 offen offset:1024 sc1
    s_mov_b32 s10, 0
    buffer_load_dwordx4 v[80:83], v45, s[40:43], s10 offen offset:2048 sc1
    s_mov_b32 s10, 0
    buffer_load_dwordx4 v[84:87], v45, s[40:43], s10 offen offset:3072 sc1
    s_mov_b32 s48, s32
    s_mov_b32 s49, s33
    s_and_b32 s49, s49, 0xffff
    s_mov_b32 s50, 2621440
    s_mov_b32 s51, 0x00020000
    v_mul_u32_u24 v184, 1280, v44
    v_lshl_add_u32 v184, v4, 3, v184
    v_lshl_add_u32 v184, s6, 1, v184
    s_mov_b32 s10, 4096
    buffer_load_dwordx4 v[88:91], v45, s[40:43], s10 offen offset:0 sc1
    s_mov_b32 s10, 4096
    buffer_load_dwordx4 v[92:95], v45, s[40:43], s10 offen offset:1024 sc1
    s_mov_b32 s10, 4096
    buffer_load_dwordx4 v[96:99], v45, s[40:43], s10 offen offset:2048 sc1
    s_mov_b32 s10, 4096
    buffer_load_dwordx4 v[100:103], v45, s[40:43], s10 offen offset:3072 sc1
    s_mov_b32 s10, 8192
    buffer_load_dwordx4 v[104:107], v45, s[40:43], s10 offen offset:0 sc1
    s_mov_b32 s10, 8192
    buffer_load_dwordx4 v[108:111], v45, s[40:43], s10 offen offset:1024 sc1
    s_mov_b32 s10, 8192
    buffer_load_dwordx4 v[112:115], v45, s[40:43], s10 offen offset:2048 sc1
    s_mov_b32 s10, 8192
    buffer_load_dwordx4 v[116:119], v45, s[40:43], s10 offen offset:3072 sc1
    s_mov_b32 s10, 12288
    buffer_load_dwordx4 v[120:123], v45, s[40:43], s10 offen offset:0 sc1
    s_mov_b32 s10, 12288
    buffer_load_dwordx4 v[124:127], v45, s[40:43], s10 offen offset:1024 sc1
    s_mov_b32 s10, 12288
    buffer_load_dwordx4 v[128:131], v45, s[40:43], s10 offen offset:2048 sc1
    s_mov_b32 s10, 12288
    buffer_load_dwordx4 v[132:135], v45, s[40:43], s10 offen offset:3072 sc1
    s_mov_b32 s10, 16384
    buffer_load_dwordx4 v[136:139], v45, s[40:43], s10 offen offset:0 sc1
    s_mov_b32 s10, 16384
    buffer_load_dwordx4 v[140:143], v45, s[40:43], s10 offen offset:1024 sc1
    s_mov_b32 s10, 16384
    buffer_load_dwordx4 v[144:147], v45, s[40:43], s10 offen offset:2048 sc1
    s_mov_b32 s10, 16384
    buffer_load_dwordx4 v[148:151], v45, s[40:43], s10 offen offset:3072 sc1
    v_mov_b32 v52, 0
    v_mov_b32 v53, 0
    v_mov_b32 v54, 0
    v_mov_b32 v55, 0
    v_mov_b32 v56, 0
    v_mov_b32 v57, 0
    v_mov_b32 v58, 0
    v_mov_b32 v59, 0
    v_mov_b32 v60, 0
    v_mov_b32 v61, 0
    v_mov_b32 v62, 0
    v_mov_b32 v63, 0
    v_mov_b32 v64, 0
    v_mov_b32 v65, 0
    v_mov_b32 v66, 0
    v_mov_b32 v67, 0
    v_mov_b32 v68, 0
    v_mov_b32 v69, 0
    v_mov_b32 v70, 0
    v_mov_b32 v71, 0
    s_waitcnt vmcnt(16)
    s_barrier
    ds_read_b64_tr_b16 v[188:189], v46 offset:0
    ds_read_b64_tr_b16 v[190:191], v46 offset:1280
    ds_read_b64_tr_b16 v[192:193], v46 offset:32
    ds_read_b64_tr_b16 v[194:195], v46 offset:1312
    ds_read_b64_tr_b16 v[196:197], v46 offset:64
    ds_read_b64_tr_b16 v[198:199], v46 offset:1344
    ds_read_b64_tr_b16 v[200:201], v46 offset:96
    ds_read_b64_tr_b16 v[202:203], v46 offset:1376
    ds_read_b64_tr_b16 v[204:205], v46 offset:128
    ds_read_b64_tr_b16 v[206:207], v46 offset:1408
    ds_read_b64_tr_b16 v[208:209], v46 offset:5120
    ds_read_b64_tr_b16 v[210:211], v46 offset:6400
    s_waitcnt lgkmcnt(10)
    v_mfma_f32_16x16x32_bf16 v[52:55], v[188:191], v[72:75], v[52:55]
    s_mov_b32 s10, 20480
    buffer_load_dwordx4 v[152:155], v45, s[40:43], s10 offen offset:0 sc1
    ds_read_b64_tr_b16 v[212:213], v46 offset:5152
    ds_read_b64_tr_b16 v[214:215], v46 offset:6432
    s_waitcnt lgkmcnt(10)
    v_mfma_f32_16x16x32_bf16 v[56:59], v[192:195], v[72:75], v[56:59]
    s_mov_b32 s10, 20480
    buffer_load_dwordx4 v[156:159], v45, s[40:43], s10 offen offset:1024 sc1
    ds_read_b64_tr_b16 v[188:189], v46 offset:5184
    ds_read_b64_tr_b16 v[190:191], v46 offset:6464
    s_waitcnt lgkmcnt(10)
    v_mfma_f32_16x16x32_bf16 v[60:63], v[196:199], v[72:75], v[60:63]
    s_mov_b32 s10, 20480
    buffer_load_dwordx4 v[160:163], v45, s[40:43], s10 offen offset:2048 sc1
    ds_read_b64_tr_b16 v[192:193], v46 offset:5216
    ds_read_b64_tr_b16 v[194:195], v46 offset:6496
    s_waitcnt lgkmcnt(10)
    v_mfma_f32_16x16x32_bf16 v[64:67], v[200:203], v[72:75], v[64:67]
    s_mov_b32 s10, 20480
    buffer_load_dwordx4 v[164:167], v45, s[40:43], s10 offen offset:3072 sc1
    ds_read_b64_tr_b16 v[196:197], v46 offset:5248
    ds_read_b64_tr_b16 v[198:199], v46 offset:6528
    s_waitcnt lgkmcnt(10)
    v_mfma_f32_16x16x32_bf16 v[68:71], v[204:207], v[72:75], v[68:71]
    ds_read_b64_tr_b16 v[200:201], v46 offset:10240
    ds_read_b64_tr_b16 v[202:203], v46 offset:11520
    s_waitcnt lgkmcnt(10)
    v_mfma_f32_16x16x32_bf16 v[52:55], v[208:211], v[76:79], v[52:55]
    ds_read_b64_tr_b16 v[204:205], v46 offset:10272
    ds_read_b64_tr_b16 v[206:207], v46 offset:11552
    s_waitcnt lgkmcnt(10)
    v_mfma_f32_16x16x32_bf16 v[56:59], v[212:215], v[76:79], v[56:59]
    ds_read_b64_tr_b16 v[208:209], v46 offset:10304
    ds_read_b64_tr_b16 v[210:211], v46 offset:11584
    s_waitcnt lgkmcnt(10)
    v_mfma_f32_16x16x32_bf16 v[60:63], v[188:191], v[76:79], v[60:63]
    ds_read_b64_tr_b16 v[212:213], v46 offset:10336
    ds_read_b64_tr_b16 v[214:215], v46 offset:11616
    s_waitcnt lgkmcnt(10)
    v_mfma_f32_16x16x32_bf16 v[64:67], v[192:195], v[76:79], v[64:67]
    ds_read_b64_tr_b16 v[188:189], v46 offset:10368
    ds_read_b64_tr_b16 v[190:191], v46 offset:11648
    s_waitcnt lgkmcnt(10)
    v_mfma_f32_16x16x32_bf16 v[68:71], v[196:199], v[76:79], v[68:71]
    ds_read_b64_tr_b16 v[192:193], v46 offset:15360
    ds_read_b64_tr_b16 v[194:195], v46 offset:16640
    s_waitcnt lgkmcnt(10)
    v_mfma_f32_16x16x32_bf16 v[52:55], v[200:203], v[80:83], v[52:55]
    ds_read_b64_tr_b16 v[196:197], v46 offset:15392
    ds_read_b64_tr_b16 v[198:199], v46 offset:16672
    s_waitcnt lgkmcnt(10)
    v_mfma_f32_16x16x32_bf16 v[56:59], v[204:207], v[80:83], v[56:59]
    ds_read_b64_tr_b16 v[200:201], v46 offset:15424
    ds_read_b64_tr_b16 v[202:203], v46 offset:16704
    s_waitcnt lgkmcnt(10)
    v_mfma_f32_16x16x32_bf16 v[60:63], v[208:211], v[80:83], v[60:63]
    ds_read_b64_tr_b16 v[204:205], v46 offset:15456
    ds_read_b64_tr_b16 v[206:207], v46 offset:16736
    s_waitcnt lgkmcnt(10)
    v_mfma_f32_16x16x32_bf16 v[64:67], v[212:215], v[80:83], v[64:67]
    ds_read_b64_tr_b16 v[208:209], v46 offset:15488
    ds_read_b64_tr_b16 v[210:211], v46 offset:16768
    s_waitcnt lgkmcnt(10)
    v_mfma_f32_16x16x32_bf16 v[68:71], v[188:191], v[80:83], v[68:71]
    s_waitcnt vmcnt(16)
    s_barrier
    ds_read_b64_tr_b16 v[212:213], v46 offset:20480
    ds_read_b64_tr_b16 v[214:215], v46 offset:21760
    s_waitcnt lgkmcnt(10)
    v_mfma_f32_16x16x32_bf16 v[52:55], v[192:195], v[84:87], v[52:55]
    s_mov_b32 s10, 24576
    buffer_load_dwordx4 v[168:171], v45, s[40:43], s10 offen offset:0 sc1
    ds_read_b64_tr_b16 v[188:189], v46 offset:20512
    ds_read_b64_tr_b16 v[190:191], v46 offset:21792
    s_waitcnt lgkmcnt(10)
    v_mfma_f32_16x16x32_bf16 v[56:59], v[196:199], v[84:87], v[56:59]
    s_mov_b32 s10, 24576
    buffer_load_dwordx4 v[172:175], v45, s[40:43], s10 offen offset:1024 sc1
    ds_read_b64_tr_b16 v[192:193], v46 offset:20544
    ds_read_b64_tr_b16 v[194:195], v46 offset:21824
    s_waitcnt lgkmcnt(10)
    v_mfma_f32_16x16x32_bf16 v[60:63], v[200:203], v[84:87], v[60:63]
    s_mov_b32 s10, 24576
    buffer_load_dwordx4 v[176:179], v45, s[40:43], s10 offen offset:2048 sc1
    ds_read_b64_tr_b16 v[196:197], v46 offset:20576
    ds_read_b64_tr_b16 v[198:199], v46 offset:21856
    s_waitcnt lgkmcnt(10)
    v_mfma_f32_16x16x32_bf16 v[64:67], v[204:207], v[84:87], v[64:67]
    s_mov_b32 s10, 24576
    buffer_load_dwordx4 v[180:183], v45, s[40:43], s10 offen offset:3072 sc1
    ds_read_b64_tr_b16 v[200:201], v46 offset:20608
    ds_read_b64_tr_b16 v[202:203], v46 offset:21888
    s_waitcnt lgkmcnt(10)
    v_mfma_f32_16x16x32_bf16 v[68:71], v[208:211], v[84:87], v[68:71]
    ds_read_b64_tr_b16 v[204:205], v46 offset:25600
    ds_read_b64_tr_b16 v[206:207], v46 offset:26880
    s_waitcnt lgkmcnt(10)
    v_mfma_f32_16x16x32_bf16 v[52:55], v[212:215], v[88:91], v[52:55]
    ds_read_b64_tr_b16 v[208:209], v46 offset:25632
    ds_read_b64_tr_b16 v[210:211], v46 offset:26912
    s_waitcnt lgkmcnt(10)
    v_mfma_f32_16x16x32_bf16 v[56:59], v[188:191], v[88:91], v[56:59]
    ds_read_b64_tr_b16 v[212:213], v46 offset:25664
    ds_read_b64_tr_b16 v[214:215], v46 offset:26944
    s_waitcnt lgkmcnt(10)
    v_mfma_f32_16x16x32_bf16 v[60:63], v[192:195], v[88:91], v[60:63]
    ds_read_b64_tr_b16 v[188:189], v46 offset:25696
    ds_read_b64_tr_b16 v[190:191], v46 offset:26976
    s_waitcnt lgkmcnt(10)
    v_mfma_f32_16x16x32_bf16 v[64:67], v[196:199], v[88:91], v[64:67]
    ds_read_b64_tr_b16 v[192:193], v46 offset:25728
    ds_read_b64_tr_b16 v[194:195], v46 offset:27008
    s_waitcnt lgkmcnt(10)
    v_mfma_f32_16x16x32_bf16 v[68:71], v[200:203], v[88:91], v[68:71]
    ds_read_b64_tr_b16 v[196:197], v46 offset:30720
    ds_read_b64_tr_b16 v[198:199], v46 offset:32000
    s_waitcnt lgkmcnt(10)
    v_mfma_f32_16x16x32_bf16 v[52:55], v[204:207], v[92:95], v[52:55]
    ds_read_b64_tr_b16 v[200:201], v46 offset:30752
    ds_read_b64_tr_b16 v[202:203], v46 offset:32032
    s_waitcnt lgkmcnt(10)
    v_mfma_f32_16x16x32_bf16 v[56:59], v[208:211], v[92:95], v[56:59]
    ds_read_b64_tr_b16 v[204:205], v46 offset:30784
    ds_read_b64_tr_b16 v[206:207], v46 offset:32064
    s_waitcnt lgkmcnt(10)
    v_mfma_f32_16x16x32_bf16 v[60:63], v[212:215], v[92:95], v[60:63]
    ds_read_b64_tr_b16 v[208:209], v46 offset:30816
    ds_read_b64_tr_b16 v[210:211], v46 offset:32096
    s_waitcnt lgkmcnt(10)
    v_mfma_f32_16x16x32_bf16 v[64:67], v[188:191], v[92:95], v[64:67]
    ds_read_b64_tr_b16 v[212:213], v46 offset:30848
    ds_read_b64_tr_b16 v[214:215], v46 offset:32128
    s_waitcnt lgkmcnt(10)
    v_mfma_f32_16x16x32_bf16 v[68:71], v[192:195], v[92:95], v[68:71]
    ds_read_b64_tr_b16 v[188:189], v46 offset:35840
    ds_read_b64_tr_b16 v[190:191], v46 offset:37120
    s_waitcnt lgkmcnt(10)
    v_mfma_f32_16x16x32_bf16 v[52:55], v[196:199], v[96:99], v[52:55]
    ds_read_b64_tr_b16 v[192:193], v46 offset:35872
    ds_read_b64_tr_b16 v[194:195], v46 offset:37152
    s_waitcnt lgkmcnt(10)
    v_mfma_f32_16x16x32_bf16 v[56:59], v[200:203], v[96:99], v[56:59]
    ds_read_b64_tr_b16 v[196:197], v46 offset:35904
    ds_read_b64_tr_b16 v[198:199], v46 offset:37184
    s_waitcnt lgkmcnt(10)
    v_mfma_f32_16x16x32_bf16 v[60:63], v[204:207], v[96:99], v[60:63]
    ds_read_b64_tr_b16 v[200:201], v46 offset:35936
    ds_read_b64_tr_b16 v[202:203], v46 offset:37216
    s_waitcnt lgkmcnt(10)
    v_mfma_f32_16x16x32_bf16 v[64:67], v[208:211], v[96:99], v[64:67]
    ds_read_b64_tr_b16 v[204:205], v46 offset:35968
    ds_read_b64_tr_b16 v[206:207], v46 offset:37248
    s_waitcnt lgkmcnt(10)
    v_mfma_f32_16x16x32_bf16 v[68:71], v[212:215], v[96:99], v[68:71]
    s_waitcnt vmcnt(16)
    s_barrier
    ds_read_b64_tr_b16 v[208:209], v46 offset:40960
    ds_read_b64_tr_b16 v[210:211], v46 offset:42240
    s_waitcnt lgkmcnt(10)
    v_mfma_f32_16x16x32_bf16 v[52:55], v[188:191], v[100:103], v[52:55]
    s_mov_b32 s10, 1146880
    s_add_u32 m0, s8, 0
    s_nop 0
    buffer_load_dwordx4 v34, s[44:47], s10 offen lds
    ds_read_b64_tr_b16 v[212:213], v46 offset:40992
    ds_read_b64_tr_b16 v[214:215], v46 offset:42272
    s_waitcnt lgkmcnt(10)
    v_mfma_f32_16x16x32_bf16 v[56:59], v[192:195], v[100:103], v[56:59]
    s_mov_b32 s10, 1146880
    s_add_u32 m0, s8, 4096
    s_nop 0
    buffer_load_dwordx4 v35, s[44:47], s10 offen lds
    ds_read_b64_tr_b16 v[188:189], v46 offset:41024
    ds_read_b64_tr_b16 v[190:191], v46 offset:42304
    s_waitcnt lgkmcnt(10)
    v_mfma_f32_16x16x32_bf16 v[60:63], v[196:199], v[100:103], v[60:63]
    s_mov_b32 s10, 1146880
    s_add_u32 m0, s8, 8192
    s_nop 0
    buffer_load_dwordx4 v36, s[44:47], s10 offen lds
    ds_read_b64_tr_b16 v[192:193], v46 offset:41056
    ds_read_b64_tr_b16 v[194:195], v46 offset:42336
    s_waitcnt lgkmcnt(10)
    v_mfma_f32_16x16x32_bf16 v[64:67], v[200:203], v[100:103], v[64:67]
    s_mov_b32 s10, 1146880
    s_add_u32 m0, s8, 12288
    s_nop 0
    buffer_load_dwordx4 v37, s[44:47], s10 offen lds
    ds_read_b64_tr_b16 v[196:197], v46 offset:41088
    ds_read_b64_tr_b16 v[198:199], v46 offset:42368
    s_waitcnt lgkmcnt(10)
    v_mfma_f32_16x16x32_bf16 v[68:71], v[204:207], v[100:103], v[68:71]
    s_mov_b32 s10, 1146880
    s_add_u32 m0, s8, 16384
    s_nop 0
    buffer_load_dwordx4 v38, s[44:47], s10 offen lds
    ds_read_b64_tr_b16 v[200:201], v46 offset:46080
    ds_read_b64_tr_b16 v[202:203], v46 offset:47360
    s_waitcnt lgkmcnt(10)
    v_mfma_f32_16x16x32_bf16 v[52:55], v[208:211], v[104:107], v[52:55]
    s_mov_b32 s10, 28672
    buffer_load_dwordx4 v[72:75], v45, s[40:43], s10 offen offset:0 sc1
    ds_read_b64_tr_b16 v[204:205], v46 offset:46112
    ds_read_b64_tr_b16 v[206:207], v46 offset:47392
    s_waitcnt lgkmcnt(10)
    v_mfma_f32_16x16x32_bf16 v[56:59], v[212:215], v[104:107], v[56:59]
    s_mov_b32 s10, 28672
    buffer_load_dwordx4 v[76:79], v45, s[40:43], s10 offen offset:1024 sc1
    ds_read_b64_tr_b16 v[208:209], v46 offset:46144
    ds_read_b64_tr_b16 v[210:211], v46 offset:47424
    s_waitcnt lgkmcnt(10)
    v_mfma_f32_16x16x32_bf16 v[60:63], v[188:191], v[104:107], v[60:63]
    s_mov_b32 s10, 28672
    buffer_load_dwordx4 v[80:83], v45, s[40:43], s10 offen offset:2048 sc1
    ds_read_b64_tr_b16 v[212:213], v46 offset:46176
    ds_read_b64_tr_b16 v[214:215], v46 offset:47456
    s_waitcnt lgkmcnt(10)
    v_mfma_f32_16x16x32_bf16 v[64:67], v[192:195], v[104:107], v[64:67]
    s_mov_b32 s10, 28672
    buffer_load_dwordx4 v[84:87], v45, s[40:43], s10 offen offset:3072 sc1
    ds_read_b64_tr_b16 v[188:189], v46 offset:46208
    ds_read_b64_tr_b16 v[190:191], v46 offset:47488
    s_waitcnt lgkmcnt(10)
    v_mfma_f32_16x16x32_bf16 v[68:71], v[196:199], v[104:107], v[68:71]
    ds_read_b64_tr_b16 v[192:193], v46 offset:51200
    ds_read_b64_tr_b16 v[194:195], v46 offset:52480
    s_waitcnt lgkmcnt(10)
    v_mfma_f32_16x16x32_bf16 v[52:55], v[200:203], v[108:111], v[52:55]
    ds_read_b64_tr_b16 v[196:197], v46 offset:51232
    ds_read_b64_tr_b16 v[198:199], v46 offset:52512
    s_waitcnt lgkmcnt(10)
    v_mfma_f32_16x16x32_bf16 v[56:59], v[204:207], v[108:111], v[56:59]
    ds_read_b64_tr_b16 v[200:201], v46 offset:51264
    ds_read_b64_tr_b16 v[202:203], v46 offset:52544
    s_waitcnt lgkmcnt(10)
    v_mfma_f32_16x16x32_bf16 v[60:63], v[208:211], v[108:111], v[60:63]
    ds_read_b64_tr_b16 v[204:205], v46 offset:51296
    ds_read_b64_tr_b16 v[206:207], v46 offset:52576
    s_waitcnt lgkmcnt(10)
    v_mfma_f32_16x16x32_bf16 v[64:67], v[212:215], v[108:111], v[64:67]
    ds_read_b64_tr_b16 v[208:209], v46 offset:51328
    ds_read_b64_tr_b16 v[210:211], v46 offset:52608
    s_waitcnt lgkmcnt(10)
    v_mfma_f32_16x16x32_bf16 v[68:71], v[188:191], v[108:111], v[68:71]
    ds_read_b64_tr_b16 v[212:213], v46 offset:56320
    ds_read_b64_tr_b16 v[214:215], v46 offset:57600
    s_waitcnt lgkmcnt(10)
    v_mfma_f32_16x16x32_bf16 v[52:55], v[192:195], v[112:115], v[52:55]
    ds_read_b64_tr_b16 v[188:189], v46 offset:56352
    ds_read_b64_tr_b16 v[190:191], v46 offset:57632
    s_waitcnt lgkmcnt(10)
    v_mfma_f32_16x16x32_bf16 v[56:59], v[196:199], v[112:115], v[56:59]
    ds_read_b64_tr_b16 v[192:193], v46 offset:56384
    ds_read_b64_tr_b16 v[194:195], v46 offset:57664
    s_waitcnt lgkmcnt(10)
    v_mfma_f32_16x16x32_bf16 v[60:63], v[200:203], v[112:115], v[60:63]
    ds_read_b64_tr_b16 v[196:197], v46 offset:56416
    ds_read_b64_tr_b16 v[198:199], v46 offset:57696
    s_waitcnt lgkmcnt(10)
    v_mfma_f32_16x16x32_bf16 v[64:67], v[204:207], v[112:115], v[64:67]
    ds_read_b64_tr_b16 v[200:201], v46 offset:56448
    ds_read_b64_tr_b16 v[202:203], v46 offset:57728
    s_waitcnt lgkmcnt(10)
    v_mfma_f32_16x16x32_bf16 v[68:71], v[208:211], v[112:115], v[68:71]
    s_waitcnt vmcnt(21)
    s_barrier
    ds_read_b64_tr_b16 v[204:205], v46 offset:61440
    ds_read_b64_tr_b16 v[206:207], v46 offset:62720
    s_waitcnt lgkmcnt(10)
    v_mfma_f32_16x16x32_bf16 v[52:55], v[212:215], v[116:119], v[52:55]
    s_mov_b32 s10, 1310720
    s_add_u32 m0, s8, 20480
    s_nop 0
    buffer_load_dwordx4 v34, s[44:47], s10 offen lds
    ds_read_b64_tr_b16 v[208:209], v46 offset:61472
    ds_read_b64_tr_b16 v[210:211], v46 offset:62752
    s_waitcnt lgkmcnt(10)
    v_mfma_f32_16x16x32_bf16 v[56:59], v[188:191], v[116:119], v[56:59]
    s_mov_b32 s10, 1310720
    s_add_u32 m0, s8, 24576
    s_nop 0
    buffer_load_dwordx4 v35, s[44:47], s10 offen lds
    ds_read_b64_tr_b16 v[212:213], v46 offset:61504
    ds_read_b64_tr_b16 v[214:215], v46 offset:62784
    s_waitcnt lgkmcnt(10)
    v_mfma_f32_16x16x32_bf16 v[60:63], v[192:195], v[116:119], v[60:63]
    s_mov_b32 s10, 1310720
    s_add_u32 m0, s8, 28672
    s_nop 0
    buffer_load_dwordx4 v36, s[44:47], s10 offen lds
    ds_read_b64_tr_b16 v[188:189], v46 offset:61536
    ds_read_b64_tr_b16 v[190:191], v46 offset:62816
    s_waitcnt lgkmcnt(10)
    v_mfma_f32_16x16x32_bf16 v[64:67], v[196:199], v[116:119], v[64:67]
    s_mov_b32 s10, 1310720
    s_add_u32 m0, s8, 32768
    s_nop 0
    buffer_load_dwordx4 v37, s[44:47], s10 offen lds
    ds_read_b64_tr_b16 v[192:193], v46 offset:61568
    ds_read_b64_tr_b16 v[194:195], v46 offset:62848
    s_waitcnt lgkmcnt(10)
    v_mfma_f32_16x16x32_bf16 v[68:71], v[200:203], v[116:119], v[68:71]
    s_mov_b32 s10, 1310720
    s_add_u32 m0, s8, 36864
    s_nop 0
    buffer_load_dwordx4 v38, s[44:47], s10 offen lds
    ds_read_b64_tr_b16 v[196:197], v47 offset:1024
    ds_read_b64_tr_b16 v[198:199], v47 offset:2304
    s_waitcnt lgkmcnt(10)
    v_mfma_f32_16x16x32_bf16 v[52:55], v[204:207], v[120:123], v[52:55]
    s_mov_b32 s10, 32768
    buffer_load_dwordx4 v[88:91], v45, s[40:43], s10 offen offset:0 sc1
    ds_read_b64_tr_b16 v[200:201], v47 offset:1056
    ds_read_b64_tr_b16 v[202:203], v47 offset:2336
    s_waitcnt lgkmcnt(10)
    v_mfma_f32_16x16x32_bf16 v[56:59], v[208:211], v[120:123], v[56:59]
    s_mov_b32 s10, 32768
    buffer_load_dwordx4 v[92:95], v45, s[40:43], s10 offen offset:1024 sc1
    ds_read_b64_tr_b16 v[204:205], v47 offset:1088
    ds_read_b64_tr_b16 v[206:207], v47 offset:2368
    s_waitcnt lgkmcnt(10)
    v_mfma_f32_16x16x32_bf16 v[60:63], v[212:215], v[120:123], v[60:63]
    s_mov_b32 s10, 32768
    buffer_load_dwordx4 v[96:99], v45, s[40:43], s10 offen offset:2048 sc1
    ds_read_b64_tr_b16 v[208:209], v47 offset:1120
    ds_read_b64_tr_b16 v[210:211], v47 offset:2400
    s_waitcnt lgkmcnt(10)
    v_mfma_f32_16x16x32_bf16 v[64:67], v[188:191], v[120:123], v[64:67]
    s_mov_b32 s10, 32768
    buffer_load_dwordx4 v[100:103], v45, s[40:43], s10 offen offset:3072 sc1
    ds_read_b64_tr_b16 v[212:213], v47 offset:1152
    ds_read_b64_tr_b16 v[214:215], v47 offset:2432
    s_waitcnt lgkmcnt(10)
    v_mfma_f32_16x16x32_bf16 v[68:71], v[192:195], v[120:123], v[68:71]
    ds_read_b64_tr_b16 v[188:189], v47 offset:6144
    ds_read_b64_tr_b16 v[190:191], v47 offset:7424
    s_waitcnt lgkmcnt(10)
    v_mfma_f32_16x16x32_bf16 v[52:55], v[196:199], v[124:127], v[52:55]
    ds_read_b64_tr_b16 v[192:193], v47 offset:6176
    ds_read_b64_tr_b16 v[194:195], v47 offset:7456
    s_waitcnt lgkmcnt(10)
    v_mfma_f32_16x16x32_bf16 v[56:59], v[200:203], v[124:127], v[56:59]
    ds_read_b64_tr_b16 v[196:197], v47 offset:6208
    ds_read_b64_tr_b16 v[198:199], v47 offset:7488
    s_waitcnt lgkmcnt(10)
    v_mfma_f32_16x16x32_bf16 v[60:63], v[204:207], v[124:127], v[60:63]
    ds_read_b64_tr_b16 v[200:201], v47 offset:6240
    ds_read_b64_tr_b16 v[202:203], v47 offset:7520
    s_waitcnt lgkmcnt(10)
    v_mfma_f32_16x16x32_bf16 v[64:67], v[208:211], v[124:127], v[64:67]
    ds_read_b64_tr_b16 v[204:205], v47 offset:6272
    ds_read_b64_tr_b16 v[206:207], v47 offset:7552
    s_waitcnt lgkmcnt(10)
    v_mfma_f32_16x16x32_bf16 v[68:71], v[212:215], v[124:127], v[68:71]
    ds_read_b64_tr_b16 v[208:209], v47 offset:11264
    ds_read_b64_tr_b16 v[210:211], v47 offset:12544
    s_waitcnt lgkmcnt(10)
    v_mfma_f32_16x16x32_bf16 v[52:55], v[188:191], v[128:131], v[52:55]
    ds_read_b64_tr_b16 v[212:213], v47 offset:11296
    ds_read_b64_tr_b16 v[214:215], v47 offset:12576
    s_waitcnt lgkmcnt(10)
    v_mfma_f32_16x16x32_bf16 v[56:59], v[192:195], v[128:131], v[56:59]
    ds_read_b64_tr_b16 v[188:189], v47 offset:11328
    ds_read_b64_tr_b16 v[190:191], v47 offset:12608
    s_waitcnt lgkmcnt(10)
    v_mfma_f32_16x16x32_bf16 v[60:63], v[196:199], v[128:131], v[60:63]
    ds_read_b64_tr_b16 v[192:193], v47 offset:11360
    ds_read_b64_tr_b16 v[194:195], v47 offset:12640
    s_waitcnt lgkmcnt(10)
    v_mfma_f32_16x16x32_bf16 v[64:67], v[200:203], v[128:131], v[64:67]
    ds_read_b64_tr_b16 v[196:197], v47 offset:11392
    ds_read_b64_tr_b16 v[198:199], v47 offset:12672
    s_waitcnt lgkmcnt(10)
    v_mfma_f32_16x16x32_bf16 v[68:71], v[204:207], v[128:131], v[68:71]
    s_waitcnt vmcnt(26)
    s_barrier
    ds_read_b64_tr_b16 v[200:201], v47 offset:16384
    ds_read_b64_tr_b16 v[202:203], v47 offset:17664
    s_waitcnt lgkmcnt(10)
    v_mfma_f32_16x16x32_bf16 v[52:55], v[208:211], v[132:135], v[52:55]
    s_mov_b32 s10, 1474560
    s_add_u32 m0, s8, 40960
    s_nop 0
    buffer_load_dwordx4 v34, s[44:47], s10 offen lds
    ds_read_b64_tr_b16 v[204:205], v47 offset:16416
    ds_read_b64_tr_b16 v[206:207], v47 offset:17696
    s_waitcnt lgkmcnt(10)
    v_mfma_f32_16x16x32_bf16 v[56:59], v[212:215], v[132:135], v[56:59]
    s_mov_b32 s10, 1474560
    s_add_u32 m0, s8, 45056
    s_nop 0
    buffer_load_dwordx4 v35, s[44:47], s10 offen lds
    ds_read_b64_tr_b16 v[208:209], v47 offset:16448
    ds_read_b64_tr_b16 v[210:211], v47 offset:17728
    s_waitcnt lgkmcnt(10)
    v_mfma_f32_16x16x32_bf16 v[60:63], v[188:191], v[132:135], v[60:63]
    s_mov_b32 s10, 1474560
    s_add_u32 m0, s8, 49152
    s_nop 0
    buffer_load_dwordx4 v36, s[44:47], s10 offen lds
    ds_read_b64_tr_b16 v[212:213], v47 offset:16480
    ds_read_b64_tr_b16 v[214:215], v47 offset:17760
    s_waitcnt lgkmcnt(10)
    v_mfma_f32_16x16x32_bf16 v[64:67], v[192:195], v[132:135], v[64:67]
    s_mov_b32 s10, 1474560
    s_add_u32 m0, s8, 53248
    s_nop 0
    buffer_load_dwordx4 v37, s[44:47], s10 offen lds
    ds_read_b64_tr_b16 v[188:189], v47 offset:16512
    ds_read_b64_tr_b16 v[190:191], v47 offset:17792
    s_waitcnt lgkmcnt(10)
    v_mfma_f32_16x16x32_bf16 v[68:71], v[196:199], v[132:135], v[68:71]
    s_mov_b32 s10, 1474560
    s_add_u32 m0, s8, 57344
    s_nop 0
    buffer_load_dwordx4 v38, s[44:47], s10 offen lds
    ds_read_b64_tr_b16 v[192:193], v47 offset:21504
    ds_read_b64_tr_b16 v[194:195], v47 offset:22784
    s_waitcnt lgkmcnt(10)
    v_mfma_f32_16x16x32_bf16 v[52:55], v[200:203], v[136:139], v[52:55]
    s_mov_b32 s10, 36864
    buffer_load_dwordx4 v[104:107], v45, s[40:43], s10 offen offset:0 sc1
    ds_read_b64_tr_b16 v[196:197], v47 offset:21536
    ds_read_b64_tr_b16 v[198:199], v47 offset:22816
    s_waitcnt lgkmcnt(10)
    v_mfma_f32_16x16x32_bf16 v[56:59], v[204:207], v[136:139], v[56:59]
    s_mov_b32 s10, 36864
    buffer_load_dwordx4 v[108:111], v45, s[40:43], s10 offen offset:1024 sc1
    ds_read_b64_tr_b16 v[200:201], v47 offset:21568
    ds_read_b64_tr_b16 v[202:203], v47 offset:22848
    s_waitcnt lgkmcnt(10)
    v_mfma_f32_16x16x32_bf16 v[60:63], v[208:211], v[136:139], v[60:63]
    s_mov_b32 s10, 36864
    buffer_load_dwordx4 v[112:115], v45, s[40:43], s10 offen offset:2048 sc1
    ds_read_b64_tr_b16 v[204:205], v47 offset:21600
    ds_read_b64_tr_b16 v[206:207], v47 offset:22880
    s_waitcnt lgkmcnt(10)
    v_mfma_f32_16x16x32_bf16 v[64:67], v[212:215], v[136:139], v[64:67]
    s_mov_b32 s10, 36864
    buffer_load_dwordx4 v[116:119], v45, s[40:43], s10 offen offset:3072 sc1
    ds_read_b64_tr_b16 v[208:209], v47 offset:21632
    ds_read_b64_tr_b16 v[210:211], v47 offset:22912
    s_waitcnt lgkmcnt(10)
    v_mfma_f32_16x16x32_bf16 v[68:71], v[188:191], v[136:139], v[68:71]
    ds_read_b64_tr_b16 v[212:213], v47 offset:26624
    ds_read_b64_tr_b16 v[214:215], v47 offset:27904
    s_waitcnt lgkmcnt(10)
    v_mfma_f32_16x16x32_bf16 v[52:55], v[192:195], v[140:143], v[52:55]
    ds_read_b64_tr_b16 v[188:189], v47 offset:26656
    ds_read_b64_tr_b16 v[190:191], v47 offset:27936
    s_waitcnt lgkmcnt(10)
    v_mfma_f32_16x16x32_bf16 v[56:59], v[196:199], v[140:143], v[56:59]
    ds_read_b64_tr_b16 v[192:193], v47 offset:26688
    ds_read_b64_tr_b16 v[194:195], v47 offset:27968
    s_waitcnt lgkmcnt(10)
    v_mfma_f32_16x16x32_bf16 v[60:63], v[200:203], v[140:143], v[60:63]
    ds_read_b64_tr_b16 v[196:197], v47 offset:26720
    ds_read_b64_tr_b16 v[198:199], v47 offset:28000
    s_waitcnt lgkmcnt(10)
    v_mfma_f32_16x16x32_bf16 v[64:67], v[204:207], v[140:143], v[64:67]
    ds_read_b64_tr_b16 v[200:201], v47 offset:26752
    ds_read_b64_tr_b16 v[202:203], v47 offset:28032
    s_waitcnt lgkmcnt(10)
    v_mfma_f32_16x16x32_bf16 v[68:71], v[208:211], v[140:143], v[68:71]
    ds_read_b64_tr_b16 v[204:205], v47 offset:31744
    ds_read_b64_tr_b16 v[206:207], v47 offset:33024
    s_waitcnt lgkmcnt(10)
    v_mfma_f32_16x16x32_bf16 v[52:55], v[212:215], v[144:147], v[52:55]
    ds_read_b64_tr_b16 v[208:209], v47 offset:31776
    ds_read_b64_tr_b16 v[210:211], v47 offset:33056
    s_waitcnt lgkmcnt(10)
    v_mfma_f32_16x16x32_bf16 v[56:59], v[188:191], v[144:147], v[56:59]
    ds_read_b64_tr_b16 v[212:213], v47 offset:31808
    ds_read_b64_tr_b16 v[214:215], v47 offset:33088
    s_waitcnt lgkmcnt(10)
    v_mfma_f32_16x16x32_bf16 v[60:63], v[192:195], v[144:147], v[60:63]
    ds_read_b64_tr_b16 v[188:189], v47 offset:31840
    ds_read_b64_tr_b16 v[190:191], v47 offset:33120
    s_waitcnt lgkmcnt(10)
    v_mfma_f32_16x16x32_bf16 v[64:67], v[196:199], v[144:147], v[64:67]
    ds_read_b64_tr_b16 v[192:193], v47 offset:31872
    ds_read_b64_tr_b16 v[194:195], v47 offset:33152
    s_waitcnt lgkmcnt(10)
    v_mfma_f32_16x16x32_bf16 v[68:71], v[200:203], v[144:147], v[68:71]
    s_waitcnt vmcnt(31)
    s_barrier
    ds_read_b64_tr_b16 v[196:197], v47 offset:36864
    ds_read_b64_tr_b16 v[198:199], v47 offset:38144
    s_waitcnt lgkmcnt(10)
    v_mfma_f32_16x16x32_bf16 v[52:55], v[204:207], v[148:151], v[52:55]
    s_mov_b32 s10, 1638400
    s_add_u32 m0, s8, 61440
    s_nop 0
    buffer_load_dwordx4 v34, s[44:47], s10 offen lds
    ds_read_b64_tr_b16 v[200:201], v47 offset:36896
    ds_read_b64_tr_b16 v[202:203], v47 offset:38176
    s_waitcnt lgkmcnt(10)
    v_mfma_f32_16x16x32_bf16 v[56:59], v[208:211], v[148:151], v[56:59]
    s_mov_b32 s10, 1638400
    s_add_u32 m0, s8, 65536
    s_nop 0
    buffer_load_dwordx4 v35, s[44:47], s10 offen lds
    ds_read_b64_tr_b16 v[204:205], v47 offset:36928
    ds_read_b64_tr_b16 v[206:207], v47 offset:38208
    s_waitcnt lgkmcnt(10)
    v_mfma_f32_16x16x32_bf16 v[60:63], v[212:215], v[148:151], v[60:63]
    s_mov_b32 s10, 1638400
    s_add_u32 m0, s8, 69632
    s_nop 0
    buffer_load_dwordx4 v36, s[44:47], s10 offen lds
    ds_read_b64_tr_b16 v[208:209], v47 offset:36960
    ds_read_b64_tr_b16 v[210:211], v47 offset:38240
    s_waitcnt lgkmcnt(10)
    v_mfma_f32_16x16x32_bf16 v[64:67], v[188:191], v[148:151], v[64:67]
    s_mov_b32 s10, 1638400
    s_add_u32 m0, s8, 73728
    s_nop 0
    buffer_load_dwordx4 v37, s[44:47], s10 offen lds
    ds_read_b64_tr_b16 v[212:213], v47 offset:36992
    ds_read_b64_tr_b16 v[214:215], v47 offset:38272
    s_waitcnt lgkmcnt(10)
    v_mfma_f32_16x16x32_bf16 v[68:71], v[192:195], v[148:151], v[68:71]
    s_mov_b32 s10, 1638400
    s_add_u32 m0, s8, 77824
    s_nop 0
    buffer_load_dwordx4 v38, s[44:47], s10 offen lds
    ds_read_b64_tr_b16 v[188:189], v47 offset:41984
    ds_read_b64_tr_b16 v[190:191], v47 offset:43264
    s_waitcnt lgkmcnt(10)
    v_mfma_f32_16x16x32_bf16 v[52:55], v[196:199], v[152:155], v[52:55]
    s_mov_b32 s10, 40960
    buffer_load_dwordx4 v[120:123], v45, s[40:43], s10 offen offset:0 sc1
    ds_read_b64_tr_b16 v[192:193], v47 offset:42016
    ds_read_b64_tr_b16 v[194:195], v47 offset:43296
    s_waitcnt lgkmcnt(10)
    v_mfma_f32_16x16x32_bf16 v[56:59], v[200:203], v[152:155], v[56:59]
    s_mov_b32 s10, 40960
    buffer_load_dwordx4 v[124:127], v45, s[40:43], s10 offen offset:1024 sc1
    ds_read_b64_tr_b16 v[196:197], v47 offset:42048
    ds_read_b64_tr_b16 v[198:199], v47 offset:43328
    s_waitcnt lgkmcnt(10)
    v_mfma_f32_16x16x32_bf16 v[60:63], v[204:207], v[152:155], v[60:63]
    s_mov_b32 s10, 40960
    buffer_load_dwordx4 v[128:131], v45, s[40:43], s10 offen offset:2048 sc1
    ds_read_b64_tr_b16 v[200:201], v47 offset:42080
    ds_read_b64_tr_b16 v[202:203], v47 offset:43360
    s_waitcnt lgkmcnt(10)
    v_mfma_f32_16x16x32_bf16 v[64:67], v[208:211], v[152:155], v[64:67]
    s_mov_b32 s10, 40960
    buffer_load_dwordx4 v[132:135], v45, s[40:43], s10 offen offset:3072 sc1
    ds_read_b64_tr_b16 v[204:205], v47 offset:42112
    ds_read_b64_tr_b16 v[206:207], v47 offset:43392
    s_waitcnt lgkmcnt(10)
    v_mfma_f32_16x16x32_bf16 v[68:71], v[212:215], v[152:155], v[68:71]
    ds_read_b64_tr_b16 v[208:209], v47 offset:47104
    ds_read_b64_tr_b16 v[210:211], v47 offset:48384
    s_waitcnt lgkmcnt(10)
    v_mfma_f32_16x16x32_bf16 v[52:55], v[188:191], v[156:159], v[52:55]
    ds_read_b64_tr_b16 v[212:213], v47 offset:47136
    ds_read_b64_tr_b16 v[214:215], v47 offset:48416
    s_waitcnt lgkmcnt(10)
    v_mfma_f32_16x16x32_bf16 v[56:59], v[192:195], v[156:159], v[56:59]
    ds_read_b64_tr_b16 v[188:189], v47 offset:47168
    ds_read_b64_tr_b16 v[190:191], v47 offset:48448
    s_waitcnt lgkmcnt(10)
    v_mfma_f32_16x16x32_bf16 v[60:63], v[196:199], v[156:159], v[60:63]
    ds_read_b64_tr_b16 v[192:193], v47 offset:47200
    ds_read_b64_tr_b16 v[194:195], v47 offset:48480
    s_waitcnt lgkmcnt(10)
    v_mfma_f32_16x16x32_bf16 v[64:67], v[200:203], v[156:159], v[64:67]
    ds_read_b64_tr_b16 v[196:197], v47 offset:47232
    ds_read_b64_tr_b16 v[198:199], v47 offset:48512
    s_waitcnt lgkmcnt(10)
    v_mfma_f32_16x16x32_bf16 v[68:71], v[204:207], v[156:159], v[68:71]
    ds_read_b64_tr_b16 v[200:201], v47 offset:52224
    ds_read_b64_tr_b16 v[202:203], v47 offset:53504
    s_waitcnt lgkmcnt(10)
    v_mfma_f32_16x16x32_bf16 v[52:55], v[208:211], v[160:163], v[52:55]
    ds_read_b64_tr_b16 v[204:205], v47 offset:52256
    ds_read_b64_tr_b16 v[206:207], v47 offset:53536
    s_waitcnt lgkmcnt(10)
    v_mfma_f32_16x16x32_bf16 v[56:59], v[212:215], v[160:163], v[56:59]
    ds_read_b64_tr_b16 v[208:209], v47 offset:52288
    ds_read_b64_tr_b16 v[210:211], v47 offset:53568
    s_waitcnt lgkmcnt(10)
    v_mfma_f32_16x16x32_bf16 v[60:63], v[188:191], v[160:163], v[60:63]
    ds_read_b64_tr_b16 v[212:213], v47 offset:52320
    ds_read_b64_tr_b16 v[214:215], v47 offset:53600
    s_waitcnt lgkmcnt(10)
    v_mfma_f32_16x16x32_bf16 v[64:67], v[192:195], v[160:163], v[64:67]
    ds_read_b64_tr_b16 v[188:189], v47 offset:52352
    ds_read_b64_tr_b16 v[190:191], v47 offset:53632
    s_waitcnt lgkmcnt(10)
    v_mfma_f32_16x16x32_bf16 v[68:71], v[196:199], v[160:163], v[68:71]
    s_waitcnt vmcnt(36)
    s_barrier
    ds_read_b64_tr_b16 v[192:193], v47 offset:57344
    ds_read_b64_tr_b16 v[194:195], v47 offset:58624
    s_waitcnt lgkmcnt(10)
    v_mfma_f32_16x16x32_bf16 v[52:55], v[200:203], v[164:167], v[52:55]
    s_mov_b32 s10, 1802240
    s_add_u32 m0, s8, 81920
    s_nop 0
    buffer_load_dwordx4 v34, s[44:47], s10 offen lds
    ds_read_b64_tr_b16 v[196:197], v47 offset:57376
    ds_read_b64_tr_b16 v[198:199], v47 offset:58656
    s_waitcnt lgkmcnt(10)
    v_mfma_f32_16x16x32_bf16 v[56:59], v[204:207], v[164:167], v[56:59]
    s_mov_b32 s10, 1802240
    s_add_u32 m0, s8, 86016
    s_nop 0
    buffer_load_dwordx4 v35, s[44:47], s10 offen lds
    ds_read_b64_tr_b16 v[200:201], v47 offset:57408
    ds_read_b64_tr_b16 v[202:203], v47 offset:58688
    s_waitcnt lgkmcnt(10)
    v_mfma_f32_16x16x32_bf16 v[60:63], v[208:211], v[164:167], v[60:63]
    s_mov_b32 s10, 1802240
    s_add_u32 m0, s8, 90112
    s_nop 0
    buffer_load_dwordx4 v36, s[44:47], s10 offen lds
    ds_read_b64_tr_b16 v[204:205], v47 offset:57440
    ds_read_b64_tr_b16 v[206:207], v47 offset:58720
    s_waitcnt lgkmcnt(10)
    v_mfma_f32_16x16x32_bf16 v[64:67], v[212:215], v[164:167], v[64:67]
    s_mov_b32 s10, 1802240
    s_add_u32 m0, s8, 94208
    s_nop 0
    buffer_load_dwordx4 v37, s[44:47], s10 offen lds
    ds_read_b64_tr_b16 v[208:209], v47 offset:57472
    ds_read_b64_tr_b16 v[210:211], v47 offset:58752
    s_waitcnt lgkmcnt(10)
    v_mfma_f32_16x16x32_bf16 v[68:71], v[188:191], v[164:167], v[68:71]
    s_mov_b32 s10, 1802240
    s_add_u32 m0, s8, 98304
    s_nop 0
    buffer_load_dwordx4 v38, s[44:47], s10 offen lds
    ds_read_b64_tr_b16 v[212:213], v47 offset:62464
    ds_read_b64_tr_b16 v[214:215], v47 offset:63744
    s_waitcnt lgkmcnt(10)
    v_mfma_f32_16x16x32_bf16 v[52:55], v[192:195], v[168:171], v[52:55]
    s_mov_b32 s10, 45056
    buffer_load_dwordx4 v[136:139], v45, s[40:43], s10 offen offset:0 sc1
    ds_read_b64_tr_b16 v[188:189], v47 offset:62496
    ds_read_b64_tr_b16 v[190:191], v47 offset:63776
    s_waitcnt lgkmcnt(10)
    v_mfma_f32_16x16x32_bf16 v[56:59], v[196:199], v[168:171], v[56:59]
    s_mov_b32 s10, 45056
    buffer_load_dwordx4 v[140:143], v45, s[40:43], s10 offen offset:1024 sc1
    ds_read_b64_tr_b16 v[192:193], v47 offset:62528
    ds_read_b64_tr_b16 v[194:195], v47 offset:63808
    s_waitcnt lgkmcnt(10)
    v_mfma_f32_16x16x32_bf16 v[60:63], v[200:203], v[168:171], v[60:63]
    s_mov_b32 s10, 45056
    buffer_load_dwordx4 v[144:147], v45, s[40:43], s10 offen offset:2048 sc1
    ds_read_b64_tr_b16 v[196:197], v47 offset:62560
    ds_read_b64_tr_b16 v[198:199], v47 offset:63840
    s_waitcnt lgkmcnt(10)
    v_mfma_f32_16x16x32_bf16 v[64:67], v[204:207], v[168:171], v[64:67]
    s_mov_b32 s10, 45056
    buffer_load_dwordx4 v[148:151], v45, s[40:43], s10 offen offset:3072 sc1
    ds_read_b64_tr_b16 v[200:201], v47 offset:62592
    ds_read_b64_tr_b16 v[202:203], v47 offset:63872
    s_waitcnt lgkmcnt(10)
    v_mfma_f32_16x16x32_bf16 v[68:71], v[208:211], v[168:171], v[68:71]
    ds_read_b64_tr_b16 v[204:205], v48 offset:2048
    ds_read_b64_tr_b16 v[206:207], v48 offset:3328
    s_waitcnt lgkmcnt(10)
    v_mfma_f32_16x16x32_bf16 v[52:55], v[212:215], v[172:175], v[52:55]
    ds_read_b64_tr_b16 v[208:209], v48 offset:2080
    ds_read_b64_tr_b16 v[210:211], v48 offset:3360
    s_waitcnt lgkmcnt(10)
    v_mfma_f32_16x16x32_bf16 v[56:59], v[188:191], v[172:175], v[56:59]
    ds_read_b64_tr_b16 v[212:213], v48 offset:2112
    ds_read_b64_tr_b16 v[214:215], v48 offset:3392
    s_waitcnt lgkmcnt(10)
    v_mfma_f32_16x16x32_bf16 v[60:63], v[192:195], v[172:175], v[60:63]
    ds_read_b64_tr_b16 v[188:189], v48 offset:2144
    ds_read_b64_tr_b16 v[190:191], v48 offset:3424
    s_waitcnt lgkmcnt(10)
    v_mfma_f32_16x16x32_bf16 v[64:67], v[196:199], v[172:175], v[64:67]
    ds_read_b64_tr_b16 v[192:193], v48 offset:2176
    ds_read_b64_tr_b16 v[194:195], v48 offset:3456
    s_waitcnt lgkmcnt(10)
    v_mfma_f32_16x16x32_bf16 v[68:71], v[200:203], v[172:175], v[68:71]
    ds_read_b64_tr_b16 v[196:197], v48 offset:7168
    ds_read_b64_tr_b16 v[198:199], v48 offset:8448
    s_waitcnt lgkmcnt(10)
    v_mfma_f32_16x16x32_bf16 v[52:55], v[204:207], v[176:179], v[52:55]
    ds_read_b64_tr_b16 v[200:201], v48 offset:7200
    ds_read_b64_tr_b16 v[202:203], v48 offset:8480
    s_waitcnt lgkmcnt(10)
    v_mfma_f32_16x16x32_bf16 v[56:59], v[208:211], v[176:179], v[56:59]
    ds_read_b64_tr_b16 v[204:205], v48 offset:7232
    ds_read_b64_tr_b16 v[206:207], v48 offset:8512
    s_waitcnt lgkmcnt(10)
    v_mfma_f32_16x16x32_bf16 v[60:63], v[212:215], v[176:179], v[60:63]
    ds_read_b64_tr_b16 v[208:209], v48 offset:7264
    ds_read_b64_tr_b16 v[210:211], v48 offset:8544
    s_waitcnt lgkmcnt(10)
    v_mfma_f32_16x16x32_bf16 v[64:67], v[188:191], v[176:179], v[64:67]
    ds_read_b64_tr_b16 v[212:213], v48 offset:7296
    ds_read_b64_tr_b16 v[214:215], v48 offset:8576
    s_waitcnt lgkmcnt(10)
    v_mfma_f32_16x16x32_bf16 v[68:71], v[192:195], v[176:179], v[68:71]
    s_waitcnt vmcnt(36)
    s_barrier
    ds_read_b64_tr_b16 v[188:189], v46 offset:0
    ds_read_b64_tr_b16 v[190:191], v46 offset:1280
    s_waitcnt lgkmcnt(10)
    v_mfma_f32_16x16x32_bf16 v[52:55], v[196:199], v[180:183], v[52:55]
    ds_read_b64_tr_b16 v[192:193], v46 offset:32
    ds_read_b64_tr_b16 v[194:195], v46 offset:1312
    s_waitcnt lgkmcnt(10)
    v_mfma_f32_16x16x32_bf16 v[56:59], v[200:203], v[180:183], v[56:59]
    ds_read_b64_tr_b16 v[196:197], v46 offset:64
    ds_read_b64_tr_b16 v[198:199], v46 offset:1344
    s_waitcnt lgkmcnt(10)
    v_mfma_f32_16x16x32_bf16 v[60:63], v[204:207], v[180:183], v[60:63]
    ds_read_b64_tr_b16 v[200:201], v46 offset:96
    ds_read_b64_tr_b16 v[202:203], v46 offset:1376
    s_waitcnt lgkmcnt(10)
    v_mfma_f32_16x16x32_bf16 v[64:67], v[208:211], v[180:183], v[64:67]
    ds_read_b64_tr_b16 v[204:205], v46 offset:128
    ds_read_b64_tr_b16 v[206:207], v46 offset:1408
    s_waitcnt lgkmcnt(10)
    v_mfma_f32_16x16x32_bf16 v[68:71], v[212:215], v[180:183], v[68:71]
    ds_read_b64_tr_b16 v[208:209], v46 offset:5120
    ds_read_b64_tr_b16 v[210:211], v46 offset:6400
    s_waitcnt lgkmcnt(10)
    v_mfma_f32_16x16x32_bf16 v[52:55], v[188:191], v[72:75], v[52:55]
    ds_read_b64_tr_b16 v[212:213], v46 offset:5152
    ds_read_b64_tr_b16 v[214:215], v46 offset:6432
    s_waitcnt lgkmcnt(10)
    v_mfma_f32_16x16x32_bf16 v[56:59], v[192:195], v[72:75], v[56:59]
    ds_read_b64_tr_b16 v[188:189], v46 offset:5184
    ds_read_b64_tr_b16 v[190:191], v46 offset:6464
    s_waitcnt lgkmcnt(10)
    v_mfma_f32_16x16x32_bf16 v[60:63], v[196:199], v[72:75], v[60:63]
    ds_read_b64_tr_b16 v[192:193], v46 offset:5216
    ds_read_b64_tr_b16 v[194:195], v46 offset:6496
    s_waitcnt lgkmcnt(10)
    v_mfma_f32_16x16x32_bf16 v[64:67], v[200:203], v[72:75], v[64:67]
    ds_read_b64_tr_b16 v[196:197], v46 offset:5248
    ds_read_b64_tr_b16 v[198:199], v46 offset:6528
    s_waitcnt lgkmcnt(10)
    v_mfma_f32_16x16x32_bf16 v[68:71], v[204:207], v[72:75], v[68:71]
    ds_read_b64_tr_b16 v[200:201], v46 offset:10240
    ds_read_b64_tr_b16 v[202:203], v46 offset:11520
    s_waitcnt lgkmcnt(10)
    v_mfma_f32_16x16x32_bf16 v[52:55], v[208:211], v[76:79], v[52:55]
    ds_read_b64_tr_b16 v[204:205], v46 offset:10272
    ds_read_b64_tr_b16 v[206:207], v46 offset:11552
    s_waitcnt lgkmcnt(10)
    v_mfma_f32_16x16x32_bf16 v[56:59], v[212:215], v[76:79], v[56:59]
    ds_read_b64_tr_b16 v[208:209], v46 offset:10304
    ds_read_b64_tr_b16 v[210:211], v46 offset:11584
    s_waitcnt lgkmcnt(10)
    v_mfma_f32_16x16x32_bf16 v[60:63], v[188:191], v[76:79], v[60:63]
    ds_read_b64_tr_b16 v[212:213], v46 offset:10336
    ds_read_b64_tr_b16 v[214:215], v46 offset:11616
    s_waitcnt lgkmcnt(10)
    v_mfma_f32_16x16x32_bf16 v[64:67], v[192:195], v[76:79], v[64:67]
    ds_read_b64_tr_b16 v[188:189], v46 offset:10368
    ds_read_b64_tr_b16 v[190:191], v46 offset:11648
    s_waitcnt lgkmcnt(10)
    v_mfma_f32_16x16x32_bf16 v[68:71], v[196:199], v[76:79], v[68:71]
    ds_read_b64_tr_b16 v[192:193], v46 offset:15360
    ds_read_b64_tr_b16 v[194:195], v46 offset:16640
    s_waitcnt lgkmcnt(10)
    v_mfma_f32_16x16x32_bf16 v[52:55], v[200:203], v[80:83], v[52:55]
    ds_read_b64_tr_b16 v[196:197], v46 offset:15392
    ds_read_b64_tr_b16 v[198:199], v46 offset:16672
    s_waitcnt lgkmcnt(10)
    v_mfma_f32_16x16x32_bf16 v[56:59], v[204:207], v[80:83], v[56:59]
    ds_read_b64_tr_b16 v[200:201], v46 offset:15424
    ds_read_b64_tr_b16 v[202:203], v46 offset:16704
    s_waitcnt lgkmcnt(10)
    v_mfma_f32_16x16x32_bf16 v[60:63], v[208:211], v[80:83], v[60:63]
    ds_read_b64_tr_b16 v[204:205], v46 offset:15456
    ds_read_b64_tr_b16 v[206:207], v46 offset:16736
    s_waitcnt lgkmcnt(10)
    v_mfma_f32_16x16x32_bf16 v[64:67], v[212:215], v[80:83], v[64:67]
    ds_read_b64_tr_b16 v[208:209], v46 offset:15488
    ds_read_b64_tr_b16 v[210:211], v46 offset:16768
    s_waitcnt lgkmcnt(10)
    v_mfma_f32_16x16x32_bf16 v[68:71], v[188:191], v[80:83], v[68:71]
    s_waitcnt vmcnt(27)
    s_barrier
    ds_read_b64_tr_b16 v[212:213], v46 offset:20480
    ds_read_b64_tr_b16 v[214:215], v46 offset:21760
    s_waitcnt lgkmcnt(10)
    v_mfma_f32_16x16x32_bf16 v[52:55], v[192:195], v[84:87], v[52:55]
    ds_read_b64_tr_b16 v[188:189], v46 offset:20512
    ds_read_b64_tr_b16 v[190:191], v46 offset:21792
    s_waitcnt lgkmcnt(10)
    v_mfma_f32_16x16x32_bf16 v[56:59], v[196:199], v[84:87], v[56:59]
    ds_read_b64_tr_b16 v[192:193], v46 offset:20544
    ds_read_b64_tr_b16 v[194:195], v46 offset:21824
    s_waitcnt lgkmcnt(10)
    v_mfma_f32_16x16x32_bf16 v[60:63], v[200:203], v[84:87], v[60:63]
    ds_read_b64_tr_b16 v[196:197], v46 offset:20576
    ds_read_b64_tr_b16 v[198:199], v46 offset:21856
    s_waitcnt lgkmcnt(10)
    v_mfma_f32_16x16x32_bf16 v[64:67], v[204:207], v[84:87], v[64:67]
    ds_read_b64_tr_b16 v[200:201], v46 offset:20608
    ds_read_b64_tr_b16 v[202:203], v46 offset:21888
    s_waitcnt lgkmcnt(10)
    v_mfma_f32_16x16x32_bf16 v[68:71], v[208:211], v[84:87], v[68:71]
    ds_read_b64_tr_b16 v[204:205], v46 offset:25600
    ds_read_b64_tr_b16 v[206:207], v46 offset:26880
    s_waitcnt lgkmcnt(10)
    v_mfma_f32_16x16x32_bf16 v[52:55], v[212:215], v[88:91], v[52:55]
    ds_read_b64_tr_b16 v[208:209], v46 offset:25632
    ds_read_b64_tr_b16 v[210:211], v46 offset:26912
    s_waitcnt lgkmcnt(10)
    v_mfma_f32_16x16x32_bf16 v[56:59], v[188:191], v[88:91], v[56:59]
    ds_read_b64_tr_b16 v[212:213], v46 offset:25664
    ds_read_b64_tr_b16 v[214:215], v46 offset:26944
    s_waitcnt lgkmcnt(10)
    v_mfma_f32_16x16x32_bf16 v[60:63], v[192:195], v[88:91], v[60:63]
    ds_read_b64_tr_b16 v[188:189], v46 offset:25696
    ds_read_b64_tr_b16 v[190:191], v46 offset:26976
    s_waitcnt lgkmcnt(10)
    v_mfma_f32_16x16x32_bf16 v[64:67], v[196:199], v[88:91], v[64:67]
    ds_read_b64_tr_b16 v[192:193], v46 offset:25728
    ds_read_b64_tr_b16 v[194:195], v46 offset:27008
    s_waitcnt lgkmcnt(10)
    v_mfma_f32_16x16x32_bf16 v[68:71], v[200:203], v[88:91], v[68:71]
    ds_read_b64_tr_b16 v[196:197], v46 offset:30720
    ds_read_b64_tr_b16 v[198:199], v46 offset:32000
    s_waitcnt lgkmcnt(10)
    v_mfma_f32_16x16x32_bf16 v[52:55], v[204:207], v[92:95], v[52:55]
    ds_read_b64_tr_b16 v[200:201], v46 offset:30752
    ds_read_b64_tr_b16 v[202:203], v46 offset:32032
    s_waitcnt lgkmcnt(10)
    v_mfma_f32_16x16x32_bf16 v[56:59], v[208:211], v[92:95], v[56:59]
    ds_read_b64_tr_b16 v[204:205], v46 offset:30784
    ds_read_b64_tr_b16 v[206:207], v46 offset:32064
    s_waitcnt lgkmcnt(10)
    v_mfma_f32_16x16x32_bf16 v[60:63], v[212:215], v[92:95], v[60:63]
    ds_read_b64_tr_b16 v[208:209], v46 offset:30816
    ds_read_b64_tr_b16 v[210:211], v46 offset:32096
    s_waitcnt lgkmcnt(10)
    v_mfma_f32_16x16x32_bf16 v[64:67], v[188:191], v[92:95], v[64:67]
    ds_read_b64_tr_b16 v[212:213], v46 offset:30848
    ds_read_b64_tr_b16 v[214:215], v46 offset:32128
    s_waitcnt lgkmcnt(10)
    v_mfma_f32_16x16x32_bf16 v[68:71], v[192:195], v[92:95], v[68:71]
    ds_read_b64_tr_b16 v[188:189], v46 offset:35840
    ds_read_b64_tr_b16 v[190:191], v46 offset:37120
    s_waitcnt lgkmcnt(10)
    v_mfma_f32_16x16x32_bf16 v[52:55], v[196:199], v[96:99], v[52:55]
    ds_read_b64_tr_b16 v[192:193], v46 offset:35872
    ds_read_b64_tr_b16 v[194:195], v46 offset:37152
    s_waitcnt lgkmcnt(10)
    v_mfma_f32_16x16x32_bf16 v[56:59], v[200:203], v[96:99], v[56:59]
    ds_read_b64_tr_b16 v[196:197], v46 offset:35904
    ds_read_b64_tr_b16 v[198:199], v46 offset:37184
    s_waitcnt lgkmcnt(10)
    v_mfma_f32_16x16x32_bf16 v[60:63], v[204:207], v[96:99], v[60:63]
    ds_read_b64_tr_b16 v[200:201], v46 offset:35936
    ds_read_b64_tr_b16 v[202:203], v46 offset:37216
    s_waitcnt lgkmcnt(10)
    v_mfma_f32_16x16x32_bf16 v[64:67], v[208:211], v[96:99], v[64:67]
    ds_read_b64_tr_b16 v[204:205], v46 offset:35968
    ds_read_b64_tr_b16 v[206:207], v46 offset:37248
    s_waitcnt lgkmcnt(10)
    v_mfma_f32_16x16x32_bf16 v[68:71], v[212:215], v[96:99], v[68:71]
    s_waitcnt vmcnt(18)
    s_barrier
    ds_read_b64_tr_b16 v[208:209], v46 offset:40960
    ds_read_b64_tr_b16 v[210:211], v46 offset:42240
    s_waitcnt lgkmcnt(10)
    v_mfma_f32_16x16x32_bf16 v[52:55], v[188:191], v[100:103], v[52:55]
    ds_read_b64_tr_b16 v[212:213], v46 offset:40992
    ds_read_b64_tr_b16 v[214:215], v46 offset:42272
    s_waitcnt lgkmcnt(10)
    v_mfma_f32_16x16x32_bf16 v[56:59], v[192:195], v[100:103], v[56:59]
    ds_read_b64_tr_b16 v[188:189], v46 offset:41024
    ds_read_b64_tr_b16 v[190:191], v46 offset:42304
    s_waitcnt lgkmcnt(10)
    v_mfma_f32_16x16x32_bf16 v[60:63], v[196:199], v[100:103], v[60:63]
    ds_read_b64_tr_b16 v[192:193], v46 offset:41056
    ds_read_b64_tr_b16 v[194:195], v46 offset:42336
    s_waitcnt lgkmcnt(10)
    v_mfma_f32_16x16x32_bf16 v[64:67], v[200:203], v[100:103], v[64:67]
    ds_read_b64_tr_b16 v[196:197], v46 offset:41088
    ds_read_b64_tr_b16 v[198:199], v46 offset:42368
    s_waitcnt lgkmcnt(10)
    v_mfma_f32_16x16x32_bf16 v[68:71], v[204:207], v[100:103], v[68:71]
    ds_read_b64_tr_b16 v[200:201], v46 offset:46080
    ds_read_b64_tr_b16 v[202:203], v46 offset:47360
    s_waitcnt lgkmcnt(10)
    v_mfma_f32_16x16x32_bf16 v[52:55], v[208:211], v[104:107], v[52:55]
    ds_read_b64_tr_b16 v[204:205], v46 offset:46112
    ds_read_b64_tr_b16 v[206:207], v46 offset:47392
    s_waitcnt lgkmcnt(10)
    v_mfma_f32_16x16x32_bf16 v[56:59], v[212:215], v[104:107], v[56:59]
    ds_read_b64_tr_b16 v[208:209], v46 offset:46144
    ds_read_b64_tr_b16 v[210:211], v46 offset:47424
    s_waitcnt lgkmcnt(10)
    v_mfma_f32_16x16x32_bf16 v[60:63], v[188:191], v[104:107], v[60:63]
    ds_read_b64_tr_b16 v[212:213], v46 offset:46176
    ds_read_b64_tr_b16 v[214:215], v46 offset:47456
    s_waitcnt lgkmcnt(10)
    v_mfma_f32_16x16x32_bf16 v[64:67], v[192:195], v[104:107], v[64:67]
    ds_read_b64_tr_b16 v[188:189], v46 offset:46208
    ds_read_b64_tr_b16 v[190:191], v46 offset:47488
    s_waitcnt lgkmcnt(10)
    v_mfma_f32_16x16x32_bf16 v[68:71], v[196:199], v[104:107], v[68:71]
    ds_read_b64_tr_b16 v[192:193], v46 offset:51200
    ds_read_b64_tr_b16 v[194:195], v46 offset:52480
    s_waitcnt lgkmcnt(10)
    v_mfma_f32_16x16x32_bf16 v[52:55], v[200:203], v[108:111], v[52:55]
    ds_read_b64_tr_b16 v[196:197], v46 offset:51232
    ds_read_b64_tr_b16 v[198:199], v46 offset:52512
    s_waitcnt lgkmcnt(10)
    v_mfma_f32_16x16x32_bf16 v[56:59], v[204:207], v[108:111], v[56:59]
    ds_read_b64_tr_b16 v[200:201], v46 offset:51264
    ds_read_b64_tr_b16 v[202:203], v46 offset:52544
    s_waitcnt lgkmcnt(10)
    v_mfma_f32_16x16x32_bf16 v[60:63], v[208:211], v[108:111], v[60:63]
    ds_read_b64_tr_b16 v[204:205], v46 offset:51296
    ds_read_b64_tr_b16 v[206:207], v46 offset:52576
    s_waitcnt lgkmcnt(10)
    v_mfma_f32_16x16x32_bf16 v[64:67], v[212:215], v[108:111], v[64:67]
    ds_read_b64_tr_b16 v[208:209], v46 offset:51328
    ds_read_b64_tr_b16 v[210:211], v46 offset:52608
    s_waitcnt lgkmcnt(10)
    v_mfma_f32_16x16x32_bf16 v[68:71], v[188:191], v[108:111], v[68:71]
    ds_read_b64_tr_b16 v[212:213], v46 offset:56320
    ds_read_b64_tr_b16 v[214:215], v46 offset:57600
    s_waitcnt lgkmcnt(10)
    v_mfma_f32_16x16x32_bf16 v[52:55], v[192:195], v[112:115], v[52:55]
    ds_read_b64_tr_b16 v[188:189], v46 offset:56352
    ds_read_b64_tr_b16 v[190:191], v46 offset:57632
    s_waitcnt lgkmcnt(10)
    v_mfma_f32_16x16x32_bf16 v[56:59], v[196:199], v[112:115], v[56:59]
    ds_read_b64_tr_b16 v[192:193], v46 offset:56384
    ds_read_b64_tr_b16 v[194:195], v46 offset:57664
    s_waitcnt lgkmcnt(10)
    v_mfma_f32_16x16x32_bf16 v[60:63], v[200:203], v[112:115], v[60:63]
    ds_read_b64_tr_b16 v[196:197], v46 offset:56416
    ds_read_b64_tr_b16 v[198:199], v46 offset:57696
    s_waitcnt lgkmcnt(10)
    v_mfma_f32_16x16x32_bf16 v[64:67], v[204:207], v[112:115], v[64:67]
    ds_read_b64_tr_b16 v[200:201], v46 offset:56448
    ds_read_b64_tr_b16 v[202:203], v46 offset:57728
    s_waitcnt lgkmcnt(10)
    v_mfma_f32_16x16x32_bf16 v[68:71], v[208:211], v[112:115], v[68:71]
    s_waitcnt vmcnt(9)
    s_barrier
    ds_read_b64_tr_b16 v[204:205], v46 offset:61440
    ds_read_b64_tr_b16 v[206:207], v46 offset:62720
    s_waitcnt lgkmcnt(10)
    v_mfma_f32_16x16x32_bf16 v[52:55], v[212:215], v[116:119], v[52:55]
    ds_read_b64_tr_b16 v[208:209], v46 offset:61472
    ds_read_b64_tr_b16 v[210:211], v46 offset:62752
    s_waitcnt lgkmcnt(10)
    v_mfma_f32_16x16x32_bf16 v[56:59], v[188:191], v[116:119], v[56:59]
    ds_read_b64_tr_b16 v[212:213], v46 offset:61504
    ds_read_b64_tr_b16 v[214:215], v46 offset:62784
    s_waitcnt lgkmcnt(10)
    v_mfma_f32_16x16x32_bf16 v[60:63], v[192:195], v[116:119], v[60:63]
    ds_read_b64_tr_b16 v[188:189], v46 offset:61536
    ds_read_b64_tr_b16 v[190:191], v46 offset:62816
    s_waitcnt lgkmcnt(10)
    v_mfma_f32_16x16x32_bf16 v[64:67], v[196:199], v[116:119], v[64:67]
    ds_read_b64_tr_b16 v[192:193], v46 offset:61568
    ds_read_b64_tr_b16 v[194:195], v46 offset:62848
    s_waitcnt lgkmcnt(10)
    v_mfma_f32_16x16x32_bf16 v[68:71], v[200:203], v[116:119], v[68:71]
    ds_read_b64_tr_b16 v[196:197], v47 offset:1024
    ds_read_b64_tr_b16 v[198:199], v47 offset:2304
    s_waitcnt lgkmcnt(10)
    v_mfma_f32_16x16x32_bf16 v[52:55], v[204:207], v[120:123], v[52:55]
    ds_read_b64_tr_b16 v[200:201], v47 offset:1056
    ds_read_b64_tr_b16 v[202:203], v47 offset:2336
    s_waitcnt lgkmcnt(10)
    v_mfma_f32_16x16x32_bf16 v[56:59], v[208:211], v[120:123], v[56:59]
    ds_read_b64_tr_b16 v[204:205], v47 offset:1088
    ds_read_b64_tr_b16 v[206:207], v47 offset:2368
    s_waitcnt lgkmcnt(10)
    v_mfma_f32_16x16x32_bf16 v[60:63], v[212:215], v[120:123], v[60:63]
    ds_read_b64_tr_b16 v[208:209], v47 offset:1120
    ds_read_b64_tr_b16 v[210:211], v47 offset:2400
    s_waitcnt lgkmcnt(10)
    v_mfma_f32_16x16x32_bf16 v[64:67], v[188:191], v[120:123], v[64:67]
    ds_read_b64_tr_b16 v[212:213], v47 offset:1152
    ds_read_b64_tr_b16 v[214:215], v47 offset:2432
    s_waitcnt lgkmcnt(10)
    v_mfma_f32_16x16x32_bf16 v[68:71], v[192:195], v[120:123], v[68:71]
    ds_read_b64_tr_b16 v[188:189], v47 offset:6144
    ds_read_b64_tr_b16 v[190:191], v47 offset:7424
    s_waitcnt lgkmcnt(10)
    v_mfma_f32_16x16x32_bf16 v[52:55], v[196:199], v[124:127], v[52:55]
    ds_read_b64_tr_b16 v[192:193], v47 offset:6176
    ds_read_b64_tr_b16 v[194:195], v47 offset:7456
    s_waitcnt lgkmcnt(10)
    v_mfma_f32_16x16x32_bf16 v[56:59], v[200:203], v[124:127], v[56:59]
    ds_read_b64_tr_b16 v[196:197], v47 offset:6208
    ds_read_b64_tr_b16 v[198:199], v47 offset:7488
    s_waitcnt lgkmcnt(10)
    v_mfma_f32_16x16x32_bf16 v[60:63], v[204:207], v[124:127], v[60:63]
    ds_read_b64_tr_b16 v[200:201], v47 offset:6240
    ds_read_b64_tr_b16 v[202:203], v47 offset:7520
    s_waitcnt lgkmcnt(10)
    v_mfma_f32_16x16x32_bf16 v[64:67], v[208:211], v[124:127], v[64:67]
    ds_read_b64_tr_b16 v[204:205], v47 offset:6272
    ds_read_b64_tr_b16 v[206:207], v47 offset:7552
    s_waitcnt lgkmcnt(10)
    v_mfma_f32_16x16x32_bf16 v[68:71], v[212:215], v[124:127], v[68:71]
    ds_read_b64_tr_b16 v[208:209], v47 offset:11264
    ds_read_b64_tr_b16 v[210:211], v47 offset:12544
    s_waitcnt lgkmcnt(10)
    v_mfma_f32_16x16x32_bf16 v[52:55], v[188:191], v[128:131], v[52:55]
    ds_read_b64_tr_b16 v[212:213], v47 offset:11296
    ds_read_b64_tr_b16 v[214:215], v47 offset:12576
    s_waitcnt lgkmcnt(10)
    v_mfma_f32_16x16x32_bf16 v[56:59], v[192:195], v[128:131], v[56:59]
    ds_read_b64_tr_b16 v[188:189], v47 offset:11328
    ds_read_b64_tr_b16 v[190:191], v47 offset:12608
    s_waitcnt lgkmcnt(10)
    v_mfma_f32_16x16x32_bf16 v[60:63], v[196:199], v[128:131], v[60:63]
    ds_read_b64_tr_b16 v[192:193], v47 offset:11360
    ds_read_b64_tr_b16 v[194:195], v47 offset:12640
    s_waitcnt lgkmcnt(10)
    v_mfma_f32_16x16x32_bf16 v[64:67], v[200:203], v[128:131], v[64:67]
    ds_read_b64_tr_b16 v[196:197], v47 offset:11392
    ds_read_b64_tr_b16 v[198:199], v47 offset:12672
    s_waitcnt lgkmcnt(10)
    v_mfma_f32_16x16x32_bf16 v[68:71], v[204:207], v[128:131], v[68:71]
    s_waitcnt vmcnt(0)
    s_barrier
    ds_read_b64_tr_b16 v[200:201], v47 offset:16384
    ds_read_b64_tr_b16 v[202:203], v47 offset:17664
    s_waitcnt lgkmcnt(10)
    v_mfma_f32_16x16x32_bf16 v[52:55], v[208:211], v[132:135], v[52:55]
    ds_read_b64_tr_b16 v[204:205], v47 offset:16416
    ds_read_b64_tr_b16 v[206:207], v47 offset:17696
    s_waitcnt lgkmcnt(10)
    v_mfma_f32_16x16x32_bf16 v[56:59], v[212:215], v[132:135], v[56:59]
    ds_read_b64_tr_b16 v[208:209], v47 offset:16448
    ds_read_b64_tr_b16 v[210:211], v47 offset:17728
    s_waitcnt lgkmcnt(10)
    v_mfma_f32_16x16x32_bf16 v[60:63], v[188:191], v[132:135], v[60:63]
    ds_read_b64_tr_b16 v[212:213], v47 offset:16480
    ds_read_b64_tr_b16 v[214:215], v47 offset:17760
    s_waitcnt lgkmcnt(10)
    v_mfma_f32_16x16x32_bf16 v[64:67], v[192:195], v[132:135], v[64:67]
    ds_read_b64_tr_b16 v[188:189], v47 offset:16512
    ds_read_b64_tr_b16 v[190:191], v47 offset:17792
    s_waitcnt lgkmcnt(10)
    v_mfma_f32_16x16x32_bf16 v[68:71], v[196:199], v[132:135], v[68:71]
    ds_read_b64_tr_b16 v[192:193], v47 offset:21504
    ds_read_b64_tr_b16 v[194:195], v47 offset:22784
    s_waitcnt lgkmcnt(10)
    v_mfma_f32_16x16x32_bf16 v[52:55], v[200:203], v[136:139], v[52:55]
    ds_read_b64_tr_b16 v[196:197], v47 offset:21536
    ds_read_b64_tr_b16 v[198:199], v47 offset:22816
    s_waitcnt lgkmcnt(10)
    v_mfma_f32_16x16x32_bf16 v[56:59], v[204:207], v[136:139], v[56:59]
    ds_read_b64_tr_b16 v[200:201], v47 offset:21568
    ds_read_b64_tr_b16 v[202:203], v47 offset:22848
    s_waitcnt lgkmcnt(10)
    v_mfma_f32_16x16x32_bf16 v[60:63], v[208:211], v[136:139], v[60:63]
    ds_read_b64_tr_b16 v[204:205], v47 offset:21600
    ds_read_b64_tr_b16 v[206:207], v47 offset:22880
    s_waitcnt lgkmcnt(10)
    v_mfma_f32_16x16x32_bf16 v[64:67], v[212:215], v[136:139], v[64:67]
    ds_read_b64_tr_b16 v[208:209], v47 offset:21632
    ds_read_b64_tr_b16 v[210:211], v47 offset:22912
    s_waitcnt lgkmcnt(10)
    v_mfma_f32_16x16x32_bf16 v[68:71], v[188:191], v[136:139], v[68:71]
    ds_read_b64_tr_b16 v[212:213], v47 offset:26624
    ds_read_b64_tr_b16 v[214:215], v47 offset:27904
    s_waitcnt lgkmcnt(10)
    v_mfma_f32_16x16x32_bf16 v[52:55], v[192:195], v[140:143], v[52:55]
    ds_read_b64_tr_b16 v[188:189], v47 offset:26656
    ds_read_b64_tr_b16 v[190:191], v47 offset:27936
    s_waitcnt lgkmcnt(10)
    v_mfma_f32_16x16x32_bf16 v[56:59], v[196:199], v[140:143], v[56:59]
    ds_read_b64_tr_b16 v[192:193], v47 offset:26688
    ds_read_b64_tr_b16 v[194:195], v47 offset:27968
    s_waitcnt lgkmcnt(10)
    v_mfma_f32_16x16x32_bf16 v[60:63], v[200:203], v[140:143], v[60:63]
    ds_read_b64_tr_b16 v[196:197], v47 offset:26720
    ds_read_b64_tr_b16 v[198:199], v47 offset:28000
    s_waitcnt lgkmcnt(10)
    v_mfma_f32_16x16x32_bf16 v[64:67], v[204:207], v[140:143], v[64:67]
    ds_read_b64_tr_b16 v[200:201], v47 offset:26752
    ds_read_b64_tr_b16 v[202:203], v47 offset:28032
    s_waitcnt lgkmcnt(10)
    v_mfma_f32_16x16x32_bf16 v[68:71], v[208:211], v[140:143], v[68:71]
    ds_read_b64_tr_b16 v[204:205], v47 offset:31744
    ds_read_b64_tr_b16 v[206:207], v47 offset:33024
    s_waitcnt lgkmcnt(10)
    v_mfma_f32_16x16x32_bf16 v[52:55], v[212:215], v[144:147], v[52:55]
    ds_read_b64_tr_b16 v[208:209], v47 offset:31776
    ds_read_b64_tr_b16 v[210:211], v47 offset:33056
    s_waitcnt lgkmcnt(10)
    v_mfma_f32_16x16x32_bf16 v[56:59], v[188:191], v[144:147], v[56:59]
    ds_read_b64_tr_b16 v[212:213], v47 offset:31808
    ds_read_b64_tr_b16 v[214:215], v47 offset:33088
    s_waitcnt lgkmcnt(10)
    v_mfma_f32_16x16x32_bf16 v[60:63], v[192:195], v[144:147], v[60:63]
    ds_read_b64_tr_b16 v[188:189], v47 offset:31840
    ds_read_b64_tr_b16 v[190:191], v47 offset:33120
    s_waitcnt lgkmcnt(10)
    v_mfma_f32_16x16x32_bf16 v[64:67], v[196:199], v[144:147], v[64:67]
    ds_read_b64_tr_b16 v[192:193], v47 offset:31872
    ds_read_b64_tr_b16 v[194:195], v47 offset:33152
    s_waitcnt lgkmcnt(10)
    v_mfma_f32_16x16x32_bf16 v[68:71], v[200:203], v[144:147], v[68:71]
    s_waitcnt lgkmcnt(8)
    v_mfma_f32_16x16x32_bf16 v[52:55], v[204:207], v[148:151], v[52:55]
    s_waitcnt lgkmcnt(6)
    v_mfma_f32_16x16x32_bf16 v[56:59], v[208:211], v[148:151], v[56:59]
    s_waitcnt lgkmcnt(4)
    v_mfma_f32_16x16x32_bf16 v[60:63], v[212:215], v[148:151], v[60:63]
    s_waitcnt lgkmcnt(2)
    v_mfma_f32_16x16x32_bf16 v[64:67], v[188:191], v[148:151], v[64:67]
    s_waitcnt lgkmcnt(0)
    v_mfma_f32_16x16x32_bf16 v[68:71], v[192:195], v[148:151], v[68:71]
    s_nop 7
    s_nop 1
    s_barrier
    v_cvt_pk_bf16_f32 v8, v52, v53
    v_and_b32 v9, 0xffff0000, v8
    v_lshlrev_b32 v8, 16, v8
    v_lshlrev_b32 v10, 16, v22
    v_and_b32 v11, 0xffff0000, v22
    v_add_f32 v8, v8, v10
    v_add_f32 v9, v9, v11
    v_cvt_pk_bf16_f32 v8, v8, v9
    v_and_b32 v9, 0xffff0000, v8
    v_lshlrev_b32 v8, 16, v8
    v_lshlrev_b32 v10, 16, v12
    v_and_b32 v11, 0xffff0000, v12
    v_add_f32 v8, v8, v10
    v_add_f32 v9, v9, v11
    v_cvt_pk_bf16_f32 v52, v8, v9
    v_cvt_pk_bf16_f32 v8, v54, v55
    v_and_b32 v9, 0xffff0000, v8
    v_lshlrev_b32 v8, 16, v8
    v_lshlrev_b32 v10, 16, v23
    v_and_b32 v11, 0xffff0000, v23
    v_add_f32 v8, v8, v10
    v_add_f32 v9, v9, v11
    v_cvt_pk_bf16_f32 v8, v8, v9
    v_and_b32 v9, 0xffff0000, v8
    v_lshlrev_b32 v8, 16, v8
    v_lshlrev_b32 v10, 16, v13
    v_and_b32 v11, 0xffff0000, v13
    v_add_f32 v8, v8, v10
    v_add_f32 v9, v9, v11
    v_cvt_pk_bf16_f32 v53, v8, v9
    buffer_store_dwordx2 v[52:53], v184, s[48:51], 0 offen offset:0
    v_cvt_pk_bf16_f32 v8, v56, v57
    v_and_b32 v9, 0xffff0000, v8
    v_lshlrev_b32 v8, 16, v8
    v_lshlrev_b32 v10, 16, v24
    v_and_b32 v11, 0xffff0000, v24
    v_add_f32 v8, v8, v10
    v_add_f32 v9, v9, v11
    v_cvt_pk_bf16_f32 v8, v8, v9
    v_and_b32 v9, 0xffff0000, v8
    v_lshlrev_b32 v8, 16, v8
    v_lshlrev_b32 v10, 16, v14
    v_and_b32 v11, 0xffff0000, v14
    v_add_f32 v8, v8, v10
    v_add_f32 v9, v9, v11
    v_cvt_pk_bf16_f32 v56, v8, v9
    v_cvt_pk_bf16_f32 v8, v58, v59
    v_and_b32 v9, 0xffff0000, v8
    v_lshlrev_b32 v8, 16, v8
    v_lshlrev_b32 v10, 16, v25
    v_and_b32 v11, 0xffff0000, v25
    v_add_f32 v8, v8, v10
    v_add_f32 v9, v9, v11
    v_cvt_pk_bf16_f32 v8, v8, v9
    v_and_b32 v9, 0xffff0000, v8
    v_lshlrev_b32 v8, 16, v8
    v_lshlrev_b32 v10, 16, v15
    v_and_b32 v11, 0xffff0000, v15
    v_add_f32 v8, v8, v10
    v_add_f32 v9, v9, v11
    v_cvt_pk_bf16_f32 v57, v8, v9
    buffer_store_dwordx2 v[56:57], v184, s[48:51], 0 offen offset:32
    v_cvt_pk_bf16_f32 v8, v60, v61
    v_and_b32 v9, 0xffff0000, v8
    v_lshlrev_b32 v8, 16, v8
    v_lshlrev_b32 v10, 16, v26
    v_and_b32 v11, 0xffff0000, v26
    v_add_f32 v8, v8, v10
    v_add_f32 v9, v9, v11
    v_cvt_pk_bf16_f32 v8, v8, v9
    v_and_b32 v9, 0xffff0000, v8
    v_lshlrev_b32 v8, 16, v8
    v_lshlrev_b32 v10, 16, v16
    v_and_b32 v11, 0xffff0000, v16
    v_add_f32 v8, v8, v10
    v_add_f32 v9, v9, v11
    v_cvt_pk_bf16_f32 v60, v8, v9
    v_cvt_pk_bf16_f32 v8, v62, v63
    v_and_b32 v9, 0xffff0000, v8
    v_lshlrev_b32 v8, 16, v8
    v_lshlrev_b32 v10, 16, v27
    v_and_b32 v11, 0xffff0000, v27
    v_add_f32 v8, v8, v10
    v_add_f32 v9, v9, v11
    v_cvt_pk_bf16_f32 v8, v8, v9
    v_and_b32 v9, 0xffff0000, v8
    v_lshlrev_b32 v8, 16, v8
    v_lshlrev_b32 v10, 16, v17
    v_and_b32 v11, 0xffff0000, v17
    v_add_f32 v8, v8, v10
    v_add_f32 v9, v9, v11
    v_cvt_pk_bf16_f32 v61, v8, v9
    buffer_store_dwordx2 v[60:61], v184, s[48:51], 0 offen offset:64
    v_cvt_pk_bf16_f32 v8, v64, v65
    v_and_b32 v9, 0xffff0000, v8
    v_lshlrev_b32 v8, 16, v8
    v_lshlrev_b32 v10, 16, v28
    v_and_b32 v11, 0xffff0000, v28
    v_add_f32 v8, v8, v10
    v_add_f32 v9, v9, v11
    v_cvt_pk_bf16_f32 v8, v8, v9
    v_and_b32 v9, 0xffff0000, v8
    v_lshlrev_b32 v8, 16, v8
    v_lshlrev_b32 v10, 16, v18
    v_and_b32 v11, 0xffff0000, v18
    v_add_f32 v8, v8, v10
    v_add_f32 v9, v9, v11
    v_cvt_pk_bf16_f32 v64, v8, v9
    v_cvt_pk_bf16_f32 v8, v66, v67
    v_and_b32 v9, 0xffff0000, v8
    v_lshlrev_b32 v8, 16, v8
    v_lshlrev_b32 v10, 16, v29
    v_and_b32 v11, 0xffff0000, v29
    v_add_f32 v8, v8, v10
    v_add_f32 v9, v9, v11
    v_cvt_pk_bf16_f32 v8, v8, v9
    v_and_b32 v9, 0xffff0000, v8
    v_lshlrev_b32 v8, 16, v8
    v_lshlrev_b32 v10, 16, v19
    v_and_b32 v11, 0xffff0000, v19
    v_add_f32 v8, v8, v10
    v_add_f32 v9, v9, v11
    v_cvt_pk_bf16_f32 v65, v8, v9
    buffer_store_dwordx2 v[64:65], v184, s[48:51], 0 offen offset:96
    v_cvt_pk_bf16_f32 v8, v68, v69
    v_and_b32 v9, 0xffff0000, v8
    v_lshlrev_b32 v8, 16, v8
    v_lshlrev_b32 v10, 16, v30
    v_and_b32 v11, 0xffff0000, v30
    v_add_f32 v8, v8, v10
    v_add_f32 v9, v9, v11
    v_cvt_pk_bf16_f32 v8, v8, v9
    v_and_b32 v9, 0xffff0000, v8
    v_lshlrev_b32 v8, 16, v8
    v_lshlrev_b32 v10, 16, v20
    v_and_b32 v11, 0xffff0000, v20
    v_add_f32 v8, v8, v10
    v_add_f32 v9, v9, v11
    v_cvt_pk_bf16_f32 v68, v8, v9
    v_cvt_pk_bf16_f32 v8, v70, v71
    v_and_b32 v9, 0xffff0000, v8
    v_lshlrev_b32 v8, 16, v8
    v_lshlrev_b32 v10, 16, v31
    v_and_b32 v11, 0xffff0000, v31
    v_add_f32 v8, v8, v10
    v_add_f32 v9, v9, v11
    v_cvt_pk_bf16_f32 v8, v8, v9
    v_and_b32 v9, 0xffff0000, v8
    v_lshlrev_b32 v8, 16, v8
    v_lshlrev_b32 v10, 16, v21
    v_and_b32 v11, 0xffff0000, v21
    v_add_f32 v8, v8, v10
    v_add_f32 v9, v9, v11
    v_cvt_pk_bf16_f32 v69, v8, v9
    buffer_store_dwordx2 v[68:69], v184, s[48:51], 0 offen offset:128
    s_endpgm
k3_fused_kernel_sync:
    s_waitcnt lgkmcnt(0)
    s_add_u32 s56, s36, 28835840
    s_addc_u32 s57, s37, 0
    s_and_b32 s57, s57, 0xffff
    s_mov_b32 s58, 8192
    s_mov_b32 s59, 0x00020000
    s_and_b32 s3, s2, 7
    s_lshr_b32 s4, s2, 3
    s_lshl_b32 s5, s3, 2
    s_and_b32 s9, s4, 3
    s_add_u32 s5, s5, s9
    s_lshl_b32 s6, s3, 1
    s_and_b32 s9, s4, 1
    s_add_u32 s6, s6, s9
    s_lshl_b32 s6, s6, 1
    s_barrier
    s_barrier
    s_barrier
    s_barrier
    s_barrier
    s_barrier
    s_barrier
    v_add_u32 v8, s5, v2
    v_lshlrev_b32 v8, 8, v8
    v_mov_b32 v9, 1
    s_mov_b64 exec, 1
    buffer_atomic_add v9, v8, s[56:59], 0 offen
    s_mov_b64 exec, -1
    v_mov_b32 v8, s5
    v_lshlrev_b32 v8, 8, v8
    s_mov_b32 s39, 0
    s_mov_b64 exec, 7
k3_fused_kernel_poll0:
    buffer_load_dword v9, v8, s[56:59], 0 offen sc1
    s_waitcnt vmcnt(0)
    v_cmp_le_u32 vcc, 8, v9
    s_nop 1
    s_cmp_eq_u64 vcc, 7
    s_cbranch_scc1 k3_fused_kernel_ready0
    s_add_u32 s39, s39, 1
    s_cmp_lt_u32 s39, 0x40000
    s_cbranch_scc0 k3_fused_kernel_ready0
    s_sleep 4
    s_branch k3_fused_kernel_poll0
k3_fused_kernel_ready0:
    s_mov_b64 exec, -1
    s_barrier
    s_barrier
    s_barrier
    s_barrier
    s_barrier
    s_barrier
    s_barrier
    s_barrier
    s_barrier
    v_add_u32 v8, s5, v2
    v_lshlrev_b32 v8, 8, v8
    v_mov_b32 v9, 1
    s_mov_b64 exec, 1
    buffer_atomic_add v9, v8, s[56:59], 0 offen
    s_mov_b64 exec, -1
    v_min_u32 v8, 2, v2
    v_add_u32 v8, s5, v8
    v_subrev_u32 v8, 1, v8
    v_max_i32 v8, 0, v8
    v_min_i32 v8, 31, v8
    v_lshlrev_b32 v8, 8, v8
    s_mov_b32 s39, 0
    s_mov_b64 exec, 7
k3_fused_kernel_poll1:
    buffer_load_dword v9, v8, s[56:59], 0 offen sc1
    s_waitcnt vmcnt(0)
    v_cmp_le_u32 vcc, 16, v9
    s_nop 1
    s_cmp_eq_u64 vcc, 7
    s_cbranch_scc1 k3_fused_kernel_ready1
    s_add_u32 s39, s39, 1
    s_cmp_lt_u32 s39, 0x40000
    s_cbranch_scc0 k3_fused_kernel_ready1
    s_sleep 4
    s_branch k3_fused_kernel_poll1
k3_fused_kernel_ready1:
    s_mov_b64 exec, -1
    s_barrier
    s_barrier
    s_barrier
    s_barrier
    s_barrier
    s_barrier
    s_barrier
    s_barrier
    v_add_u32 v8, s5, v2
    v_lshlrev_b32 v8, 8, v8
    v_mov_b32 v9, 1
    s_mov_b64 exec, 1
    buffer_atomic_add v9, v8, s[56:59], 0 offen
    s_mov_b64 exec, -1
    v_and_b32 v8, 1, v2
    v_add_u32 v8, s6, v8
    v_lshlrev_b32 v8, 8, v8
    s_mov_b32 s39, 0
    s_mov_b64 exec, 7
k3_fused_kernel_poll2:
    buffer_load_dword v9, v8, s[56:59], 0 offen sc1
    s_waitcnt vmcnt(0)
    v_cmp_le_u32 vcc, 24, v9
    s_nop 1
    s_cmp_eq_u64 vcc, 7
    s_cbranch_scc1 k3_fused_kernel_ready2
    s_add_u32 s39, s39, 1
    s_cmp_lt_u32 s39, 0x40000
    s_cbranch_scc0 k3_fused_kernel_ready2
    s_sleep 4
    s_branch k3_fused_kernel_poll2
k3_fused_kernel_ready2:
    s_mov_b64 exec, -1
    s_barrier
    s_barrier
    s_barrier
    s_barrier
    s_barrier
    s_barrier
    s_barrier
    s_barrier
    s_barrier
    s_barrier
    s_barrier
    s_barrier
    s_barrier
    s_barrier
    v_add_u32 v8, s6, v2
    v_lshlrev_b32 v8, 8, v8
    v_mov_b32 v9, 1
    s_mov_b64 exec, 3
    buffer_atomic_add v9, v8, s[56:59], 0 offen
    s_mov_b64 exec, -1
    v_mov_b32 v8, s5
    v_lshlrev_b32 v8, 8, v8
    s_mov_b32 s39, 0
    s_mov_b64 exec, 7
k3_fused_kernel_poll3:
    buffer_load_dword v9, v8, s[56:59], 0 offen sc1
    s_waitcnt vmcnt(0)
    v_cmp_le_u32 vcc, 40, v9
    s_nop 1
    s_cmp_eq_u64 vcc, 7
    s_cbranch_scc1 k3_fused_kernel_ready3
    s_add_u32 s39, s39, 1
    s_cmp_lt_u32 s39, 0x40000
    s_cbranch_scc0 k3_fused_kernel_ready3
    s_sleep 4
    s_branch k3_fused_kernel_poll3
k3_fused_kernel_ready3:
    s_mov_b64 exec, -1
    s_barrier
k3_fused_kernel_end:
    s_endpgm
.section .rodata,"a"
.p2align 6
.amdhsa_kernel k1_qkv_kernel
  .amdhsa_next_free_vgpr 164
  .amdhsa_next_free_sgpr 102
  .amdhsa_accum_offset 164
  .amdhsa_group_segment_fixed_size 0
  .amdhsa_kernarg_size 88
  .amdhsa_user_sgpr_count 2
  .amdhsa_user_sgpr_kernarg_segment_ptr 1
  .amdhsa_system_sgpr_workgroup_id_x 1
.end_amdhsa_kernel
.p2align 6
.amdhsa_kernel k2_attn_kernel
  .amdhsa_next_free_vgpr 208
  .amdhsa_next_free_sgpr 102
  .amdhsa_accum_offset 208
  .amdhsa_group_segment_fixed_size 0
  .amdhsa_kernarg_size 88
  .amdhsa_user_sgpr_count 2
  .amdhsa_user_sgpr_kernarg_segment_ptr 1
  .amdhsa_system_sgpr_workgroup_id_x 1
.end_amdhsa_kernel
.p2align 6
.amdhsa_kernel k3_fused_kernel
  .amdhsa_next_free_vgpr 244
  .amdhsa_next_free_sgpr 102
  .amdhsa_accum_offset 244
  .amdhsa_group_segment_fixed_size 0
  .amdhsa_kernarg_size 88
  .amdhsa_user_sgpr_count 2
  .amdhsa_user_sgpr_kernarg_segment_ptr 1
  .amdhsa_system_sgpr_workgroup_id_x 1
.end_amdhsa_kernel
```
